```python
import torch

def _softmax(x, axis=-1):
    return torch.softmax(x, dim=axis)
def _gelu(x):
    return torch.nn.functional.gelu(x, approximate="tanh")
def _silu(x):
    return torch.nn.functional.silu(x)
def _sigmoid(x):
    return torch.sigmoid(x)
def _layernorm(x, axis=-1, eps=1e-5):
    m = x.mean(dim=axis, keepdim=True)
    v = x.var(dim=axis, keepdim=True, unbiased=False)
    return (x - m) / torch.sqrt(v + eps)
def _scatter_add(tgt, idx, src, axis=0):
    return tgt.clone().index_add_(axis, idx, src)
def _segment_sum(src, seg, n):
    out = torch.zeros((n,) + src.shape[1:], dtype=src.dtype)
    return out.index_add_(0, seg, src)
def _pad(x, pw):
    flat = tuple(v for pair in reversed(pw) for v in pair)
    return torch.nn.functional.pad(x, flat)

kernel_name = 'standalone__qk_norm__prompt'

def setup_inputs():

    _w = (lambda a: (lambda t: t.to(torch.bfloat16) if t.is_floating_point() else t)(torch.as_tensor(a)))
    B, H, S, D = 1, 32, 2048, 1024
    Dh = D // H
    return {
        "q": _w((lambda *s: torch.randn(*s, dtype=torch.bfloat16) * 0.05)(B, H, S, Dh)),
        "k": _w((lambda *s: torch.randn(*s, dtype=torch.bfloat16) * 0.05)(B, H, S, Dh)),
        "v": _w((lambda *s: torch.randn(*s, dtype=torch.bfloat16) * 0.8)(B, H, S, Dh)),
        "t": _w(torch.abs((lambda *s: torch.randn(*s, dtype=torch.bfloat16) * 0.8)(H)) + 1.0),
    }

def reference(q, k, v, t):
    eps = 1e-6
    qn = q / (torch.sqrt((q * q).sum(axis=-1, keepdims=True)) + eps)
    kn = k / (torch.sqrt((k * k).sum(axis=-1, keepdims=True)) + eps)
    logits = torch.einsum('bhqd,bhkd->bhqk', qn, kn) * t[None, :, None, None]
    attn = _softmax(logits, axis=-1)
    return torch.einsum('bhqk,bhkd->bhqd', attn, v)
```

```asm
; @launch grid=(256,1,1) block=(256,1,1) lds=147456
.amdgcn_target "amdgcn-amd-amdhsa--gfx950"
.text
.p2align 12
.globl standalone__qk_norm__prompt_kernel
.p2align 8
.type standalone__qk_norm__prompt_kernel,@function
standalone__qk_norm__prompt_kernel:
    s_load_dwordx8 s[4:11], s[0:1], 0
    s_load_dwordx2 s[12:13], s[0:1], 32
    s_cmp_ge_u32 s2, 256
    s_cbranch_scc1 L_end
    s_getpc_b64 s[46:47]
    s_and_b32 s38, s2, 248
    v_lshrrev_b32 v15, 5, v0
    v_add_lshl_u32 v15, v15, s38, 7
    global_load_dword v31, v15, s[46:47]
    v_lshrrev_b32 v15, 6, v0
    v_and_b32 v0, 63, v0
    v_readfirstlane_b32 s32, v15
    v_lshlrev_b32 v2, 4, v0
    v_and_b32 v112, 48, v0
    v_xor_b32 v1, v112, v2
    s_and_b32 s33, s2, 7
    s_lshl_b32 s33, s33, 2
    s_bfe_u32 s38, s2, 131075
    s_add_u32 s33, s33, s38
    s_lshl_b32 s36, s32, 15
    s_lshl_b32 s38, s33, 17
    s_add_u32 s34, s38, s36
    s_lshr_b32 s39, s2, 5
    s_lshl_b32 s39, s39, 14
    s_add_u32 s35, s38, s39
    s_lshl_b32 s39, s32, 12
    s_add_u32 s35, s35, s39
    s_lshl_b32 s49, s33, 1
    s_and_b32 s49, s49, 60
    s_add_u32 s48, s34, 2048
    s_mov_b32 s18, 4194304
    s_mov_b32 s19, 131072
    s_mov_b32 s22, 4194304
    s_mov_b32 s23, 131072
    s_mov_b32 s26, 4194304
    s_mov_b32 s27, 131072
    s_add_u32 m0, s36, 24576
    v_lshlrev_b32 v112, 6, v0
    v_lshlrev_b32 v113, 2, v0
    v_and_b32 v113, 48, v113
    v_add3_u32 v4, v112, v113, s36
    v_xor_b32 v5, 16, v4
    v_xor_b32 v6, 32, v4
    v_xor_b32 v7, 48, v4
    v_and_b32 v112, 3, v0
    v_bfe_u32 v113, v0, 2, 2
    v_bfe_u32 v114, v0, 4, 1
    v_lshrrev_b32 v115, 5, v0
    v_lshlrev_b32 v116, 10, v114
    v_lshl_add_u32 v116, v112, 8, v116
    v_lshl_add_u32 v116, v113, 6, v116
    v_lshlrev_b32 v117, 1, v115
    v_xor_b32 v117, v117, v112
    v_lshl_add_u32 v116, v117, 4, v116
    v_add_u32 v8, s36, v116
    v_xor_b32 v9, 16, v8
    v_and_b32 v117, 1, v0
    v_lshlrev_b32 v117, 4, v117
    v_mov_b32 v116, 65535
    v_lshlrev_b32 v116, v117, v116
    s_mov_b32 s40, 572662306
    s_mov_b32 s41, 572662306
    s_mov_b32 s42, 1145324612
    s_mov_b32 s43, 1145324612
    s_mov_b32 s44, 2290649224
    s_mov_b32 s45, 2290649224
    s_mov_b32 vcc_lo, 3435973836
    s_mov_b32 vcc_hi, 3435973836
    v_cndmask_b32 v11, 0, v116, vcc
    v_xor_b32 v10, v11, v116
    v_mov_b32 v120, 0
    v_mov_b32 v121, 0
    v_mov_b32 v122, 0
    v_mov_b32 v123, 0
    s_waitcnt lgkmcnt(0)
    s_mov_b32 s16, s4
    s_mov_b32 s17, s5
    buffer_load_dwordx4 v1, s[16:19], s35 offen lds
    buffer_load_dwordx4 v1, s[16:19], s35 offen offset:1024 lds
    s_add_u32 m0, s36, 26624
    s_mov_b32 s20, s6
    s_mov_b32 s21, s7
    buffer_load_dwordx4 v1, s[20:23], s34 offen lds
    buffer_load_dwordx4 v1, s[20:23], s34 offen offset:1024 lds
    s_add_u32 m0, s36, 4096
    s_load_dword s37, s[10:11], s49
    s_mov_b32 s24, s8
    s_mov_b32 s25, s9
    buffer_load_dwordx4 v2, s[24:27], s34 offen lds
    buffer_load_dwordx4 v2, s[24:27], s34 offen offset:1024 lds
    s_add_u32 m0, s36, 0
    s_nop 0
    buffer_load_dwordx4 v1, s[20:23], s48 offen lds
    buffer_load_dwordx4 v1, s[20:23], s48 offen offset:1024 lds
    buffer_load_dwordx4 v1, s[20:23], s48 offen offset:2048 lds
    buffer_load_dwordx4 v1, s[20:23], s48 offen offset:3072 lds
    s_mov_b32 s28, s12
    s_mov_b32 s29, s13
    s_mov_b32 s30, 4194304
    v_mfma_f32_32x32x16_bf16 v[208:223], v[120:123], v[120:123], 0
    s_mov_b32 s31, 131072
    v_lshlrev_b32 v116, 9, v115
    v_lshl_add_u32 v116, v113, 6, v116
    v_lshl_add_u32 v116, v114, 5, v116
    v_and_b32 v117, 1, v112
    v_mfma_f32_32x32x16_bf16 v[224:239], v[120:123], v[120:123], 0
    v_lshl_add_u32 v116, v117, 4, v116
    v_lshrrev_b32 v117, 1, v112
    v_lshl_add_u32 v116, v117, 3, v116
    v_add_u32 v116, s36, v116
    v_add_u32 v3, 4096, v116
    v_mfma_f32_32x32x16_bf16 a[0:15], v[120:123], v[120:123], 0
    v_mov_b32 v12, 3722304989
    s_mov_b32 vcc_lo, 269488144
    s_mov_b32 vcc_hi, 269488144
    v_mov_b32 v116, 1065369472
    v_cndmask_b32 v22, 0, v116, vcc
    v_mfma_f32_32x32x16_bf16 a[16:31], v[120:123], v[120:123], 0
    v_cndmask_b32 v23, 0, v116, vcc
    s_mov_b32 vcc_lo, 16843009
    s_mov_b32 vcc_hi, 16843009
    v_cndmask_b32 v20, 0, v116, vcc
    v_cndmask_b32 v21, 0, v116, vcc
    v_mfma_f32_32x32x16_bf16 a[32:47], v[120:123], v[120:123], 0
    v_add_u32 v14, s36, v2
    s_lshl_b32 s38, s32, 12
    v_add_u32 v116, s38, v2
    s_mov_b32 s38, 16383
    s_mov_b32 s39, 131072
    v_mfma_f32_32x32x16_bf16 a[48:63], v[120:123], v[120:123], 0
    v_mov_b32 v117, s39
    v_add_u32 v15, v117, v116
    v_add_u32 v116, 4096, v116
    v_and_or_b32 v16, v116, s38, v117
    v_add_u32 v116, 4096, v116
    v_mfma_f32_32x32x16_bf16 a[64:79], v[120:123], v[120:123], 0
    v_and_or_b32 v17, v116, s38, v117
    v_add_u32 v116, 4096, v116
    v_and_or_b32 v18, v116, s38, v117
    v_add_u32 v116, 98304, v14
    v_and_b32 v248, 131071, v116
    v_mfma_f32_32x32x16_bf16 a[80:95], v[120:123], v[120:123], 0
    v_add_u32 v116, 65536, v14
    v_and_b32 v249, 131071, v116
    v_mfma_f32_16x16x32_bf16 v[240:243], v[120:123], v[120:123], 0
    v_add_u32 v116, 32768, v14
    v_and_b32 v250, 131071, v116
    v_mfma_f32_16x16x32_bf16 v[244:247], v[120:123], v[120:123], 0
    v_and_b32 v116, 31, v0
    v_lshlrev_b32 v116, 6, v116
    v_mfma_f32_16x16x32_bf16 a[96:99], v[120:123], v[120:123], 0
    v_lshl_add_u32 v117, v115, 4, v116
    v_bfe_u32 v116, v0, 1, 2
    v_mfma_f32_16x16x32_bf16 a[100:103], v[120:123], v[120:123], 0
    v_lshlrev_b32 v116, 4, v116
    v_xor_b32 v116, v116, v117
    v_mfma_f32_16x16x32_bf16 a[104:107], v[120:123], v[120:123], 0
    v_add_u32 v251, s36, v116
    v_xor_b32 v252, 32, v251
    v_mfma_f32_16x16x32_bf16 a[108:111], v[120:123], v[120:123], 0
    v_bfe_u32 v116, v0, 3, 2
    v_lshlrev_b32 v116, 4, v116
    v_mfma_f32_16x16x32_bf16 a[112:115], v[120:123], v[120:123], 0
    v_xor_b32 v253, v116, v2
    v_mfma_f32_16x16x32_bf16 a[116:119], v[120:123], v[120:123], 0
    s_waitcnt lgkmcnt(0)
    s_lshl_b32 s38, s37, 16
    s_and_b32 s39, s37, 4294901760
    s_bitcmp1_b32 s33, 0
    s_cselect_b32 s37, s39, s38
    v_mov_b32 v13, 1069066811
    s_mov_b32 vcc_lo, -1
    s_mov_b32 vcc_hi, 0
    v_mul_f32 v13, s37, v13
    v_cndmask_b32 v13, 1.0, v13, vcc
    s_and_b32 s37, s37, 2147483647
    s_mov_b64 vcc, -1
    s_cmp_eq_u32 s32, 0
    s_cbranch_scc1 L_t0
    s_cmp_eq_u32 s32, 1
    s_cbranch_scc1 L_t1
    s_cmp_eq_u32 s32, 2
    s_cbranch_scc1 L_t2
    s_branch L_t3
L_ret:
    s_mov_b64 vcc, 0
    s_waitcnt vmcnt(6)
    ds_read_b128 v[144:147], v4 offset:24576
    ds_read_b128 v[148:151], v5 offset:24576
    ds_read_b128 v[152:155], v6 offset:24576
    ds_read_b128 v[156:159], v7 offset:24576
    ds_read_b64_tr_b16 v[160:161], v8 offset:24576
    ds_read_b64_tr_b16 v[162:163], v8 offset:24584
    ds_read_b64_tr_b16 v[164:165], v9 offset:24576
    ds_read_b64_tr_b16 v[166:167], v9 offset:24584
    ds_read_b64_tr_b16 v[168:169], v8 offset:26624
    ds_read_b64_tr_b16 v[170:171], v8 offset:26632
    ds_read_b64_tr_b16 v[172:173], v9 offset:26624
    ds_read_b64_tr_b16 v[174:175], v9 offset:26632
    s_waitcnt lgkmcnt(11)
    v_mfma_f32_4x4x4_16b_bf16 v[24:27], v[144:145], v[144:145], 0
    s_add_u32 m0, s36, 4096
    s_add_u32 s48, s35, 2048
    v_mfma_f32_4x4x4_16b_bf16 v[24:27], v[146:147], v[146:147], v[24:27]
    s_waitcnt lgkmcnt(10)
    buffer_load_dwordx4 v2, s[24:27], s34 offen offset:2048 lds
    v_mfma_f32_4x4x4_16b_bf16 v[24:27], v[148:149], v[148:149], v[24:27]
    buffer_load_dwordx4 v2, s[24:27], s34 offen offset:3072 lds
    s_add_u32 m0, s36, 8192
    v_mfma_f32_4x4x4_16b_bf16 v[24:27], v[150:151], v[150:151], v[24:27]
    s_waitcnt lgkmcnt(9)
    buffer_load_dwordx4 v1, s[16:19], s48 offen lds
    v_mfma_f32_4x4x4_16b_bf16 v[24:27], v[152:153], v[152:153], v[24:27]
    buffer_load_dwordx4 v1, s[16:19], s48 offen offset:1024 lds
    s_add_u32 s48, s34, 4096
    v_mfma_f32_4x4x4_16b_bf16 v[24:27], v[154:155], v[154:155], v[24:27]
    s_waitcnt lgkmcnt(8)
    buffer_load_dwordx4 v1, s[20:23], s48 offen offset:2048 lds
    v_mfma_f32_4x4x4_16b_bf16 v[24:27], v[156:157], v[156:157], v[24:27]
    buffer_load_dwordx4 v1, s[20:23], s48 offen offset:3072 lds
    s_nop 0
    v_mfma_f32_4x4x4_16b_bf16 v[24:27], v[158:159], v[158:159], v[24:27]
    s_nop 4
    v_cndmask_b32 v28, v24, v25, s[40:41]
    v_cndmask_b32 v28, v28, v26, s[42:43]
    v_cndmask_b32 v28, v28, v27, s[44:45]
    v_sqrt_f32 v28, v28
    s_nop 0
    v_add_f32 v28, 0x358637bd, v28
    v_rcp_f32 v28, v28
    s_nop 0
    v_mul_f32 v28, v28, v13
    v_cvt_pk_bf16_f32 v29, v28, v28
    v_cvt_pk_bf16_f32 v30, v28, v28
    s_nop 1
    v_permlane32_swap_b32 v29, v30
    v_and_b32 v32, v29, v10
    v_and_b32 v33, v29, v11
    v_and_b32 v34, v30, v10
    v_and_b32 v35, v30, v11
    s_waitcnt lgkmcnt(0)
    v_mfma_f32_4x4x4_16b_bf16 v[64:67], v[160:161], v[32:33], 0
    v_mfma_f32_4x4x4_16b_bf16 v[68:71], v[162:163], v[32:33], 0
    v_mfma_f32_4x4x4_16b_bf16 v[72:75], v[164:165], v[32:33], 0
    v_mfma_f32_4x4x4_16b_bf16 v[76:79], v[166:167], v[32:33], 0
    v_mfma_f32_4x4x4_16b_bf16 v[80:83], v[168:169], v[34:35], 0
    s_nop 0
    v_cvt_pk_bf16_f32 v192, v64, v65
    v_cvt_pk_bf16_f32 v193, v66, v67
    v_mfma_f32_4x4x4_16b_bf16 v[84:87], v[170:171], v[34:35], 0
    v_cvt_pk_bf16_f32 v194, v68, v69
    v_cvt_pk_bf16_f32 v195, v70, v71
    v_mfma_f32_4x4x4_16b_bf16 v[88:91], v[172:173], v[34:35], 0
    v_cvt_pk_bf16_f32 v196, v72, v73
    v_cvt_pk_bf16_f32 v197, v74, v75
    v_mfma_f32_4x4x4_16b_bf16 v[92:95], v[174:175], v[34:35], 0
    v_cvt_pk_bf16_f32 v198, v76, v77
    v_cvt_pk_bf16_f32 v199, v78, v79
    ds_write_b128 v15, v[192:195]
    ds_write_b128 v15, v[196:199] offset:1024
    v_cvt_pk_bf16_f32 v96, v80, v81
    v_cvt_pk_bf16_f32 v97, v82, v83
    v_cvt_pk_bf16_f32 v98, v84, v85
    v_cvt_pk_bf16_f32 v99, v86, v87
    v_cvt_pk_bf16_f32 v100, v88, v89
    v_cvt_pk_bf16_f32 v101, v90, v91
    v_mfma_f32_32x32x16_bf16 v[48:63], v[96:99], v[192:195], 4.0
    v_cvt_pk_bf16_f32 v102, v92, v93
    v_cvt_pk_bf16_f32 v103, v94, v95
    s_waitcnt lgkmcnt(0)
    s_barrier
    v_mfma_f32_32x32x16_bf16 v[48:63], v[100:103], v[196:199], v[48:63]
    ds_read_b128 a[120:123], v16
    ds_read_b128 a[124:127], v16 offset:1024
    s_waitcnt vmcnt(10)
    ds_read_b64_tr_b16 v[128:129], v3
    ds_read_b64_tr_b16 v[130:131], v3 offset:256
    ds_read_b64_tr_b16 v[132:133], v3 offset:1024
    ds_read_b64_tr_b16 v[134:135], v3 offset:1280
    ds_read_b128 a[136:139], v17
    ds_read_b128 a[140:143], v17 offset:1024
    ds_read_b128 a[152:155], v18
    ds_read_b128 a[156:159], v18 offset:1024
    s_cmp_gt_u32 s37, 1098907648
    s_cbranch_scc1 L_slow
    v_exp_f32 v48, v48
    v_exp_f32 v49, v49
    v_exp_f32 v50, v50
    v_exp_f32 v51, v51
    v_exp_f32 v52, v52
    s_waitcnt lgkmcnt(8)
    v_mfma_f32_32x32x16_bf16 v[64:79], v[96:99], a[120:123], 4.0
    v_exp_f32 v53, v53
    v_exp_f32 v54, v54
    v_exp_f32 v55, v55
    v_mfma_f32_32x32x16_bf16 v[64:79], v[100:103], a[124:127], v[64:79]
    s_waitcnt lgkmcnt(2)
    v_exp_f32 v56, v56
    v_exp_f32 v57, v57
    v_exp_f32 v58, v58
    v_smfmac_f32_32x32x32_bf16 v[208:223], v[128:131], v[48:55], v12
    s_waitcnt vmcnt(6)
    ds_read_b128 v[144:147], v4
    ds_read_b128 v[148:151], v5
    v_exp_f32 v59, v59
    v_exp_f32 v60, v60
    v_exp_f32 v61, v61
    v_smfmac_f32_16x16x64_bf16 v[240:243], v[20:23], v[48:55], v12
    ds_read_b128 v[152:155], v6
    ds_read_b128 v[156:159], v7
    v_exp_f32 v62, v62
    v_exp_f32 v63, v63
    v_mfma_f32_32x32x16_bf16 v[80:95], v[96:99], a[136:139], 4.0
    ds_read_b64_tr_b16 v[160:161], v8
    v_exp_f32 v64, v64
    v_exp_f32 v65, v65
    v_exp_f32 v66, v66
    v_mfma_f32_32x32x16_bf16 v[80:95], v[100:103], a[140:143], v[80:95]
    ds_read_b64_tr_b16 v[162:163], v8 offset:8
    v_exp_f32 v67, v67
    v_exp_f32 v68, v68
    v_exp_f32 v69, v69
    v_smfmac_f32_32x32x32_bf16 v[208:223], v[132:135], v[56:63], v12
    s_waitcnt lgkmcnt(4)
    ds_read_b64_tr_b16 v[164:165], v9
    v_exp_f32 v70, v70
    v_exp_f32 v71, v71
    v_exp_f32 v72, v72
    v_smfmac_f32_16x16x64_bf16 v[240:243], v[20:23], v[56:63], v12
    ds_read_b64_tr_b16 v[166:167], v9 offset:8
    v_exp_f32 v73, v73
    v_mfma_f32_4x4x4_16b_bf16 v[24:27], v[144:145], v[144:145], 0
    v_exp_f32 v74, v74
    s_nop 0
    v_mfma_f32_4x4x4_16b_bf16 v[24:27], v[146:147], v[146:147], v[24:27]
    s_nop 1
    v_mfma_f32_4x4x4_16b_bf16 v[24:27], v[148:149], v[148:149], v[24:27]
    s_nop 1
    v_mfma_f32_4x4x4_16b_bf16 v[24:27], v[150:151], v[150:151], v[24:27]
    v_smfmac_f32_32x32x32_bf16 a[0:15], v[128:131], v[64:71], v12
    s_waitcnt lgkmcnt(4)
    v_exp_f32 v75, v75
    v_exp_f32 v76, v76
    v_exp_f32 v77, v77
    v_smfmac_f32_16x16x64_bf16 a[96:99], v[20:23], v[64:71], v12
    ds_read_b64_tr_b16 v[168:169], v8 offset:2048
    v_exp_f32 v78, v78
    v_mfma_f32_4x4x4_16b_bf16 v[24:27], v[152:153], v[152:153], v[24:27]
    v_exp_f32 v79, v79
    s_nop 0
    v_mfma_f32_4x4x4_16b_bf16 v[24:27], v[154:155], v[154:155], v[24:27]
    s_nop 1
    v_mfma_f32_4x4x4_16b_bf16 v[24:27], v[156:157], v[156:157], v[24:27]
    s_nop 1
    v_mfma_f32_4x4x4_16b_bf16 v[24:27], v[158:159], v[158:159], v[24:27]
    v_mfma_f32_32x32x16_bf16 v[48:63], v[96:99], a[152:155], 4.0
    v_exp_f32 v80, v80
    v_exp_f32 v81, v81
    v_exp_f32 v82, v82
    s_nop 0
    v_cndmask_b32 v28, v24, v25, s[40:41]
    v_mfma_f32_32x32x16_bf16 v[48:63], v[100:103], a[156:159], v[48:63]
    v_exp_f32 v83, v83
    v_cndmask_b32 v28, v28, v26, s[42:43]
    v_cndmask_b32 v28, v28, v27, s[44:45]
    v_sqrt_f32 v28, v28
    v_exp_f32 v84, v84
    v_exp_f32 v85, v85
    v_add_f32 v28, 0x358637bd, v28
    v_rcp_f32 v28, v28
    v_smfmac_f32_32x32x32_bf16 a[0:15], v[132:135], v[72:79], v12
    s_waitcnt lgkmcnt(1)
    v_exp_f32 v86, v86
    v_cvt_pk_bf16_f32 v29, v28, v28
    v_cvt_pk_bf16_f32 v30, v28, v28
    v_exp_f32 v87, v87
    v_exp_f32 v88, v88
    v_permlane32_swap_b32 v29, v30
    v_and_b32 v32, v29, v10
    v_and_b32 v33, v29, v11
    v_smfmac_f32_16x16x64_bf16 a[96:99], v[20:23], v[72:79], v12
    ds_read_b64_tr_b16 v[170:171], v8 offset:2056
    v_exp_f32 v89, v89
    v_mfma_f32_4x4x4_16b_bf16 v[176:179], v[160:161], v[32:33], 0
    v_and_b32 v34, v30, v10
    v_mfma_f32_4x4x4_16b_bf16 v[180:183], v[162:163], v[32:33], 0
    v_and_b32 v35, v30, v11
    v_exp_f32 v90, v90
    v_smfmac_f32_32x32x32_bf16 a[32:47], v[128:131], v[80:87], v12
    ds_read_b64_tr_b16 v[174:175], v9 offset:2056
    v_exp_f32 v91, v91
    v_exp_f32 v92, v92
    v_exp_f32 v93, v93
    v_smfmac_f32_16x16x64_bf16 a[104:107], v[20:23], v[80:87], v12
    ds_read_b64_tr_b16 v[172:173], v9 offset:2048
    v_exp_f32 v94, v94
    v_mfma_f32_4x4x4_16b_bf16 v[184:187], v[164:165], v[32:33], 0
    v_cvt_pk_bf16_f32 v104, v176, v177
    v_mfma_f32_4x4x4_16b_bf16 v[188:191], v[166:167], v[32:33], 0
    v_cvt_pk_bf16_f32 v105, v178, v179
    v_exp_f32 v95, v95
    v_cvt_pk_bf16_f32 v106, v180, v181
    v_cvt_pk_bf16_f32 v107, v182, v183
    v_smfmac_f32_32x32x32_bf16 a[32:47], v[132:135], v[88:95], v12
    v_exp_f32 v48, v48
    v_cvt_pk_bf16_f32 v108, v184, v185
    v_cvt_pk_bf16_f32 v109, v186, v187
    v_exp_f32 v49, v49
    v_exp_f32 v50, v50
    v_cvt_pk_bf16_f32 v110, v188, v189
    v_cvt_pk_bf16_f32 v111, v190, v191
    v_smfmac_f32_16x16x64_bf16 a[104:107], v[20:23], v[88:95], v12
    v_exp_f32 v51, v51
    v_exp_f32 v52, v52
    v_mfma_f32_32x32x16_bf16 v[64:79], v[104:107], v[192:195], 4.0
    s_waitcnt vmcnt(4)
    ds_read_b64_tr_b16 v[136:137], v3 offset:2048
    v_exp_f32 v53, v53
    v_exp_f32 v54, v54
    v_exp_f32 v55, v55
    v_mfma_f32_32x32x16_bf16 v[64:79], v[108:111], v[196:199], v[64:79]
    ds_read_b64_tr_b16 v[138:139], v3 offset:2304
    v_exp_f32 v56, v56
    v_exp_f32 v57, v57
    v_exp_f32 v58, v58
    v_smfmac_f32_32x32x32_bf16 a[64:79], v[128:131], v[48:55], v12
    ds_read_b64_tr_b16 v[140:141], v3 offset:3072
    v_exp_f32 v59, v59
    v_exp_f32 v60, v60
    v_exp_f32 v61, v61
    v_smfmac_f32_16x16x64_bf16 a[112:115], v[20:23], v[48:55], v12
    s_waitcnt vmcnt(0)
    ds_read_b128 v[144:147], v4 offset:8192
    ds_read_b128 v[148:151], v5 offset:8192
    v_exp_f32 v62, v62
    v_exp_f32 v63, v63
    v_mfma_f32_32x32x16_bf16 v[80:95], v[104:107], a[120:123], 4.0
    ds_read_b64_tr_b16 v[142:143], v3 offset:3328
    v_exp_f32 v64, v64
    v_exp_f32 v65, v65
    v_exp_f32 v66, v66
    v_mfma_f32_32x32x16_bf16 v[80:95], v[108:111], a[124:127], v[80:95]
    ds_read_b128 v[152:155], v6 offset:8192
    v_exp_f32 v67, v67
    v_exp_f32 v68, v68
    v_exp_f32 v69, v69
    v_smfmac_f32_32x32x32_bf16 a[64:79], v[132:135], v[56:63], v12
    s_waitcnt lgkmcnt(1)
    ds_read_b128 v[156:159], v7 offset:8192
    v_exp_f32 v70, v70
    v_exp_f32 v71, v71
    v_exp_f32 v72, v72
    v_smfmac_f32_16x16x64_bf16 a[112:115], v[20:23], v[56:63], v12
    ds_read_b64_tr_b16 v[160:161], v8 offset:8192
    v_exp_f32 v73, v73
    v_mfma_f32_4x4x4_16b_bf16 v[24:27], v[144:145], v[144:145], 0
    v_exp_f32 v74, v74
    s_nop 0
    v_mfma_f32_4x4x4_16b_bf16 v[24:27], v[146:147], v[146:147], v[24:27]
    v_smfmac_f32_32x32x32_bf16 v[208:223], v[136:139], v[64:71], v12
    v_exp_f32 v75, v75
    v_exp_f32 v76, v76
    v_exp_f32 v77, v77
    v_smfmac_f32_16x16x64_bf16 v[240:243], v[20:23], v[64:71], v12
    ds_read_b64_tr_b16 v[162:163], v8 offset:8200
    v_exp_f32 v78, v78
    v_mfma_f32_4x4x4_16b_bf16 v[24:27], v[148:149], v[148:149], v[24:27]
    v_exp_f32 v79, v79
    s_nop 0
    v_mfma_f32_4x4x4_16b_bf16 v[24:27], v[150:151], v[150:151], v[24:27]
    v_mfma_f32_32x32x16_bf16 v[48:63], v[104:107], a[136:139], 4.0
    s_add_u32 m0, s36, 12288
    v_exp_f32 v80, v80
    v_exp_f32 v81, v81
    v_exp_f32 v82, v82
    v_mfma_f32_32x32x16_bf16 v[48:63], v[108:111], a[140:143], v[48:63]
    s_add_u32 s48, s34, 4096
    v_exp_f32 v83, v83
    v_exp_f32 v84, v84
    v_exp_f32 v85, v85
    v_smfmac_f32_32x32x32_bf16 v[208:223], v[140:143], v[72:79], v12
    buffer_load_dwordx4 v2, s[24:27], s48 offen lds
    buffer_load_dwordx4 v2, s[24:27], s48 offen offset:1024 lds
    v_exp_f32 v86, v86
    v_exp_f32 v87, v87
    v_exp_f32 v88, v88
    v_smfmac_f32_16x16x64_bf16 v[240:243], v[20:23], v[72:79], v12
    s_waitcnt lgkmcnt(2)
    ds_read_b64_tr_b16 v[164:165], v9 offset:8192
    v_exp_f32 v89, v89
    v_mfma_f32_4x4x4_16b_bf16 v[24:27], v[152:153], v[152:153], v[24:27]
    v_exp_f32 v90, v90
    s_nop 0
    v_mfma_f32_4x4x4_16b_bf16 v[24:27], v[154:155], v[154:155], v[24:27]
    v_smfmac_f32_32x32x32_bf16 a[0:15], v[136:139], v[80:87], v12
    buffer_load_dwordx4 v2, s[24:27], s48 offen offset:2048 lds
    buffer_load_dwordx4 v2, s[24:27], s48 offen offset:3072 lds
    v_exp_f32 v91, v91
    v_exp_f32 v92, v92
    v_exp_f32 v93, v93
    v_smfmac_f32_16x16x64_bf16 a[96:99], v[20:23], v[80:87], v12
    ds_read_b64_tr_b16 v[166:167], v9 offset:8200
    v_exp_f32 v94, v94
    v_mfma_f32_4x4x4_16b_bf16 v[24:27], v[156:157], v[156:157], v[24:27]
    v_exp_f32 v95, v95
    s_nop 0
    v_mfma_f32_4x4x4_16b_bf16 v[24:27], v[158:159], v[158:159], v[24:27]
    v_mfma_f32_32x32x16_bf16 v[64:79], v[104:107], a[152:155], 4.0
    s_add_u32 m0, s36, 16384
    v_exp_f32 v48, v48
    v_exp_f32 v49, v49
    v_exp_f32 v50, v50
    v_cndmask_b32 v28, v24, v25, s[40:41]
    v_mfma_f32_32x32x16_bf16 v[64:79], v[108:111], a[156:159], v[64:79]
    s_add_u32 s48, s34, 8192
    v_exp_f32 v51, v51
    v_cndmask_b32 v28, v28, v26, s[42:43]
    v_cndmask_b32 v28, v28, v27, s[44:45]
    v_sqrt_f32 v28, v28
    v_exp_f32 v52, v52
    v_exp_f32 v53, v53
    v_add_f32 v28, 0x358637bd, v28
    v_rcp_f32 v28, v28
    v_smfmac_f32_32x32x32_bf16 a[0:15], v[140:143], v[88:95], v12
    buffer_load_dwordx4 v1, s[20:23], s48 offen lds
    buffer_load_dwordx4 v1, s[20:23], s48 offen offset:1024 lds
    v_exp_f32 v54, v54
    v_mul_f32 v28, v28, v13
    v_cvt_pk_bf16_f32 v29, v28, v28
    v_cvt_pk_bf16_f32 v30, v28, v28
    v_exp_f32 v55, v55
    v_exp_f32 v56, v56
    v_permlane32_swap_b32 v29, v30
    v_and_b32 v44, v29, v10
    v_and_b32 v45, v29, v11
    v_smfmac_f32_16x16x64_bf16 a[96:99], v[20:23], v[88:95], v12
    s_waitcnt lgkmcnt(0)
    v_exp_f32 v57, v57
    v_mfma_f32_4x4x4_16b_bf16 v[176:179], v[160:161], v[44:45], 0
    v_and_b32 v46, v30, v10
    v_mfma_f32_4x4x4_16b_bf16 v[180:183], v[162:163], v[44:45], 0
    v_and_b32 v47, v30, v11
    v_exp_f32 v58, v58
    v_smfmac_f32_32x32x32_bf16 a[32:47], v[136:139], v[48:55], v12
    buffer_load_dwordx4 v1, s[20:23], s48 offen offset:2048 lds
    buffer_load_dwordx4 v1, s[20:23], s48 offen offset:3072 lds
    v_exp_f32 v59, v59
    v_exp_f32 v60, v60
    v_exp_f32 v61, v61
    v_smfmac_f32_16x16x64_bf16 a[104:107], v[20:23], v[48:55], v12
L_t0:
    s_cbranch_vccnz L_t4
    v_exp_f32 v62, v62
    v_mfma_f32_4x4x4_16b_bf16 v[184:187], v[164:165], v[44:45], 0
    v_cvt_pk_bf16_f32 v200, v176, v177
    v_mfma_f32_4x4x4_16b_bf16 v[188:191], v[166:167], v[44:45], 0
    v_cvt_pk_bf16_f32 v201, v178, v179
    v_exp_f32 v63, v63
    v_cvt_pk_bf16_f32 v202, v180, v181
    v_cvt_pk_bf16_f32 v203, v182, v183
    v_smfmac_f32_32x32x32_bf16 a[32:47], v[140:143], v[56:63], v12
    v_exp_f32 v64, v64
    v_cvt_pk_bf16_f32 v204, v184, v185
    v_cvt_pk_bf16_f32 v205, v186, v187
    v_exp_f32 v65, v65
    v_exp_f32 v66, v66
    v_cvt_pk_bf16_f32 v206, v188, v189
    v_cvt_pk_bf16_f32 v207, v190, v191
    v_smfmac_f32_16x16x64_bf16 a[104:107], v[20:23], v[56:63], v12
    ds_write_b128 v15, v[200:203] offset:2048
    v_exp_f32 v67, v67
    v_exp_f32 v68, v68
    v_mfma_f32_32x32x16_bf16 v[80:95], v[96:99], v[200:203], 4.0
    v_exp_f32 v69, v69
    v_exp_f32 v70, v70
    v_exp_f32 v71, v71
    v_mfma_f32_32x32x16_bf16 v[80:95], v[100:103], v[204:207], v[80:95]
    v_exp_f32 v72, v72
    v_exp_f32 v73, v73
    v_exp_f32 v74, v74
    v_smfmac_f32_32x32x32_bf16 a[64:79], v[136:139], v[64:71], v12
    v_exp_f32 v75, v75
    v_exp_f32 v76, v76
    v_exp_f32 v77, v77
    v_smfmac_f32_16x16x64_bf16 a[112:115], v[20:23], v[64:71], v12
    ds_write_b128 v15, v[204:207] offset:3072
    v_exp_f32 v78, v78
    v_exp_f32 v79, v79
    v_mfma_f32_32x32x16_bf16 v[48:63], v[104:107], v[200:203], 4.0
    s_waitcnt lgkmcnt(0)
    v_exp_f32 v80, v80
    v_exp_f32 v81, v81
    v_exp_f32 v82, v82
    v_mfma_f32_32x32x16_bf16 v[48:63], v[108:111], v[204:207], v[48:63]
    s_barrier
    v_exp_f32 v83, v83
    v_exp_f32 v84, v84
    v_exp_f32 v85, v85
    v_smfmac_f32_32x32x32_bf16 a[64:79], v[140:143], v[72:79], v12
    ds_read_b128 a[128:131], v16 offset:2048
    v_exp_f32 v86, v86
    v_exp_f32 v87, v87
    v_exp_f32 v88, v88
    v_smfmac_f32_16x16x64_bf16 a[112:115], v[20:23], v[72:79], v12
    ds_read_b128 a[132:135], v16 offset:3072
    v_exp_f32 v89, v89
    v_mfma_f32_4x4x4_16b_bf16 v[176:179], v[168:169], v[34:35], 0
    v_exp_f32 v90, v90
    v_smfmac_f32_32x32x32_bf16 v[224:239], v[128:131], v[80:87], v12
    v_exp_f32 v91, v91
    v_exp_f32 v92, v92
    v_exp_f32 v93, v93
    v_smfmac_f32_16x16x64_bf16 v[244:247], v[20:23], v[80:87], v12
    s_waitcnt lgkmcnt(0)
    ds_read_b128 a[144:147], v17 offset:2048
    v_exp_f32 v94, v94
    v_mfma_f32_4x4x4_16b_bf16 v[180:183], v[170:171], v[34:35], 0
    v_exp_f32 v95, v95
    v_cvt_pk_bf16_f32 v112, v176, v177
    v_cvt_pk_bf16_f32 v113, v178, v179
    v_mfma_f32_32x32x16_bf16 v[64:79], v[96:99], a[128:131], 4.0
    v_exp_f32 v48, v48
    v_exp_f32 v49, v49
    v_exp_f32 v50, v50
    v_mfma_f32_32x32x16_bf16 v[64:79], v[100:103], a[132:135], v[64:79]
    v_exp_f32 v51, v51
    v_exp_f32 v52, v52
    v_exp_f32 v53, v53
    v_cvt_pk_bf16_f32 v114, v180, v181
    v_cvt_pk_bf16_f32 v115, v182, v183
    v_smfmac_f32_32x32x32_bf16 v[224:239], v[132:135], v[88:95], v12
    ds_read_b128 a[148:151], v17 offset:3072
    v_exp_f32 v54, v54
    v_exp_f32 v55, v55
    v_exp_f32 v56, v56
    v_smfmac_f32_16x16x64_bf16 v[244:247], v[20:23], v[88:95], v12
    ds_read_b128 a[160:163], v18 offset:2048
    v_exp_f32 v57, v57
    v_mfma_f32_4x4x4_16b_bf16 v[184:187], v[172:173], v[34:35], 0
    v_exp_f32 v58, v58
    v_smfmac_f32_32x32x32_bf16 v[224:239], v[136:139], v[48:55], v12
    s_waitcnt lgkmcnt(1)
    v_exp_f32 v59, v59
    v_exp_f32 v60, v60
    v_exp_f32 v61, v61
    v_smfmac_f32_16x16x64_bf16 v[244:247], v[20:23], v[48:55], v12
    ds_read_b128 a[164:167], v18 offset:3072
    v_exp_f32 v62, v62
    v_mfma_f32_4x4x4_16b_bf16 v[188:191], v[174:175], v[34:35], 0
    v_exp_f32 v63, v63
    v_cvt_pk_bf16_f32 v116, v184, v185
    v_cvt_pk_bf16_f32 v117, v186, v187
    v_mfma_f32_32x32x16_bf16 v[80:95], v[96:99], a[144:147], 4.0
    ds_read_b64_tr_b16 v[168:169], v8 offset:10240
    v_exp_f32 v64, v64
    v_exp_f32 v65, v65
    v_exp_f32 v66, v66
    v_mfma_f32_32x32x16_bf16 v[80:95], v[100:103], a[148:151], v[80:95]
    ds_read_b64_tr_b16 v[170:171], v8 offset:10248
    v_exp_f32 v67, v67
    v_exp_f32 v68, v68
    v_exp_f32 v69, v69
    v_cvt_pk_bf16_f32 v118, v188, v189
    v_cvt_pk_bf16_f32 v119, v190, v191
    v_smfmac_f32_32x32x32_bf16 v[224:239], v[140:143], v[56:63], v12
    v_exp_f32 v70, v70
    v_exp_f32 v71, v71
    v_exp_f32 v72, v72
    v_smfmac_f32_16x16x64_bf16 v[244:247], v[20:23], v[56:63], v12
    ds_read_b64_tr_b16 v[172:173], v9 offset:10240
    v_exp_f32 v73, v73
    v_exp_f32 v74, v74
    v_smfmac_f32_32x32x32_bf16 a[16:31], v[128:131], v[64:71], v12
    s_waitcnt lgkmcnt(3)
    v_exp_f32 v75, v75
    v_exp_f32 v76, v76
    v_exp_f32 v77, v77
    v_smfmac_f32_16x16x64_bf16 a[100:103], v[20:23], v[64:71], v12
    ds_read_b64_tr_b16 v[174:175], v9 offset:10248
    v_exp_f32 v78, v78
    v_exp_f32 v79, v79
    v_mfma_f32_32x32x16_bf16 v[48:63], v[96:99], a[160:163], 4.0
    s_add_u32 m0, s36, 20480
    v_exp_f32 v80, v80
    v_exp_f32 v81, v81
    v_exp_f32 v82, v82
    v_mfma_f32_32x32x16_bf16 v[48:63], v[100:103], a[164:167], v[48:63]
    s_add_u32 s48, s34, 8192
    v_exp_f32 v83, v83
    v_exp_f32 v84, v84
    v_exp_f32 v85, v85
    v_smfmac_f32_32x32x32_bf16 a[16:31], v[132:135], v[72:79], v12
    v_exp_f32 v86, v86
    v_exp_f32 v87, v87
    v_exp_f32 v88, v88
    v_smfmac_f32_16x16x64_bf16 a[100:103], v[20:23], v[72:79], v12
    buffer_load_dwordx4 v2, s[24:27], s48 offen lds
    v_exp_f32 v89, v89
    v_exp_f32 v90, v90
    v_smfmac_f32_32x32x32_bf16 a[48:63], v[128:131], v[80:87], v12
    v_exp_f32 v91, v91
    v_exp_f32 v92, v92
    v_exp_f32 v93, v93
    v_smfmac_f32_16x16x64_bf16 a[108:111], v[20:23], v[80:87], v12
    buffer_load_dwordx4 v2, s[24:27], s48 offen offset:1024 lds
    v_exp_f32 v94, v94
    v_exp_f32 v95, v95
    v_mfma_f32_32x32x16_bf16 v[64:79], v[104:107], a[128:131], 4.0
    v_exp_f32 v48, v48
    v_exp_f32 v49, v49
    v_exp_f32 v50, v50
    v_mfma_f32_32x32x16_bf16 v[64:79], v[108:111], a[132:135], v[64:79]
    v_exp_f32 v51, v51
    v_exp_f32 v52, v52
    v_exp_f32 v53, v53
    v_smfmac_f32_32x32x32_bf16 a[48:63], v[132:135], v[88:95], v12
    s_waitcnt lgkmcnt(0)
    v_exp_f32 v54, v54
    v_exp_f32 v55, v55
    v_exp_f32 v56, v56
    v_smfmac_f32_16x16x64_bf16 a[108:111], v[20:23], v[88:95], v12
    buffer_load_dwordx4 v2, s[24:27], s48 offen offset:2048 lds
    v_exp_f32 v57, v57
    v_mfma_f32_4x4x4_16b_bf16 v[176:179], v[168:169], v[46:47], 0
    v_exp_f32 v58, v58
    v_smfmac_f32_32x32x32_bf16 a[80:95], v[128:131], v[48:55], v12
    v_exp_f32 v59, v59
    v_exp_f32 v60, v60
    v_exp_f32 v61, v61
    v_smfmac_f32_16x16x64_bf16 a[116:119], v[20:23], v[48:55], v12
    buffer_load_dwordx4 v2, s[24:27], s48 offen offset:3072 lds
    v_exp_f32 v62, v62
    v_mfma_f32_4x4x4_16b_bf16 v[180:183], v[170:171], v[46:47], 0
    v_exp_f32 v63, v63
    v_cvt_pk_bf16_f32 v120, v176, v177
    v_cvt_pk_bf16_f32 v121, v178, v179
    v_mfma_f32_32x32x16_bf16 v[80:95], v[104:107], a[144:147], 4.0
    v_exp_f32 v64, v64
    v_exp_f32 v65, v65
    v_exp_f32 v66, v66
    v_mfma_f32_32x32x16_bf16 v[80:95], v[108:111], a[148:151], v[80:95]
    v_exp_f32 v67, v67
    v_exp_f32 v68, v68
    v_exp_f32 v69, v69
    v_cvt_pk_bf16_f32 v122, v180, v181
    v_cvt_pk_bf16_f32 v123, v182, v183
    v_smfmac_f32_32x32x32_bf16 a[80:95], v[132:135], v[56:63], v12
    s_waitcnt vmcnt(10)
    v_exp_f32 v70, v70
    v_exp_f32 v71, v71
    v_exp_f32 v72, v72
    v_smfmac_f32_16x16x64_bf16 a[116:119], v[20:23], v[56:63], v12
    ds_read_b64_tr_b16 v[128:129], v3 offset:8192
    v_exp_f32 v73, v73
    v_mfma_f32_4x4x4_16b_bf16 v[184:187], v[172:173], v[46:47], 0
    v_exp_f32 v74, v74
    v_smfmac_f32_32x32x32_bf16 a[16:31], v[136:139], v[64:71], v12
    v_exp_f32 v75, v75
    v_exp_f32 v76, v76
    v_exp_f32 v77, v77
    v_smfmac_f32_16x16x64_bf16 a[100:103], v[20:23], v[64:71], v12
    ds_read_b64_tr_b16 v[130:131], v3 offset:8448
    v_exp_f32 v78, v78
    v_mfma_f32_4x4x4_16b_bf16 v[188:191], v[174:175], v[46:47], 0
    v_exp_f32 v79, v79
    v_cvt_pk_bf16_f32 v124, v184, v185
    v_cvt_pk_bf16_f32 v125, v186, v187
    v_mfma_f32_32x32x16_bf16 v[48:63], v[104:107], a[160:163], 4.0
    v_exp_f32 v80, v80
    v_exp_f32 v81, v81
    v_exp_f32 v82, v82
    v_mfma_f32_32x32x16_bf16 v[48:63], v[108:111], a[164:167], v[48:63]
    v_exp_f32 v83, v83
    v_exp_f32 v84, v84
    v_exp_f32 v85, v85
    v_cvt_pk_bf16_f32 v126, v188, v189
    v_cvt_pk_bf16_f32 v127, v190, v191
    v_smfmac_f32_32x32x32_bf16 a[16:31], v[140:143], v[72:79], v12
    v_exp_f32 v86, v86
    v_exp_f32 v87, v87
    v_exp_f32 v88, v88
    v_smfmac_f32_16x16x64_bf16 a[100:103], v[20:23], v[72:79], v12
    ds_read_b64_tr_b16 v[132:133], v3 offset:9216
    v_exp_f32 v89, v89
    v_exp_f32 v90, v90
    v_smfmac_f32_32x32x32_bf16 a[48:63], v[136:139], v[80:87], v12
    v_exp_f32 v91, v91
    v_exp_f32 v92, v92
    v_exp_f32 v93, v93
    v_smfmac_f32_16x16x64_bf16 a[108:111], v[20:23], v[80:87], v12
    ds_read_b64_tr_b16 v[134:135], v3 offset:9472
    v_exp_f32 v94, v94
    v_exp_f32 v95, v95
    v_mfma_f32_32x32x16_bf16 v[64:79], v[112:115], v[192:195], 4.0
    s_add_u32 m0, s36, 24576
    v_exp_f32 v48, v48
    v_exp_f32 v49, v49
    v_exp_f32 v50, v50
    v_mfma_f32_32x32x16_bf16 v[64:79], v[116:119], v[196:199], v[64:79]
    s_add_u32 s48, s34, 12288
    v_exp_f32 v51, v51
    v_exp_f32 v52, v52
    v_exp_f32 v53, v53
    v_smfmac_f32_32x32x32_bf16 a[48:63], v[140:143], v[88:95], v12
    buffer_load_dwordx4 v1, s[20:23], s48 offen lds
    buffer_load_dwordx4 v1, s[20:23], s48 offen offset:1024 lds
    v_exp_f32 v54, v54
    v_exp_f32 v55, v55
    v_exp_f32 v56, v56
    v_smfmac_f32_16x16x64_bf16 a[108:111], v[20:23], v[88:95], v12
    v_exp_f32 v57, v57
    v_exp_f32 v58, v58
    v_smfmac_f32_32x32x32_bf16 a[80:95], v[136:139], v[48:55], v12
    s_waitcnt lgkmcnt(0)
    buffer_load_dwordx4 v1, s[20:23], s48 offen offset:2048 lds
    buffer_load_dwordx4 v1, s[20:23], s48 offen offset:3072 lds
    v_exp_f32 v59, v59
    v_exp_f32 v60, v60
    v_exp_f32 v61, v61
    v_smfmac_f32_16x16x64_bf16 a[116:119], v[20:23], v[48:55], v12
    v_exp_f32 v62, v62
    v_exp_f32 v63, v63
    v_mfma_f32_32x32x16_bf16 v[80:95], v[112:115], v[200:203], 4.0
    v_exp_f32 v64, v64
    v_exp_f32 v65, v65
    v_exp_f32 v66, v66
    v_mfma_f32_32x32x16_bf16 v[80:95], v[116:119], v[204:207], v[80:95]
    v_exp_f32 v67, v67
    v_exp_f32 v68, v68
    v_exp_f32 v69, v69
    v_smfmac_f32_32x32x32_bf16 a[80:95], v[140:143], v[56:63], v12
    s_waitcnt vmcnt(8)
    v_exp_f32 v70, v70
    v_exp_f32 v71, v71
    v_exp_f32 v72, v72
    v_smfmac_f32_16x16x64_bf16 a[116:119], v[20:23], v[56:63], v12
    ds_read_b128 v[144:147], v4 offset:16384
    v_exp_f32 v73, v73
    v_exp_f32 v74, v74
    v_smfmac_f32_32x32x32_bf16 v[208:223], v[128:131], v[64:71], v12
    v_exp_f32 v75, v75
    v_exp_f32 v76, v76
    v_exp_f32 v77, v77
    v_smfmac_f32_16x16x64_bf16 v[240:243], v[20:23], v[64:71], v12
    ds_read_b128 v[148:151], v5 offset:16384
    v_exp_f32 v78, v78
    v_exp_f32 v79, v79
    v_mfma_f32_32x32x16_bf16 v[48:63], v[112:115], a[120:123], 4.0
    v_exp_f32 v80, v80
    v_exp_f32 v81, v81
    v_exp_f32 v82, v82
    v_mfma_f32_32x32x16_bf16 v[48:63], v[116:119], a[124:127], v[48:63]
    v_exp_f32 v83, v83
    v_exp_f32 v84, v84
    v_exp_f32 v85, v85
    v_smfmac_f32_32x32x32_bf16 v[208:223], v[132:135], v[72:79], v12
    v_exp_f32 v86, v86
    v_exp_f32 v87, v87
    v_exp_f32 v88, v88
    v_smfmac_f32_16x16x64_bf16 v[240:243], v[20:23], v[72:79], v12
    ds_read_b128 v[152:155], v6 offset:16384
    v_exp_f32 v89, v89
    v_exp_f32 v90, v90
    v_smfmac_f32_32x32x32_bf16 v[224:239], v[128:131], v[80:87], v12
    v_exp_f32 v91, v91
    v_exp_f32 v92, v92
    v_exp_f32 v93, v93
    v_smfmac_f32_16x16x64_bf16 v[244:247], v[20:23], v[80:87], v12
    ds_read_b128 v[156:159], v7 offset:16384
    v_exp_f32 v94, v94
    v_exp_f32 v95, v95
    v_mfma_f32_32x32x16_bf16 v[64:79], v[112:115], a[128:131], 4.0
    v_exp_f32 v48, v48
    v_exp_f32 v49, v49
    v_exp_f32 v50, v50
    v_mfma_f32_32x32x16_bf16 v[64:79], v[116:119], a[132:135], v[64:79]
    v_exp_f32 v51, v51
    v_exp_f32 v52, v52
    v_exp_f32 v53, v53
    v_smfmac_f32_32x32x32_bf16 v[224:239], v[132:135], v[88:95], v12
    v_exp_f32 v54, v54
    v_exp_f32 v55, v55
    v_exp_f32 v56, v56
    v_smfmac_f32_16x16x64_bf16 v[244:247], v[20:23], v[88:95], v12
    ds_read_b64_tr_b16 v[136:137], v3 offset:10240
    v_exp_f32 v57, v57
    v_exp_f32 v58, v58
    v_smfmac_f32_32x32x32_bf16 a[0:15], v[128:131], v[48:55], v12
    s_waitcnt lgkmcnt(4)
    v_exp_f32 v59, v59
    v_exp_f32 v60, v60
    v_exp_f32 v61, v61
    v_smfmac_f32_16x16x64_bf16 a[96:99], v[20:23], v[48:55], v12
    ds_read_b64_tr_b16 v[138:139], v3 offset:10496
    v_exp_f32 v62, v62
    v_mfma_f32_4x4x4_16b_bf16 v[24:27], v[144:145], v[144:145], 0
    v_exp_f32 v63, v63
    v_mfma_f32_32x32x16_bf16 v[80:95], v[112:115], a[136:139], 4.0
    v_exp_f32 v64, v64
    v_exp_f32 v65, v65
    v_exp_f32 v66, v66
    v_mfma_f32_32x32x16_bf16 v[80:95], v[116:119], a[140:143], v[80:95]
    v_exp_f32 v67, v67
    v_exp_f32 v68, v68
    v_exp_f32 v69, v69
    v_smfmac_f32_32x32x32_bf16 a[0:15], v[132:135], v[56:63], v12
    v_exp_f32 v70, v70
    v_exp_f32 v71, v71
    v_exp_f32 v72, v72
    v_smfmac_f32_16x16x64_bf16 a[96:99], v[20:23], v[56:63], v12
    ds_read_b64_tr_b16 v[140:141], v3 offset:11264
    v_exp_f32 v73, v73
    v_mfma_f32_4x4x4_16b_bf16 v[24:27], v[146:147], v[146:147], v[24:27]
    v_exp_f32 v74, v74
    v_smfmac_f32_32x32x32_bf16 a[16:31], v[128:131], v[64:71], v12
    s_waitcnt lgkmcnt(5)
    v_exp_f32 v75, v75
    v_exp_f32 v76, v76
    v_exp_f32 v77, v77
    v_smfmac_f32_16x16x64_bf16 a[100:103], v[20:23], v[64:71], v12
    ds_read_b64_tr_b16 v[142:143], v3 offset:11520
    v_exp_f32 v78, v78
    v_mfma_f32_4x4x4_16b_bf16 v[24:27], v[148:149], v[148:149], v[24:27]
    v_exp_f32 v79, v79
    v_mfma_f32_32x32x16_bf16 v[48:63], v[112:115], a[144:147], 4.0
    v_exp_f32 v80, v80
    v_exp_f32 v81, v81
    v_exp_f32 v82, v82
    v_mfma_f32_32x32x16_bf16 v[48:63], v[116:119], a[148:151], v[48:63]
    v_exp_f32 v83, v83
    v_exp_f32 v84, v84
    v_exp_f32 v85, v85
    v_smfmac_f32_32x32x32_bf16 a[16:31], v[132:135], v[72:79], v12
    v_exp_f32 v86, v86
    v_exp_f32 v87, v87
    v_exp_f32 v88, v88
    v_smfmac_f32_16x16x64_bf16 a[100:103], v[20:23], v[72:79], v12
    ds_read_b64_tr_b16 v[160:161], v8 offset:16384
    v_exp_f32 v89, v89
    v_mfma_f32_4x4x4_16b_bf16 v[24:27], v[150:151], v[150:151], v[24:27]
    v_exp_f32 v90, v90
    v_smfmac_f32_32x32x32_bf16 a[32:47], v[128:131], v[80:87], v12
    s_waitcnt lgkmcnt(6)
    v_exp_f32 v91, v91
    v_exp_f32 v92, v92
    v_exp_f32 v93, v93
    v_smfmac_f32_16x16x64_bf16 a[104:107], v[20:23], v[80:87], v12
    ds_read_b64_tr_b16 v[162:163], v8 offset:16392
    v_exp_f32 v94, v94
    v_mfma_f32_4x4x4_16b_bf16 v[24:27], v[152:153], v[152:153], v[24:27]
    v_exp_f32 v95, v95
    v_mfma_f32_32x32x16_bf16 v[64:79], v[112:115], a[152:155], 4.0
    v_exp_f32 v48, v48
    v_exp_f32 v49, v49
    v_exp_f32 v50, v50
    v_mfma_f32_32x32x16_bf16 v[64:79], v[116:119], a[156:159], v[64:79]
    v_exp_f32 v51, v51
    v_exp_f32 v52, v52
    v_exp_f32 v53, v53
    v_smfmac_f32_32x32x32_bf16 a[32:47], v[132:135], v[88:95], v12
    v_exp_f32 v54, v54
    v_exp_f32 v55, v55
    v_exp_f32 v56, v56
    v_smfmac_f32_16x16x64_bf16 a[104:107], v[20:23], v[88:95], v12
    ds_read_b64_tr_b16 v[164:165], v9 offset:16384
    v_exp_f32 v57, v57
    v_mfma_f32_4x4x4_16b_bf16 v[24:27], v[154:155], v[154:155], v[24:27]
    v_exp_f32 v58, v58
    v_smfmac_f32_32x32x32_bf16 a[48:63], v[128:131], v[48:55], v12
    s_waitcnt lgkmcnt(7)
    v_exp_f32 v59, v59
    v_exp_f32 v60, v60
    v_exp_f32 v61, v61
    v_smfmac_f32_16x16x64_bf16 a[108:111], v[20:23], v[48:55], v12
    ds_read_b64_tr_b16 v[166:167], v9 offset:16392
    v_exp_f32 v62, v62
    v_mfma_f32_4x4x4_16b_bf16 v[24:27], v[156:157], v[156:157], v[24:27]
    v_exp_f32 v63, v63
    v_mfma_f32_32x32x16_bf16 v[80:95], v[112:115], a[160:163], 4.0
    v_exp_f32 v64, v64
    v_exp_f32 v65, v65
    v_exp_f32 v66, v66
    v_mfma_f32_32x32x16_bf16 v[80:95], v[116:119], a[164:167], v[80:95]
    v_exp_f32 v67, v67
    v_exp_f32 v68, v68
    v_exp_f32 v69, v69
    v_smfmac_f32_32x32x32_bf16 a[48:63], v[132:135], v[56:63], v12
    v_exp_f32 v70, v70
    v_exp_f32 v71, v71
    v_exp_f32 v72, v72
    v_smfmac_f32_16x16x64_bf16 a[108:111], v[20:23], v[56:63], v12
    ds_read_b64_tr_b16 v[168:169], v8 offset:18432
    v_exp_f32 v73, v73
    v_mfma_f32_4x4x4_16b_bf16 v[24:27], v[158:159], v[158:159], v[24:27]
    v_exp_f32 v74, v74
    v_smfmac_f32_32x32x32_bf16 a[64:79], v[128:131], v[64:71], v12
    v_exp_f32 v75, v75
    v_exp_f32 v76, v76
    v_exp_f32 v77, v77
    v_smfmac_f32_16x16x64_bf16 a[112:115], v[20:23], v[64:71], v12
    ds_read_b64_tr_b16 v[170:171], v8 offset:18440
    v_exp_f32 v78, v78
    v_exp_f32 v79, v79
    v_cndmask_b32 v28, v24, v25, s[40:41]
    v_mfma_f32_32x32x16_bf16 v[48:63], v[120:123], v[192:195], 4.0
    v_exp_f32 v80, v80
    v_exp_f32 v81, v81
    v_exp_f32 v82, v82
    v_cndmask_b32 v28, v28, v26, s[42:43]
    v_mfma_f32_32x32x16_bf16 v[48:63], v[124:127], v[196:199], v[48:63]
    s_waitcnt lgkmcnt(6)
    v_exp_f32 v83, v83
    v_exp_f32 v84, v84
    v_exp_f32 v85, v85
    v_cndmask_b32 v28, v28, v27, s[44:45]
    v_smfmac_f32_32x32x32_bf16 a[64:79], v[132:135], v[72:79], v12
    v_exp_f32 v86, v86
    v_exp_f32 v87, v87
    v_exp_f32 v88, v88
    v_sqrt_f32 v28, v28
    v_smfmac_f32_16x16x64_bf16 a[112:115], v[20:23], v[72:79], v12
    ds_read_b64_tr_b16 v[172:173], v9 offset:18432
    v_exp_f32 v89, v89
    v_exp_f32 v90, v90
    v_add_f32 v28, 0x358637bd, v28
    v_smfmac_f32_32x32x32_bf16 a[80:95], v[128:131], v[80:87], v12
    v_exp_f32 v91, v91
    v_exp_f32 v92, v92
    v_exp_f32 v93, v93
    v_rcp_f32 v28, v28
    v_smfmac_f32_16x16x64_bf16 a[116:119], v[20:23], v[80:87], v12
    ds_read_b64_tr_b16 v[174:175], v9 offset:18440
    v_exp_f32 v94, v94
    v_exp_f32 v95, v95
    v_cvt_pk_bf16_f32 v29, v28, v28
    v_cvt_pk_bf16_f32 v30, v28, v28
    v_mfma_f32_32x32x16_bf16 v[64:79], v[120:123], v[200:203], 4.0
    s_add_u32 m0, s36, 28672
    v_exp_f32 v48, v48
    v_exp_f32 v49, v49
    v_exp_f32 v50, v50
    v_permlane32_swap_b32 v29, v30
    v_mfma_f32_32x32x16_bf16 v[64:79], v[124:127], v[204:207], v[64:79]
    s_add_u32 s48, s34, 12288
    v_exp_f32 v51, v51
    v_exp_f32 v52, v52
    v_exp_f32 v53, v53
    v_and_b32 v32, v29, v10
    v_and_b32 v33, v29, v11
    v_smfmac_f32_32x32x32_bf16 a[80:95], v[132:135], v[88:95], v12
    buffer_load_dwordx4 v2, s[24:27], s48 offen lds
    buffer_load_dwordx4 v2, s[24:27], s48 offen offset:1024 lds
    v_exp_f32 v54, v54
    v_exp_f32 v55, v55
    v_exp_f32 v56, v56
    v_and_b32 v34, v30, v10
    v_and_b32 v35, v30, v11
    v_smfmac_f32_16x16x64_bf16 a[116:119], v[20:23], v[88:95], v12
    v_exp_f32 v57, v57
    v_exp_f32 v58, v58
    v_smfmac_f32_32x32x32_bf16 v[208:223], v[136:139], v[48:55], v12
    s_waitcnt lgkmcnt(4)
    buffer_load_dwordx4 v2, s[24:27], s48 offen offset:2048 lds
    buffer_load_dwordx4 v2, s[24:27], s48 offen offset:3072 lds
    v_exp_f32 v59, v59
    v_exp_f32 v60, v60
    v_exp_f32 v61, v61
    v_smfmac_f32_16x16x64_bf16 v[240:243], v[20:23], v[48:55], v12
    v_exp_f32 v62, v62
    v_mfma_f32_4x4x4_16b_bf16 v[176:179], v[160:161], v[32:33], 0
    v_exp_f32 v63, v63
    v_mfma_f32_32x32x16_bf16 v[80:95], v[120:123], a[120:123], 4.0
    v_exp_f32 v64, v64
    v_exp_f32 v65, v65
    v_exp_f32 v66, v66
    v_mfma_f32_32x32x16_bf16 v[80:95], v[124:127], a[124:127], v[80:95]
    v_exp_f32 v67, v67
    v_exp_f32 v68, v68
    v_exp_f32 v69, v69
    v_cvt_pk_bf16_f32 v96, v176, v177
    v_cvt_pk_bf16_f32 v97, v178, v179
    v_smfmac_f32_32x32x32_bf16 v[208:223], v[140:143], v[56:63], v12
    s_waitcnt vmcnt(10)
    v_exp_f32 v70, v70
    v_exp_f32 v71, v71
    v_exp_f32 v72, v72
    v_smfmac_f32_16x16x64_bf16 v[240:243], v[20:23], v[56:63], v12
    ds_read_b64_tr_b16 v[128:129], v3 offset:16384
    v_exp_f32 v73, v73
    v_mfma_f32_4x4x4_16b_bf16 v[180:183], v[162:163], v[32:33], 0
    v_exp_f32 v74, v74
    v_smfmac_f32_32x32x32_bf16 v[224:239], v[136:139], v[64:71], v12
    v_exp_f32 v75, v75
    v_exp_f32 v76, v76
    v_exp_f32 v77, v77
    v_smfmac_f32_16x16x64_bf16 v[244:247], v[20:23], v[64:71], v12
    ds_read_b64_tr_b16 v[130:131], v3 offset:16640
    v_exp_f32 v78, v78
    v_mfma_f32_4x4x4_16b_bf16 v[184:187], v[164:165], v[32:33], 0
    v_exp_f32 v79, v79
    v_cvt_pk_bf16_f32 v98, v180, v181
    v_cvt_pk_bf16_f32 v99, v182, v183
    v_mfma_f32_32x32x16_bf16 v[48:63], v[120:123], a[128:131], 4.0
    v_exp_f32 v80, v80
    v_exp_f32 v81, v81
    v_exp_f32 v82, v82
    v_mfma_f32_32x32x16_bf16 v[48:63], v[124:127], a[132:135], v[48:63]
    v_exp_f32 v83, v83
    v_exp_f32 v84, v84
    v_exp_f32 v85, v85
    v_cvt_pk_bf16_f32 v100, v184, v185
    v_cvt_pk_bf16_f32 v101, v186, v187
    v_smfmac_f32_32x32x32_bf16 v[224:239], v[140:143], v[72:79], v12
    v_exp_f32 v86, v86
    v_exp_f32 v87, v87
    v_exp_f32 v88, v88
    v_smfmac_f32_16x16x64_bf16 v[244:247], v[20:23], v[72:79], v12
    ds_read_b64_tr_b16 v[132:133], v3 offset:17408
    v_exp_f32 v89, v89
    v_mfma_f32_4x4x4_16b_bf16 v[188:191], v[166:167], v[32:33], 0
    v_exp_f32 v90, v90
    v_smfmac_f32_32x32x32_bf16 a[0:15], v[136:139], v[80:87], v12
    s_waitcnt lgkmcnt(3)
    v_exp_f32 v91, v91
    v_exp_f32 v92, v92
    v_exp_f32 v93, v93
    v_smfmac_f32_16x16x64_bf16 a[96:99], v[20:23], v[80:87], v12
    ds_read_b64_tr_b16 v[134:135], v3 offset:17664
    v_exp_f32 v94, v94
    v_mfma_f32_4x4x4_16b_bf16 v[176:179], v[168:169], v[34:35], 0
    v_exp_f32 v95, v95
    v_cvt_pk_bf16_f32 v102, v188, v189
    v_cvt_pk_bf16_f32 v103, v190, v191
    v_mfma_f32_32x32x16_bf16 v[64:79], v[120:123], a[136:139], 4.0
    s_add_u32 m0, s36, 0
    v_exp_f32 v48, v48
    v_exp_f32 v49, v49
    v_exp_f32 v50, v50
    v_mfma_f32_32x32x16_bf16 v[64:79], v[124:127], a[140:143], v[64:79]
    s_add_u32 s48, s34, 16384
    v_exp_f32 v51, v51
    v_exp_f32 v52, v52
    v_exp_f32 v53, v53
    v_cvt_pk_bf16_f32 v104, v176, v177
    v_cvt_pk_bf16_f32 v105, v178, v179
    v_smfmac_f32_32x32x32_bf16 a[0:15], v[140:143], v[88:95], v12
    v_exp_f32 v54, v54
    v_exp_f32 v55, v55
    v_exp_f32 v56, v56
    v_smfmac_f32_16x16x64_bf16 a[96:99], v[20:23], v[88:95], v12
    buffer_load_dwordx4 v1, s[20:23], s48 offen lds
    v_exp_f32 v57, v57
    v_mfma_f32_4x4x4_16b_bf16 v[180:183], v[170:171], v[34:35], 0
    v_exp_f32 v58, v58
    v_smfmac_f32_32x32x32_bf16 a[16:31], v[136:139], v[48:55], v12
    v_exp_f32 v59, v59
    v_exp_f32 v60, v60
    v_exp_f32 v61, v61
    v_smfmac_f32_16x16x64_bf16 a[100:103], v[20:23], v[48:55], v12
    buffer_load_dwordx4 v1, s[20:23], s48 offen offset:1024 lds
    v_exp_f32 v62, v62
    v_mfma_f32_4x4x4_16b_bf16 v[184:187], v[172:173], v[34:35], 0
    v_exp_f32 v63, v63
    v_cvt_pk_bf16_f32 v106, v180, v181
    v_cvt_pk_bf16_f32 v107, v182, v183
    v_mfma_f32_32x32x16_bf16 v[80:95], v[120:123], a[144:147], 4.0
    v_exp_f32 v64, v64
    v_exp_f32 v65, v65
    v_exp_f32 v66, v66
    v_mfma_f32_32x32x16_bf16 v[80:95], v[124:127], a[148:151], v[80:95]
    v_exp_f32 v67, v67
    v_exp_f32 v68, v68
    v_exp_f32 v69, v69
    v_cvt_pk_bf16_f32 v108, v184, v185
    v_cvt_pk_bf16_f32 v109, v186, v187
    v_smfmac_f32_32x32x32_bf16 a[16:31], v[140:143], v[56:63], v12
    v_exp_f32 v70, v70
    v_exp_f32 v71, v71
    v_exp_f32 v72, v72
    v_smfmac_f32_16x16x64_bf16 a[100:103], v[20:23], v[56:63], v12
    buffer_load_dwordx4 v1, s[20:23], s48 offen offset:2048 lds
    v_exp_f32 v73, v73
    v_mfma_f32_4x4x4_16b_bf16 v[188:191], v[174:175], v[34:35], 0
    v_exp_f32 v74, v74
    v_smfmac_f32_32x32x32_bf16 a[32:47], v[136:139], v[64:71], v12
    v_exp_f32 v75, v75
    v_exp_f32 v76, v76
    v_exp_f32 v77, v77
    v_smfmac_f32_16x16x64_bf16 a[104:107], v[20:23], v[64:71], v12
    buffer_load_dwordx4 v1, s[20:23], s48 offen offset:3072 lds
    v_exp_f32 v78, v78
    v_exp_f32 v79, v79
    v_cvt_pk_bf16_f32 v110, v188, v189
    v_cvt_pk_bf16_f32 v111, v190, v191
    v_mfma_f32_32x32x16_bf16 v[48:63], v[120:123], a[152:155], 4.0
    s_add_u32 m0, s36, 4096
    v_exp_f32 v80, v80
    v_exp_f32 v81, v81
    v_exp_f32 v82, v82
    v_mfma_f32_32x32x16_bf16 v[48:63], v[124:127], a[156:159], v[48:63]
    s_add_u32 s48, s34, 16384
    v_exp_f32 v83, v83
    v_exp_f32 v84, v84
    v_exp_f32 v85, v85
    v_smfmac_f32_32x32x32_bf16 a[32:47], v[140:143], v[72:79], v12
    v_exp_f32 v86, v86
    v_exp_f32 v87, v87
    v_exp_f32 v88, v88
    v_smfmac_f32_16x16x64_bf16 a[104:107], v[20:23], v[72:79], v12
    buffer_load_dwordx4 v2, s[24:27], s48 offen lds
    v_exp_f32 v89, v89
    v_exp_f32 v90, v90
    v_smfmac_f32_32x32x32_bf16 a[48:63], v[136:139], v[80:87], v12
    v_exp_f32 v91, v91
    v_exp_f32 v92, v92
    v_exp_f32 v93, v93
    v_smfmac_f32_16x16x64_bf16 a[108:111], v[20:23], v[80:87], v12
    buffer_load_dwordx4 v2, s[24:27], s48 offen offset:1024 lds
    v_exp_f32 v94, v94
    v_exp_f32 v95, v95
    v_mfma_f32_32x32x16_bf16 v[64:79], v[120:123], a[160:163], 4.0
    v_exp_f32 v48, v48
    v_exp_f32 v49, v49
    v_exp_f32 v50, v50
    v_mfma_f32_32x32x16_bf16 v[64:79], v[124:127], a[164:167], v[64:79]
    v_exp_f32 v51, v51
    v_exp_f32 v52, v52
    v_exp_f32 v53, v53
    v_smfmac_f32_32x32x32_bf16 a[48:63], v[140:143], v[88:95], v12
    v_exp_f32 v54, v54
    v_exp_f32 v55, v55
    v_exp_f32 v56, v56
    v_smfmac_f32_16x16x64_bf16 a[108:111], v[20:23], v[88:95], v12
    buffer_load_dwordx4 v2, s[24:27], s48 offen offset:2048 lds
    v_exp_f32 v57, v57
    v_exp_f32 v58, v58
    v_smfmac_f32_32x32x32_bf16 a[64:79], v[136:139], v[48:55], v12
    v_exp_f32 v59, v59
    v_exp_f32 v60, v60
    v_exp_f32 v61, v61
    v_smfmac_f32_16x16x64_bf16 a[112:115], v[20:23], v[48:55], v12
    buffer_load_dwordx4 v2, s[24:27], s48 offen offset:3072 lds
    v_exp_f32 v62, v62
    v_exp_f32 v63, v63
    v_mfma_f32_32x32x16_bf16 v[80:95], v[96:99], v[192:195], 4.0
    v_exp_f32 v64, v64
    v_exp_f32 v65, v65
    v_exp_f32 v66, v66
    v_mfma_f32_32x32x16_bf16 v[80:95], v[100:103], v[196:199], v[80:95]
    v_exp_f32 v67, v67
    v_exp_f32 v68, v68
    v_exp_f32 v69, v69
    v_smfmac_f32_32x32x32_bf16 a[64:79], v[140:143], v[56:63], v12
    v_exp_f32 v70, v70
    v_exp_f32 v71, v71
    v_exp_f32 v72, v72
    v_smfmac_f32_16x16x64_bf16 a[112:115], v[20:23], v[56:63], v12
    v_exp_f32 v73, v73
    v_exp_f32 v74, v74
    v_smfmac_f32_32x32x32_bf16 a[80:95], v[136:139], v[64:71], v12
    s_waitcnt lgkmcnt(0)
    v_exp_f32 v75, v75
    v_exp_f32 v76, v76
    v_exp_f32 v77, v77
    v_smfmac_f32_16x16x64_bf16 a[116:119], v[20:23], v[64:71], v12
    v_exp_f32 v78, v78
    v_exp_f32 v79, v79
    v_mfma_f32_32x32x16_bf16 v[48:63], v[96:99], v[200:203], 4.0
    v_exp_f32 v80, v80
    v_exp_f32 v81, v81
    v_exp_f32 v82, v82
    v_mfma_f32_32x32x16_bf16 v[48:63], v[100:103], v[204:207], v[48:63]
    v_exp_f32 v83, v83
    v_exp_f32 v84, v84
    v_exp_f32 v85, v85
    v_smfmac_f32_32x32x32_bf16 a[80:95], v[140:143], v[72:79], v12
    s_waitcnt vmcnt(12)
    v_exp_f32 v86, v86
    v_exp_f32 v87, v87
    v_exp_f32 v88, v88
    v_smfmac_f32_16x16x64_bf16 a[116:119], v[20:23], v[72:79], v12
    ds_read_b128 v[144:147], v4 offset:24576
    v_exp_f32 v89, v89
    v_exp_f32 v90, v90
    v_smfmac_f32_32x32x32_bf16 v[208:223], v[128:131], v[80:87], v12
L_t1:
    s_cbranch_vccnz L_ret
    v_exp_f32 v91, v91
    v_exp_f32 v92, v92
    v_exp_f32 v93, v93
    v_smfmac_f32_16x16x64_bf16 v[240:243], v[20:23], v[80:87], v12
    ds_read_b128 v[148:151], v5 offset:24576
    v_exp_f32 v94, v94
    v_exp_f32 v95, v95
    v_mfma_f32_32x32x16_bf16 v[64:79], v[96:99], a[120:123], 4.0
    v_exp_f32 v48, v48
    v_exp_f32 v49, v49
    v_exp_f32 v50, v50
    v_mfma_f32_32x32x16_bf16 v[64:79], v[100:103], a[124:127], v[64:79]
    v_exp_f32 v51, v51
    v_exp_f32 v52, v52
    v_exp_f32 v53, v53
    v_smfmac_f32_32x32x32_bf16 v[208:223], v[132:135], v[88:95], v12
    v_exp_f32 v54, v54
    v_exp_f32 v55, v55
    v_exp_f32 v56, v56
    v_smfmac_f32_16x16x64_bf16 v[240:243], v[20:23], v[88:95], v12
    ds_read_b128 v[152:155], v6 offset:24576
    v_exp_f32 v57, v57
    v_exp_f32 v58, v58
    v_smfmac_f32_32x32x32_bf16 v[224:239], v[128:131], v[48:55], v12
    v_exp_f32 v59, v59
    v_exp_f32 v60, v60
    v_exp_f32 v61, v61
    v_smfmac_f32_16x16x64_bf16 v[244:247], v[20:23], v[48:55], v12
    ds_read_b128 v[156:159], v7 offset:24576
    v_exp_f32 v62, v62
    v_exp_f32 v63, v63
    v_mfma_f32_32x32x16_bf16 v[80:95], v[96:99], a[128:131], 4.0
    v_exp_f32 v64, v64
    v_exp_f32 v65, v65
    v_exp_f32 v66, v66
    v_mfma_f32_32x32x16_bf16 v[80:95], v[100:103], a[132:135], v[80:95]
    v_exp_f32 v67, v67
    v_exp_f32 v68, v68
    v_exp_f32 v69, v69
    v_smfmac_f32_32x32x32_bf16 v[224:239], v[132:135], v[56:63], v12
    v_exp_f32 v70, v70
    v_exp_f32 v71, v71
    v_exp_f32 v72, v72
    v_smfmac_f32_16x16x64_bf16 v[244:247], v[20:23], v[56:63], v12
    ds_read_b64_tr_b16 v[136:137], v3 offset:18432
    v_exp_f32 v73, v73
    v_exp_f32 v74, v74
    v_smfmac_f32_32x32x32_bf16 a[0:15], v[128:131], v[64:71], v12
    s_waitcnt lgkmcnt(4)
    v_exp_f32 v75, v75
    v_exp_f32 v76, v76
    v_exp_f32 v77, v77
    v_smfmac_f32_16x16x64_bf16 a[96:99], v[20:23], v[64:71], v12
    ds_read_b64_tr_b16 v[138:139], v3 offset:18688
    v_exp_f32 v78, v78
    v_mfma_f32_4x4x4_16b_bf16 v[24:27], v[144:145], v[144:145], 0
    v_exp_f32 v79, v79
    v_mfma_f32_32x32x16_bf16 v[48:63], v[96:99], a[136:139], 4.0
    v_exp_f32 v80, v80
    v_exp_f32 v81, v81
    v_exp_f32 v82, v82
    v_mfma_f32_32x32x16_bf16 v[48:63], v[100:103], a[140:143], v[48:63]
    v_exp_f32 v83, v83
    v_exp_f32 v84, v84
    v_exp_f32 v85, v85
    v_smfmac_f32_32x32x32_bf16 a[0:15], v[132:135], v[72:79], v12
    v_exp_f32 v86, v86
    v_exp_f32 v87, v87
    v_exp_f32 v88, v88
    v_smfmac_f32_16x16x64_bf16 a[96:99], v[20:23], v[72:79], v12
    ds_read_b64_tr_b16 v[140:141], v3 offset:19456
    v_exp_f32 v89, v89
    v_mfma_f32_4x4x4_16b_bf16 v[24:27], v[146:147], v[146:147], v[24:27]
    v_exp_f32 v90, v90
    v_smfmac_f32_32x32x32_bf16 a[16:31], v[128:131], v[80:87], v12
    s_waitcnt lgkmcnt(5)
    v_exp_f32 v91, v91
    v_exp_f32 v92, v92
    v_exp_f32 v93, v93
    v_smfmac_f32_16x16x64_bf16 a[100:103], v[20:23], v[80:87], v12
    ds_read_b64_tr_b16 v[142:143], v3 offset:19712
    v_exp_f32 v94, v94
    v_mfma_f32_4x4x4_16b_bf16 v[24:27], v[148:149], v[148:149], v[24:27]
    v_exp_f32 v95, v95
    v_mfma_f32_32x32x16_bf16 v[64:79], v[96:99], a[144:147], 4.0
    v_exp_f32 v48, v48
    v_exp_f32 v49, v49
    v_exp_f32 v50, v50
    v_mfma_f32_32x32x16_bf16 v[64:79], v[100:103], a[148:151], v[64:79]
    v_exp_f32 v51, v51
    v_exp_f32 v52, v52
    v_exp_f32 v53, v53
    v_smfmac_f32_32x32x32_bf16 a[16:31], v[132:135], v[88:95], v12
    v_exp_f32 v54, v54
    v_exp_f32 v55, v55
    v_exp_f32 v56, v56
    v_smfmac_f32_16x16x64_bf16 a[100:103], v[20:23], v[88:95], v12
    ds_read_b64_tr_b16 v[160:161], v8 offset:24576
    v_exp_f32 v57, v57
    v_mfma_f32_4x4x4_16b_bf16 v[24:27], v[150:151], v[150:151], v[24:27]
    v_exp_f32 v58, v58
    v_smfmac_f32_32x32x32_bf16 a[32:47], v[128:131], v[48:55], v12
    s_waitcnt lgkmcnt(6)
    v_exp_f32 v59, v59
    v_exp_f32 v60, v60
    v_exp_f32 v61, v61
    v_smfmac_f32_16x16x64_bf16 a[104:107], v[20:23], v[48:55], v12
    ds_read_b64_tr_b16 v[162:163], v8 offset:24584
    v_exp_f32 v62, v62
    v_mfma_f32_4x4x4_16b_bf16 v[24:27], v[152:153], v[152:153], v[24:27]
    v_exp_f32 v63, v63
    v_mfma_f32_32x32x16_bf16 v[80:95], v[96:99], a[152:155], 4.0
    v_exp_f32 v64, v64
    v_exp_f32 v65, v65
    v_exp_f32 v66, v66
    v_mfma_f32_32x32x16_bf16 v[80:95], v[100:103], a[156:159], v[80:95]
    v_exp_f32 v67, v67
    v_exp_f32 v68, v68
    v_exp_f32 v69, v69
    v_smfmac_f32_32x32x32_bf16 a[32:47], v[132:135], v[56:63], v12
    v_exp_f32 v70, v70
    v_exp_f32 v71, v71
    v_exp_f32 v72, v72
    v_smfmac_f32_16x16x64_bf16 a[104:107], v[20:23], v[56:63], v12
    ds_read_b64_tr_b16 v[164:165], v9 offset:24576
    v_exp_f32 v73, v73
    v_mfma_f32_4x4x4_16b_bf16 v[24:27], v[154:155], v[154:155], v[24:27]
    v_exp_f32 v74, v74
    v_smfmac_f32_32x32x32_bf16 a[48:63], v[128:131], v[64:71], v12
    s_waitcnt lgkmcnt(7)
    v_exp_f32 v75, v75
    v_exp_f32 v76, v76
    v_exp_f32 v77, v77
    v_smfmac_f32_16x16x64_bf16 a[108:111], v[20:23], v[64:71], v12
    ds_read_b64_tr_b16 v[166:167], v9 offset:24584
    v_exp_f32 v78, v78
    v_mfma_f32_4x4x4_16b_bf16 v[24:27], v[156:157], v[156:157], v[24:27]
    v_exp_f32 v79, v79
    v_mfma_f32_32x32x16_bf16 v[48:63], v[96:99], a[160:163], 4.0
    v_exp_f32 v80, v80
    v_exp_f32 v81, v81
    v_exp_f32 v82, v82
    v_mfma_f32_32x32x16_bf16 v[48:63], v[100:103], a[164:167], v[48:63]
    v_exp_f32 v83, v83
    v_exp_f32 v84, v84
    v_exp_f32 v85, v85
    v_smfmac_f32_32x32x32_bf16 a[48:63], v[132:135], v[72:79], v12
    v_exp_f32 v86, v86
    v_exp_f32 v87, v87
    v_exp_f32 v88, v88
    v_smfmac_f32_16x16x64_bf16 a[108:111], v[20:23], v[72:79], v12
    ds_read_b64_tr_b16 v[168:169], v8 offset:26624
    v_exp_f32 v89, v89
    v_mfma_f32_4x4x4_16b_bf16 v[24:27], v[158:159], v[158:159], v[24:27]
    v_exp_f32 v90, v90
    v_smfmac_f32_32x32x32_bf16 a[64:79], v[128:131], v[80:87], v12
    v_exp_f32 v91, v91
    v_exp_f32 v92, v92
    v_exp_f32 v93, v93
    v_smfmac_f32_16x16x64_bf16 a[112:115], v[20:23], v[80:87], v12
    ds_read_b64_tr_b16 v[170:171], v8 offset:26632
    v_exp_f32 v94, v94
    v_exp_f32 v95, v95
    v_cndmask_b32 v28, v24, v25, s[40:41]
    v_mfma_f32_32x32x16_bf16 v[64:79], v[104:107], v[192:195], 4.0
    v_exp_f32 v48, v48
    v_exp_f32 v49, v49
    v_exp_f32 v50, v50
    v_cndmask_b32 v28, v28, v26, s[42:43]
    v_mfma_f32_32x32x16_bf16 v[64:79], v[108:111], v[196:199], v[64:79]
    s_waitcnt lgkmcnt(6)
    v_exp_f32 v51, v51
    v_exp_f32 v52, v52
    v_exp_f32 v53, v53
    v_cndmask_b32 v28, v28, v27, s[44:45]
    v_smfmac_f32_32x32x32_bf16 a[64:79], v[132:135], v[88:95], v12
    v_exp_f32 v54, v54
    v_exp_f32 v55, v55
    v_exp_f32 v56, v56
    v_sqrt_f32 v28, v28
    v_smfmac_f32_16x16x64_bf16 a[112:115], v[20:23], v[88:95], v12
    ds_read_b64_tr_b16 v[172:173], v9 offset:26624
    v_exp_f32 v57, v57
    v_exp_f32 v58, v58
    v_add_f32 v28, 0x358637bd, v28
    v_smfmac_f32_32x32x32_bf16 a[80:95], v[128:131], v[48:55], v12
    v_exp_f32 v59, v59
    v_exp_f32 v60, v60
    v_exp_f32 v61, v61
    v_rcp_f32 v28, v28
    v_smfmac_f32_16x16x64_bf16 a[116:119], v[20:23], v[48:55], v12
    ds_read_b64_tr_b16 v[174:175], v9 offset:26632
    v_exp_f32 v62, v62
    v_exp_f32 v63, v63
    v_cvt_pk_bf16_f32 v29, v28, v28
    v_cvt_pk_bf16_f32 v30, v28, v28
    v_mfma_f32_32x32x16_bf16 v[80:95], v[104:107], v[200:203], 4.0
    v_exp_f32 v64, v64
    v_exp_f32 v65, v65
    v_exp_f32 v66, v66
    v_permlane32_swap_b32 v29, v30
    v_mfma_f32_32x32x16_bf16 v[80:95], v[108:111], v[204:207], v[80:95]
    v_exp_f32 v67, v67
    v_exp_f32 v68, v68
    v_exp_f32 v69, v69
    v_and_b32 v32, v29, v10
    v_and_b32 v33, v29, v11
    v_smfmac_f32_32x32x32_bf16 a[80:95], v[132:135], v[56:63], v12
    v_exp_f32 v70, v70
    v_exp_f32 v71, v71
    v_exp_f32 v72, v72
    v_and_b32 v34, v30, v10
    v_and_b32 v35, v30, v11
    v_smfmac_f32_16x16x64_bf16 a[116:119], v[20:23], v[56:63], v12
    v_exp_f32 v73, v73
    v_exp_f32 v74, v74
    v_smfmac_f32_32x32x32_bf16 v[208:223], v[136:139], v[64:71], v12
    s_waitcnt lgkmcnt(4)
    v_exp_f32 v75, v75
    v_exp_f32 v76, v76
    v_exp_f32 v77, v77
    v_smfmac_f32_16x16x64_bf16 v[240:243], v[20:23], v[64:71], v12
    v_exp_f32 v78, v78
    v_mfma_f32_4x4x4_16b_bf16 v[176:179], v[160:161], v[32:33], 0
    v_exp_f32 v79, v79
    v_mfma_f32_32x32x16_bf16 v[48:63], v[104:107], a[120:123], 4.0
    v_exp_f32 v80, v80
    v_exp_f32 v81, v81
    v_exp_f32 v82, v82
    v_mfma_f32_32x32x16_bf16 v[48:63], v[108:111], a[124:127], v[48:63]
    v_exp_f32 v83, v83
    v_exp_f32 v84, v84
    v_exp_f32 v85, v85
    v_cvt_pk_bf16_f32 v112, v176, v177
    v_cvt_pk_bf16_f32 v113, v178, v179
    v_smfmac_f32_32x32x32_bf16 v[208:223], v[140:143], v[72:79], v12
    s_waitcnt vmcnt(10)
    v_exp_f32 v86, v86
    v_exp_f32 v87, v87
    v_exp_f32 v88, v88
    v_smfmac_f32_16x16x64_bf16 v[240:243], v[20:23], v[72:79], v12
    ds_read_b64_tr_b16 v[128:129], v3 offset:24576
    v_exp_f32 v89, v89
    v_mfma_f32_4x4x4_16b_bf16 v[180:183], v[162:163], v[32:33], 0
    v_exp_f32 v90, v90
    v_smfmac_f32_32x32x32_bf16 v[224:239], v[136:139], v[80:87], v12
    v_exp_f32 v91, v91
    v_exp_f32 v92, v92
    v_exp_f32 v93, v93
    v_smfmac_f32_16x16x64_bf16 v[244:247], v[20:23], v[80:87], v12
    ds_read_b64_tr_b16 v[130:131], v3 offset:24832
    v_exp_f32 v94, v94
    v_mfma_f32_4x4x4_16b_bf16 v[184:187], v[164:165], v[32:33], 0
    v_exp_f32 v95, v95
    v_cvt_pk_bf16_f32 v114, v180, v181
    v_cvt_pk_bf16_f32 v115, v182, v183
    v_mfma_f32_32x32x16_bf16 v[64:79], v[104:107], a[128:131], 4.0
    v_exp_f32 v48, v48
    v_exp_f32 v49, v49
    v_exp_f32 v50, v50
    v_mfma_f32_32x32x16_bf16 v[64:79], v[108:111], a[132:135], v[64:79]
    v_exp_f32 v51, v51
    v_exp_f32 v52, v52
    v_exp_f32 v53, v53
    v_cvt_pk_bf16_f32 v116, v184, v185
    v_cvt_pk_bf16_f32 v117, v186, v187
    v_smfmac_f32_32x32x32_bf16 v[224:239], v[140:143], v[88:95], v12
    v_exp_f32 v54, v54
    v_exp_f32 v55, v55
    v_exp_f32 v56, v56
    v_smfmac_f32_16x16x64_bf16 v[244:247], v[20:23], v[88:95], v12
    ds_read_b64_tr_b16 v[132:133], v3 offset:25600
    v_exp_f32 v57, v57
    v_mfma_f32_4x4x4_16b_bf16 v[188:191], v[166:167], v[32:33], 0
    v_exp_f32 v58, v58
    v_smfmac_f32_32x32x32_bf16 a[0:15], v[136:139], v[48:55], v12
    s_waitcnt lgkmcnt(3)
    v_exp_f32 v59, v59
    v_exp_f32 v60, v60
    v_exp_f32 v61, v61
    v_smfmac_f32_16x16x64_bf16 a[96:99], v[20:23], v[48:55], v12
    ds_read_b64_tr_b16 v[134:135], v3 offset:25856
    v_exp_f32 v62, v62
    v_mfma_f32_4x4x4_16b_bf16 v[176:179], v[168:169], v[34:35], 0
    v_exp_f32 v63, v63
    v_cvt_pk_bf16_f32 v118, v188, v189
    v_cvt_pk_bf16_f32 v119, v190, v191
    v_mfma_f32_32x32x16_bf16 v[80:95], v[104:107], a[136:139], 4.0
    s_add_u32 m0, s36, 8192
    v_exp_f32 v64, v64
    v_exp_f32 v65, v65
    v_exp_f32 v66, v66
    v_mfma_f32_32x32x16_bf16 v[80:95], v[108:111], a[140:143], v[80:95]
    s_add_u32 s48, s34, 20480
    v_exp_f32 v67, v67
    v_exp_f32 v68, v68
    v_exp_f32 v69, v69
    v_cvt_pk_bf16_f32 v120, v176, v177
    v_cvt_pk_bf16_f32 v121, v178, v179
    v_smfmac_f32_32x32x32_bf16 a[0:15], v[140:143], v[56:63], v12
    v_exp_f32 v70, v70
    v_exp_f32 v71, v71
    v_exp_f32 v72, v72
    v_smfmac_f32_16x16x64_bf16 a[96:99], v[20:23], v[56:63], v12
    buffer_load_dwordx4 v1, s[20:23], s48 offen lds
    v_exp_f32 v73, v73
    v_mfma_f32_4x4x4_16b_bf16 v[180:183], v[170:171], v[34:35], 0
    v_exp_f32 v74, v74
    v_smfmac_f32_32x32x32_bf16 a[16:31], v[136:139], v[64:71], v12
    v_exp_f32 v75, v75
    v_exp_f32 v76, v76
    v_exp_f32 v77, v77
    v_smfmac_f32_16x16x64_bf16 a[100:103], v[20:23], v[64:71], v12
    buffer_load_dwordx4 v1, s[20:23], s48 offen offset:1024 lds
    v_exp_f32 v78, v78
    v_mfma_f32_4x4x4_16b_bf16 v[184:187], v[172:173], v[34:35], 0
    v_exp_f32 v79, v79
    v_cvt_pk_bf16_f32 v122, v180, v181
    v_cvt_pk_bf16_f32 v123, v182, v183
    v_mfma_f32_32x32x16_bf16 v[48:63], v[104:107], a[144:147], 4.0
    v_exp_f32 v80, v80
    v_exp_f32 v81, v81
    v_exp_f32 v82, v82
    v_mfma_f32_32x32x16_bf16 v[48:63], v[108:111], a[148:151], v[48:63]
    v_exp_f32 v83, v83
    v_exp_f32 v84, v84
    v_exp_f32 v85, v85
    v_cvt_pk_bf16_f32 v124, v184, v185
    v_cvt_pk_bf16_f32 v125, v186, v187
    v_smfmac_f32_32x32x32_bf16 a[16:31], v[140:143], v[72:79], v12
    v_exp_f32 v86, v86
    v_exp_f32 v87, v87
    v_exp_f32 v88, v88
    v_smfmac_f32_16x16x64_bf16 a[100:103], v[20:23], v[72:79], v12
    buffer_load_dwordx4 v1, s[20:23], s48 offen offset:2048 lds
    v_exp_f32 v89, v89
    v_mfma_f32_4x4x4_16b_bf16 v[188:191], v[174:175], v[34:35], 0
    v_exp_f32 v90, v90
    v_smfmac_f32_32x32x32_bf16 a[32:47], v[136:139], v[80:87], v12
    v_exp_f32 v91, v91
    v_exp_f32 v92, v92
    v_exp_f32 v93, v93
    v_smfmac_f32_16x16x64_bf16 a[104:107], v[20:23], v[80:87], v12
    buffer_load_dwordx4 v1, s[20:23], s48 offen offset:3072 lds
    v_exp_f32 v94, v94
    v_exp_f32 v95, v95
    v_cvt_pk_bf16_f32 v126, v188, v189
    v_cvt_pk_bf16_f32 v127, v190, v191
    v_mfma_f32_32x32x16_bf16 v[64:79], v[104:107], a[152:155], 4.0
    s_add_u32 m0, s36, 12288
    v_exp_f32 v48, v48
    v_exp_f32 v49, v49
    v_exp_f32 v50, v50
    v_mfma_f32_32x32x16_bf16 v[64:79], v[108:111], a[156:159], v[64:79]
    s_add_u32 s48, s34, 20480
    v_exp_f32 v51, v51
    v_exp_f32 v52, v52
    v_exp_f32 v53, v53
    v_smfmac_f32_32x32x32_bf16 a[32:47], v[140:143], v[88:95], v12
    v_exp_f32 v54, v54
    v_exp_f32 v55, v55
    v_exp_f32 v56, v56
    v_smfmac_f32_16x16x64_bf16 a[104:107], v[20:23], v[88:95], v12
    buffer_load_dwordx4 v2, s[24:27], s48 offen lds
    v_exp_f32 v57, v57
    v_exp_f32 v58, v58
    v_smfmac_f32_32x32x32_bf16 a[48:63], v[136:139], v[48:55], v12
    v_exp_f32 v59, v59
    v_exp_f32 v60, v60
    v_exp_f32 v61, v61
    v_smfmac_f32_16x16x64_bf16 a[108:111], v[20:23], v[48:55], v12
    buffer_load_dwordx4 v2, s[24:27], s48 offen offset:1024 lds
    v_exp_f32 v62, v62
    v_exp_f32 v63, v63
    v_mfma_f32_32x32x16_bf16 v[80:95], v[104:107], a[160:163], 4.0
    v_exp_f32 v64, v64
    v_exp_f32 v65, v65
    v_exp_f32 v66, v66
    v_mfma_f32_32x32x16_bf16 v[80:95], v[108:111], a[164:167], v[80:95]
    v_exp_f32 v67, v67
    v_exp_f32 v68, v68
    v_exp_f32 v69, v69
    v_smfmac_f32_32x32x32_bf16 a[48:63], v[140:143], v[56:63], v12
    v_exp_f32 v70, v70
    v_exp_f32 v71, v71
    v_exp_f32 v72, v72
    v_smfmac_f32_16x16x64_bf16 a[108:111], v[20:23], v[56:63], v12
    buffer_load_dwordx4 v2, s[24:27], s48 offen offset:2048 lds
    v_exp_f32 v73, v73
    v_exp_f32 v74, v74
    v_smfmac_f32_32x32x32_bf16 a[64:79], v[136:139], v[64:71], v12
    v_exp_f32 v75, v75
    v_exp_f32 v76, v76
    v_exp_f32 v77, v77
    v_smfmac_f32_16x16x64_bf16 a[112:115], v[20:23], v[64:71], v12
    buffer_load_dwordx4 v2, s[24:27], s48 offen offset:3072 lds
    v_exp_f32 v78, v78
    v_exp_f32 v79, v79
    v_mfma_f32_32x32x16_bf16 v[48:63], v[112:115], v[192:195], 4.0
    v_exp_f32 v80, v80
    v_exp_f32 v81, v81
    v_exp_f32 v82, v82
    v_mfma_f32_32x32x16_bf16 v[48:63], v[116:119], v[196:199], v[48:63]
    v_exp_f32 v83, v83
    v_exp_f32 v84, v84
    v_exp_f32 v85, v85
    v_smfmac_f32_32x32x32_bf16 a[64:79], v[140:143], v[72:79], v12
    v_exp_f32 v86, v86
    v_exp_f32 v87, v87
    v_exp_f32 v88, v88
    v_smfmac_f32_16x16x64_bf16 a[112:115], v[20:23], v[72:79], v12
    v_exp_f32 v89, v89
    v_exp_f32 v90, v90
    v_smfmac_f32_32x32x32_bf16 a[80:95], v[136:139], v[80:87], v12
    s_waitcnt lgkmcnt(0)
    v_exp_f32 v91, v91
    v_exp_f32 v92, v92
    v_exp_f32 v93, v93
    v_smfmac_f32_16x16x64_bf16 a[116:119], v[20:23], v[80:87], v12
    v_exp_f32 v94, v94
    v_exp_f32 v95, v95
    v_mfma_f32_32x32x16_bf16 v[64:79], v[112:115], v[200:203], 4.0
    v_exp_f32 v48, v48
    v_exp_f32 v49, v49
    v_exp_f32 v50, v50
    v_mfma_f32_32x32x16_bf16 v[64:79], v[116:119], v[204:207], v[64:79]
    v_exp_f32 v51, v51
    v_exp_f32 v52, v52
    v_exp_f32 v53, v53
    v_smfmac_f32_32x32x32_bf16 a[80:95], v[140:143], v[88:95], v12
    s_waitcnt vmcnt(12)
    v_exp_f32 v54, v54
    v_exp_f32 v55, v55
    v_exp_f32 v56, v56
    v_smfmac_f32_16x16x64_bf16 a[116:119], v[20:23], v[88:95], v12
    ds_read_b128 v[144:147], v4
    v_exp_f32 v57, v57
    v_exp_f32 v58, v58
    v_smfmac_f32_32x32x32_bf16 v[208:223], v[128:131], v[48:55], v12
    v_exp_f32 v59, v59
    v_exp_f32 v60, v60
    v_exp_f32 v61, v61
    v_smfmac_f32_16x16x64_bf16 v[240:243], v[20:23], v[48:55], v12
    ds_read_b128 v[148:151], v5
    v_exp_f32 v62, v62
    v_exp_f32 v63, v63
    v_mfma_f32_32x32x16_bf16 v[80:95], v[112:115], a[120:123], 4.0
    v_exp_f32 v64, v64
    v_exp_f32 v65, v65
    v_exp_f32 v66, v66
    v_mfma_f32_32x32x16_bf16 v[80:95], v[116:119], a[124:127], v[80:95]
    v_exp_f32 v67, v67
    v_exp_f32 v68, v68
    v_exp_f32 v69, v69
    v_smfmac_f32_32x32x32_bf16 v[208:223], v[132:135], v[56:63], v12
    v_exp_f32 v70, v70
    v_exp_f32 v71, v71
    v_exp_f32 v72, v72
    v_smfmac_f32_16x16x64_bf16 v[240:243], v[20:23], v[56:63], v12
    ds_read_b128 v[152:155], v6
    v_exp_f32 v73, v73
    v_exp_f32 v74, v74
    v_smfmac_f32_32x32x32_bf16 v[224:239], v[128:131], v[64:71], v12
    v_exp_f32 v75, v75
    v_exp_f32 v76, v76
    v_exp_f32 v77, v77
    v_smfmac_f32_16x16x64_bf16 v[244:247], v[20:23], v[64:71], v12
    ds_read_b128 v[156:159], v7
    v_exp_f32 v78, v78
    v_exp_f32 v79, v79
    v_mfma_f32_32x32x16_bf16 v[48:63], v[112:115], a[128:131], 4.0
    v_exp_f32 v80, v80
    v_exp_f32 v81, v81
    v_exp_f32 v82, v82
    v_mfma_f32_32x32x16_bf16 v[48:63], v[116:119], a[132:135], v[48:63]
    v_exp_f32 v83, v83
    v_exp_f32 v84, v84
    v_exp_f32 v85, v85
    v_smfmac_f32_32x32x32_bf16 v[224:239], v[132:135], v[72:79], v12
    v_exp_f32 v86, v86
    v_exp_f32 v87, v87
    v_exp_f32 v88, v88
    v_smfmac_f32_16x16x64_bf16 v[244:247], v[20:23], v[72:79], v12
    ds_read_b64_tr_b16 v[136:137], v3 offset:26624
    v_exp_f32 v89, v89
    v_exp_f32 v90, v90
    v_smfmac_f32_32x32x32_bf16 a[0:15], v[128:131], v[80:87], v12
    s_waitcnt lgkmcnt(4)
    v_exp_f32 v91, v91
    v_exp_f32 v92, v92
    v_exp_f32 v93, v93
    v_smfmac_f32_16x16x64_bf16 a[96:99], v[20:23], v[80:87], v12
    ds_read_b64_tr_b16 v[138:139], v3 offset:26880
    v_exp_f32 v94, v94
    v_mfma_f32_4x4x4_16b_bf16 v[24:27], v[144:145], v[144:145], 0
    v_exp_f32 v95, v95
    v_mfma_f32_32x32x16_bf16 v[64:79], v[112:115], a[136:139], 4.0
    v_exp_f32 v48, v48
    v_exp_f32 v49, v49
    v_exp_f32 v50, v50
    v_mfma_f32_32x32x16_bf16 v[64:79], v[116:119], a[140:143], v[64:79]
    v_exp_f32 v51, v51
    v_exp_f32 v52, v52
    v_exp_f32 v53, v53
    v_smfmac_f32_32x32x32_bf16 a[0:15], v[132:135], v[88:95], v12
    v_exp_f32 v54, v54
    v_exp_f32 v55, v55
    v_exp_f32 v56, v56
    v_smfmac_f32_16x16x64_bf16 a[96:99], v[20:23], v[88:95], v12
    ds_read_b64_tr_b16 v[140:141], v3 offset:27648
    v_exp_f32 v57, v57
    v_mfma_f32_4x4x4_16b_bf16 v[24:27], v[146:147], v[146:147], v[24:27]
    v_exp_f32 v58, v58
    v_smfmac_f32_32x32x32_bf16 a[16:31], v[128:131], v[48:55], v12
    s_waitcnt lgkmcnt(5)
    v_exp_f32 v59, v59
    v_exp_f32 v60, v60
    v_exp_f32 v61, v61
    v_smfmac_f32_16x16x64_bf16 a[100:103], v[20:23], v[48:55], v12
    ds_read_b64_tr_b16 v[142:143], v3 offset:27904
    v_exp_f32 v62, v62
    v_mfma_f32_4x4x4_16b_bf16 v[24:27], v[148:149], v[148:149], v[24:27]
    v_exp_f32 v63, v63
    v_mfma_f32_32x32x16_bf16 v[80:95], v[112:115], a[144:147], 4.0
    v_exp_f32 v64, v64
    v_exp_f32 v65, v65
    v_exp_f32 v66, v66
    v_mfma_f32_32x32x16_bf16 v[80:95], v[116:119], a[148:151], v[80:95]
    v_exp_f32 v67, v67
    v_exp_f32 v68, v68
    v_exp_f32 v69, v69
    v_smfmac_f32_32x32x32_bf16 a[16:31], v[132:135], v[56:63], v12
    v_exp_f32 v70, v70
    v_exp_f32 v71, v71
    v_exp_f32 v72, v72
    v_smfmac_f32_16x16x64_bf16 a[100:103], v[20:23], v[56:63], v12
    ds_read_b64_tr_b16 v[160:161], v8
    v_exp_f32 v73, v73
    v_mfma_f32_4x4x4_16b_bf16 v[24:27], v[150:151], v[150:151], v[24:27]
    v_exp_f32 v74, v74
    v_smfmac_f32_32x32x32_bf16 a[32:47], v[128:131], v[64:71], v12
    s_waitcnt lgkmcnt(6)
    v_exp_f32 v75, v75
    v_exp_f32 v76, v76
    v_exp_f32 v77, v77
    v_smfmac_f32_16x16x64_bf16 a[104:107], v[20:23], v[64:71], v12
    ds_read_b64_tr_b16 v[162:163], v8 offset:8
    v_exp_f32 v78, v78
    v_mfma_f32_4x4x4_16b_bf16 v[24:27], v[152:153], v[152:153], v[24:27]
    v_exp_f32 v79, v79
    v_mfma_f32_32x32x16_bf16 v[48:63], v[112:115], a[152:155], 4.0
    v_exp_f32 v80, v80
    v_exp_f32 v81, v81
    v_exp_f32 v82, v82
    v_mfma_f32_32x32x16_bf16 v[48:63], v[116:119], a[156:159], v[48:63]
    v_exp_f32 v83, v83
    v_exp_f32 v84, v84
    v_exp_f32 v85, v85
    v_smfmac_f32_32x32x32_bf16 a[32:47], v[132:135], v[72:79], v12
    v_exp_f32 v86, v86
    v_exp_f32 v87, v87
    v_exp_f32 v88, v88
    v_smfmac_f32_16x16x64_bf16 a[104:107], v[20:23], v[72:79], v12
    ds_read_b64_tr_b16 v[164:165], v9
    v_exp_f32 v89, v89
    v_mfma_f32_4x4x4_16b_bf16 v[24:27], v[154:155], v[154:155], v[24:27]
    v_exp_f32 v90, v90
    v_smfmac_f32_32x32x32_bf16 a[48:63], v[128:131], v[80:87], v12
    s_waitcnt lgkmcnt(7)
    v_exp_f32 v91, v91
    v_exp_f32 v92, v92
    v_exp_f32 v93, v93
    v_smfmac_f32_16x16x64_bf16 a[108:111], v[20:23], v[80:87], v12
    ds_read_b64_tr_b16 v[166:167], v9 offset:8
    v_exp_f32 v94, v94
    v_mfma_f32_4x4x4_16b_bf16 v[24:27], v[156:157], v[156:157], v[24:27]
    v_exp_f32 v95, v95
    v_mfma_f32_32x32x16_bf16 v[64:79], v[112:115], a[160:163], 4.0
    v_exp_f32 v48, v48
    v_exp_f32 v49, v49
    v_exp_f32 v50, v50
    v_mfma_f32_32x32x16_bf16 v[64:79], v[116:119], a[164:167], v[64:79]
    v_exp_f32 v51, v51
    v_exp_f32 v52, v52
    v_exp_f32 v53, v53
    v_smfmac_f32_32x32x32_bf16 a[48:63], v[132:135], v[88:95], v12
    v_exp_f32 v54, v54
    v_exp_f32 v55, v55
    v_exp_f32 v56, v56
    v_smfmac_f32_16x16x64_bf16 a[108:111], v[20:23], v[88:95], v12
    ds_read_b64_tr_b16 v[168:169], v8 offset:2048
    v_exp_f32 v57, v57
    v_mfma_f32_4x4x4_16b_bf16 v[24:27], v[158:159], v[158:159], v[24:27]
    v_exp_f32 v58, v58
    v_smfmac_f32_32x32x32_bf16 a[64:79], v[128:131], v[48:55], v12
    v_exp_f32 v59, v59
    v_exp_f32 v60, v60
    v_exp_f32 v61, v61
    v_smfmac_f32_16x16x64_bf16 a[112:115], v[20:23], v[48:55], v12
    ds_read_b64_tr_b16 v[170:171], v8 offset:2056
    v_exp_f32 v62, v62
    v_exp_f32 v63, v63
    v_cndmask_b32 v28, v24, v25, s[40:41]
    v_mfma_f32_32x32x16_bf16 v[80:95], v[120:123], v[192:195], 4.0
    v_exp_f32 v64, v64
    v_exp_f32 v65, v65
    v_exp_f32 v66, v66
    v_cndmask_b32 v28, v28, v26, s[42:43]
    v_mfma_f32_32x32x16_bf16 v[80:95], v[124:127], v[196:199], v[80:95]
    s_waitcnt lgkmcnt(6)
    v_exp_f32 v67, v67
    v_exp_f32 v68, v68
    v_exp_f32 v69, v69
    v_cndmask_b32 v28, v28, v27, s[44:45]
    v_smfmac_f32_32x32x32_bf16 a[64:79], v[132:135], v[56:63], v12
    v_exp_f32 v70, v70
    v_exp_f32 v71, v71
    v_exp_f32 v72, v72
    v_sqrt_f32 v28, v28
    v_smfmac_f32_16x16x64_bf16 a[112:115], v[20:23], v[56:63], v12
    ds_read_b64_tr_b16 v[172:173], v9 offset:2048
    v_exp_f32 v73, v73
    v_exp_f32 v74, v74
    v_add_f32 v28, 0x358637bd, v28
    v_smfmac_f32_32x32x32_bf16 a[80:95], v[128:131], v[64:71], v12
    v_exp_f32 v75, v75
    v_exp_f32 v76, v76
    v_exp_f32 v77, v77
    v_rcp_f32 v28, v28
    v_smfmac_f32_16x16x64_bf16 a[116:119], v[20:23], v[64:71], v12
    ds_read_b64_tr_b16 v[174:175], v9 offset:2056
    v_exp_f32 v78, v78
    v_exp_f32 v79, v79
    v_cvt_pk_bf16_f32 v29, v28, v28
    v_cvt_pk_bf16_f32 v30, v28, v28
    v_mfma_f32_32x32x16_bf16 v[48:63], v[120:123], v[200:203], 4.0
    v_exp_f32 v80, v80
    v_exp_f32 v81, v81
    v_exp_f32 v82, v82
    v_permlane32_swap_b32 v29, v30
    v_mfma_f32_32x32x16_bf16 v[48:63], v[124:127], v[204:207], v[48:63]
    v_exp_f32 v83, v83
    v_exp_f32 v84, v84
    v_exp_f32 v85, v85
    v_and_b32 v32, v29, v10
    v_and_b32 v33, v29, v11
    v_smfmac_f32_32x32x32_bf16 a[80:95], v[132:135], v[72:79], v12
    v_exp_f32 v86, v86
    v_exp_f32 v87, v87
    v_exp_f32 v88, v88
    v_and_b32 v34, v30, v10
    v_and_b32 v35, v30, v11
    v_smfmac_f32_16x16x64_bf16 a[116:119], v[20:23], v[72:79], v12
    v_exp_f32 v89, v89
    v_exp_f32 v90, v90
    v_smfmac_f32_32x32x32_bf16 v[208:223], v[136:139], v[80:87], v12
    s_waitcnt lgkmcnt(4)
    v_exp_f32 v91, v91
    v_exp_f32 v92, v92
    v_exp_f32 v93, v93
    v_smfmac_f32_16x16x64_bf16 v[240:243], v[20:23], v[80:87], v12
    v_exp_f32 v94, v94
    v_mfma_f32_4x4x4_16b_bf16 v[176:179], v[160:161], v[32:33], 0
    v_exp_f32 v95, v95
    v_mfma_f32_32x32x16_bf16 v[64:79], v[120:123], a[120:123], 4.0
    v_exp_f32 v48, v48
    v_exp_f32 v49, v49
    v_exp_f32 v50, v50
    v_mfma_f32_32x32x16_bf16 v[64:79], v[124:127], a[124:127], v[64:79]
    v_exp_f32 v51, v51
    v_exp_f32 v52, v52
    v_exp_f32 v53, v53
    v_cvt_pk_bf16_f32 v96, v176, v177
    v_cvt_pk_bf16_f32 v97, v178, v179
    v_smfmac_f32_32x32x32_bf16 v[208:223], v[140:143], v[88:95], v12
    s_waitcnt vmcnt(10)
    v_exp_f32 v54, v54
    v_exp_f32 v55, v55
    v_exp_f32 v56, v56
    v_smfmac_f32_16x16x64_bf16 v[240:243], v[20:23], v[88:95], v12
    ds_read_b64_tr_b16 v[128:129], v3
    v_exp_f32 v57, v57
    v_mfma_f32_4x4x4_16b_bf16 v[180:183], v[162:163], v[32:33], 0
    v_exp_f32 v58, v58
    v_smfmac_f32_32x32x32_bf16 v[224:239], v[136:139], v[48:55], v12
    v_exp_f32 v59, v59
    v_exp_f32 v60, v60
    v_exp_f32 v61, v61
    v_smfmac_f32_16x16x64_bf16 v[244:247], v[20:23], v[48:55], v12
    ds_read_b64_tr_b16 v[130:131], v3 offset:256
    v_exp_f32 v62, v62
    v_mfma_f32_4x4x4_16b_bf16 v[184:187], v[164:165], v[32:33], 0
    v_exp_f32 v63, v63
    v_cvt_pk_bf16_f32 v98, v180, v181
    v_cvt_pk_bf16_f32 v99, v182, v183
    v_mfma_f32_32x32x16_bf16 v[80:95], v[120:123], a[128:131], 4.0
    v_exp_f32 v64, v64
    v_exp_f32 v65, v65
    v_exp_f32 v66, v66
    v_mfma_f32_32x32x16_bf16 v[80:95], v[124:127], a[132:135], v[80:95]
    v_exp_f32 v67, v67
    v_exp_f32 v68, v68
    v_exp_f32 v69, v69
    v_cvt_pk_bf16_f32 v100, v184, v185
    v_cvt_pk_bf16_f32 v101, v186, v187
    v_smfmac_f32_32x32x32_bf16 v[224:239], v[140:143], v[56:63], v12
    v_exp_f32 v70, v70
    v_exp_f32 v71, v71
    v_exp_f32 v72, v72
    v_smfmac_f32_16x16x64_bf16 v[244:247], v[20:23], v[56:63], v12
    ds_read_b64_tr_b16 v[132:133], v3 offset:1024
    v_exp_f32 v73, v73
    v_mfma_f32_4x4x4_16b_bf16 v[188:191], v[166:167], v[32:33], 0
    v_exp_f32 v74, v74
    v_smfmac_f32_32x32x32_bf16 a[0:15], v[136:139], v[64:71], v12
    s_waitcnt lgkmcnt(3)
    v_exp_f32 v75, v75
    v_exp_f32 v76, v76
    v_exp_f32 v77, v77
    v_smfmac_f32_16x16x64_bf16 a[96:99], v[20:23], v[64:71], v12
    ds_read_b64_tr_b16 v[134:135], v3 offset:1280
    v_exp_f32 v78, v78
    v_mfma_f32_4x4x4_16b_bf16 v[176:179], v[168:169], v[34:35], 0
    v_exp_f32 v79, v79
    v_cvt_pk_bf16_f32 v102, v188, v189
    v_cvt_pk_bf16_f32 v103, v190, v191
    v_mfma_f32_32x32x16_bf16 v[48:63], v[120:123], a[136:139], 4.0
    s_add_u32 m0, s36, 16384
    v_exp_f32 v80, v80
    v_exp_f32 v81, v81
    v_exp_f32 v82, v82
    v_mfma_f32_32x32x16_bf16 v[48:63], v[124:127], a[140:143], v[48:63]
    s_add_u32 s48, s34, 24576
    v_exp_f32 v83, v83
    v_exp_f32 v84, v84
    v_exp_f32 v85, v85
    v_cvt_pk_bf16_f32 v104, v176, v177
    v_cvt_pk_bf16_f32 v105, v178, v179
    v_smfmac_f32_32x32x32_bf16 a[0:15], v[140:143], v[72:79], v12
L_t2:
    s_cbranch_vccnz L_ret
    v_exp_f32 v86, v86
    v_exp_f32 v87, v87
    v_exp_f32 v88, v88
    v_smfmac_f32_16x16x64_bf16 a[96:99], v[20:23], v[72:79], v12
    buffer_load_dwordx4 v1, s[20:23], s48 offen lds
    v_exp_f32 v89, v89
    v_mfma_f32_4x4x4_16b_bf16 v[180:183], v[170:171], v[34:35], 0
    v_exp_f32 v90, v90
    v_smfmac_f32_32x32x32_bf16 a[16:31], v[136:139], v[80:87], v12
    v_exp_f32 v91, v91
    v_exp_f32 v92, v92
    v_exp_f32 v93, v93
    v_smfmac_f32_16x16x64_bf16 a[100:103], v[20:23], v[80:87], v12
    buffer_load_dwordx4 v1, s[20:23], s48 offen offset:1024 lds
    v_exp_f32 v94, v94
    v_mfma_f32_4x4x4_16b_bf16 v[184:187], v[172:173], v[34:35], 0
    v_exp_f32 v95, v95
    v_cvt_pk_bf16_f32 v106, v180, v181
    v_cvt_pk_bf16_f32 v107, v182, v183
    v_mfma_f32_32x32x16_bf16 v[64:79], v[120:123], a[144:147], 4.0
    v_exp_f32 v48, v48
    v_exp_f32 v49, v49
    v_exp_f32 v50, v50
    v_mfma_f32_32x32x16_bf16 v[64:79], v[124:127], a[148:151], v[64:79]
    v_exp_f32 v51, v51
    v_exp_f32 v52, v52
    v_exp_f32 v53, v53
    v_cvt_pk_bf16_f32 v108, v184, v185
    v_cvt_pk_bf16_f32 v109, v186, v187
    v_smfmac_f32_32x32x32_bf16 a[16:31], v[140:143], v[88:95], v12
    v_exp_f32 v54, v54
    v_exp_f32 v55, v55
    v_exp_f32 v56, v56
    v_smfmac_f32_16x16x64_bf16 a[100:103], v[20:23], v[88:95], v12
    buffer_load_dwordx4 v1, s[20:23], s48 offen offset:2048 lds
    v_exp_f32 v57, v57
    v_mfma_f32_4x4x4_16b_bf16 v[188:191], v[174:175], v[34:35], 0
    v_exp_f32 v58, v58
    v_smfmac_f32_32x32x32_bf16 a[32:47], v[136:139], v[48:55], v12
    v_exp_f32 v59, v59
    v_exp_f32 v60, v60
    v_exp_f32 v61, v61
    v_smfmac_f32_16x16x64_bf16 a[104:107], v[20:23], v[48:55], v12
    buffer_load_dwordx4 v1, s[20:23], s48 offen offset:3072 lds
    v_exp_f32 v62, v62
    v_exp_f32 v63, v63
    v_cvt_pk_bf16_f32 v110, v188, v189
    v_cvt_pk_bf16_f32 v111, v190, v191
    v_mfma_f32_32x32x16_bf16 v[80:95], v[120:123], a[152:155], 4.0
    s_add_u32 m0, s36, 20480
    v_exp_f32 v64, v64
    v_exp_f32 v65, v65
    v_exp_f32 v66, v66
    v_mfma_f32_32x32x16_bf16 v[80:95], v[124:127], a[156:159], v[80:95]
    s_add_u32 s48, s34, 24576
    v_exp_f32 v67, v67
    v_exp_f32 v68, v68
    v_exp_f32 v69, v69
    v_smfmac_f32_32x32x32_bf16 a[32:47], v[140:143], v[56:63], v12
    v_exp_f32 v70, v70
    v_exp_f32 v71, v71
    v_exp_f32 v72, v72
    v_smfmac_f32_16x16x64_bf16 a[104:107], v[20:23], v[56:63], v12
    buffer_load_dwordx4 v2, s[24:27], s48 offen lds
    v_exp_f32 v73, v73
    v_exp_f32 v74, v74
    v_smfmac_f32_32x32x32_bf16 a[48:63], v[136:139], v[64:71], v12
    v_exp_f32 v75, v75
    v_exp_f32 v76, v76
    v_exp_f32 v77, v77
    v_smfmac_f32_16x16x64_bf16 a[108:111], v[20:23], v[64:71], v12
    buffer_load_dwordx4 v2, s[24:27], s48 offen offset:1024 lds
    v_exp_f32 v78, v78
    v_exp_f32 v79, v79
    v_mfma_f32_32x32x16_bf16 v[48:63], v[120:123], a[160:163], 4.0
    v_exp_f32 v80, v80
    v_exp_f32 v81, v81
    v_exp_f32 v82, v82
    v_mfma_f32_32x32x16_bf16 v[48:63], v[124:127], a[164:167], v[48:63]
    v_exp_f32 v83, v83
    v_exp_f32 v84, v84
    v_exp_f32 v85, v85
    v_smfmac_f32_32x32x32_bf16 a[48:63], v[140:143], v[72:79], v12
    v_exp_f32 v86, v86
    v_exp_f32 v87, v87
    v_exp_f32 v88, v88
    v_smfmac_f32_16x16x64_bf16 a[108:111], v[20:23], v[72:79], v12
    buffer_load_dwordx4 v2, s[24:27], s48 offen offset:2048 lds
    v_exp_f32 v89, v89
    v_exp_f32 v90, v90
    v_smfmac_f32_32x32x32_bf16 a[64:79], v[136:139], v[80:87], v12
    v_exp_f32 v91, v91
    v_exp_f32 v92, v92
    v_exp_f32 v93, v93
    v_smfmac_f32_16x16x64_bf16 a[112:115], v[20:23], v[80:87], v12
    buffer_load_dwordx4 v2, s[24:27], s48 offen offset:3072 lds
    v_exp_f32 v94, v94
    v_exp_f32 v95, v95
    v_mfma_f32_32x32x16_bf16 v[64:79], v[96:99], v[192:195], 4.0
    v_exp_f32 v48, v48
    v_exp_f32 v49, v49
    v_exp_f32 v50, v50
    v_mfma_f32_32x32x16_bf16 v[64:79], v[100:103], v[196:199], v[64:79]
    v_exp_f32 v51, v51
    v_exp_f32 v52, v52
    v_exp_f32 v53, v53
    v_smfmac_f32_32x32x32_bf16 a[64:79], v[140:143], v[88:95], v12
    v_exp_f32 v54, v54
    v_exp_f32 v55, v55
    v_exp_f32 v56, v56
    v_smfmac_f32_16x16x64_bf16 a[112:115], v[20:23], v[88:95], v12
    v_exp_f32 v57, v57
    v_exp_f32 v58, v58
    v_smfmac_f32_32x32x32_bf16 a[80:95], v[136:139], v[48:55], v12
    s_waitcnt lgkmcnt(0)
    v_exp_f32 v59, v59
    v_exp_f32 v60, v60
    v_exp_f32 v61, v61
    v_smfmac_f32_16x16x64_bf16 a[116:119], v[20:23], v[48:55], v12
    v_exp_f32 v62, v62
    v_exp_f32 v63, v63
    v_mfma_f32_32x32x16_bf16 v[80:95], v[96:99], v[200:203], 4.0
    v_exp_f32 v64, v64
    v_exp_f32 v65, v65
    v_exp_f32 v66, v66
    v_mfma_f32_32x32x16_bf16 v[80:95], v[100:103], v[204:207], v[80:95]
    v_exp_f32 v67, v67
    v_exp_f32 v68, v68
    v_exp_f32 v69, v69
    v_smfmac_f32_32x32x32_bf16 a[80:95], v[140:143], v[56:63], v12
    s_waitcnt vmcnt(12)
    v_exp_f32 v70, v70
    v_exp_f32 v71, v71
    v_exp_f32 v72, v72
    v_smfmac_f32_16x16x64_bf16 a[116:119], v[20:23], v[56:63], v12
    ds_read_b128 v[144:147], v4 offset:8192
    v_exp_f32 v73, v73
    v_exp_f32 v74, v74
    v_smfmac_f32_32x32x32_bf16 v[208:223], v[128:131], v[64:71], v12
    v_exp_f32 v75, v75
    v_exp_f32 v76, v76
    v_exp_f32 v77, v77
    v_smfmac_f32_16x16x64_bf16 v[240:243], v[20:23], v[64:71], v12
    ds_read_b128 v[148:151], v5 offset:8192
    v_exp_f32 v78, v78
    v_exp_f32 v79, v79
    v_mfma_f32_32x32x16_bf16 v[48:63], v[96:99], a[120:123], 4.0
    v_exp_f32 v80, v80
    v_exp_f32 v81, v81
    v_exp_f32 v82, v82
    v_mfma_f32_32x32x16_bf16 v[48:63], v[100:103], a[124:127], v[48:63]
    v_exp_f32 v83, v83
    v_exp_f32 v84, v84
    v_exp_f32 v85, v85
    v_smfmac_f32_32x32x32_bf16 v[208:223], v[132:135], v[72:79], v12
    v_exp_f32 v86, v86
    v_exp_f32 v87, v87
    v_exp_f32 v88, v88
    v_smfmac_f32_16x16x64_bf16 v[240:243], v[20:23], v[72:79], v12
    ds_read_b128 v[152:155], v6 offset:8192
    v_exp_f32 v89, v89
    v_exp_f32 v90, v90
    v_smfmac_f32_32x32x32_bf16 v[224:239], v[128:131], v[80:87], v12
    v_exp_f32 v91, v91
    v_exp_f32 v92, v92
    v_exp_f32 v93, v93
    v_smfmac_f32_16x16x64_bf16 v[244:247], v[20:23], v[80:87], v12
    ds_read_b128 v[156:159], v7 offset:8192
    v_exp_f32 v94, v94
    v_exp_f32 v95, v95
    v_mfma_f32_32x32x16_bf16 v[64:79], v[96:99], a[128:131], 4.0
    v_exp_f32 v48, v48
    v_exp_f32 v49, v49
    v_exp_f32 v50, v50
    v_mfma_f32_32x32x16_bf16 v[64:79], v[100:103], a[132:135], v[64:79]
    v_exp_f32 v51, v51
    v_exp_f32 v52, v52
    v_exp_f32 v53, v53
    v_smfmac_f32_32x32x32_bf16 v[224:239], v[132:135], v[88:95], v12
    v_exp_f32 v54, v54
    v_exp_f32 v55, v55
    v_exp_f32 v56, v56
    v_smfmac_f32_16x16x64_bf16 v[244:247], v[20:23], v[88:95], v12
    ds_read_b64_tr_b16 v[136:137], v3 offset:2048
    v_exp_f32 v57, v57
    v_exp_f32 v58, v58
    v_smfmac_f32_32x32x32_bf16 a[0:15], v[128:131], v[48:55], v12
    s_waitcnt lgkmcnt(4)
    v_exp_f32 v59, v59
    v_exp_f32 v60, v60
    v_exp_f32 v61, v61
    v_smfmac_f32_16x16x64_bf16 a[96:99], v[20:23], v[48:55], v12
    ds_read_b64_tr_b16 v[138:139], v3 offset:2304
    v_exp_f32 v62, v62
    v_mfma_f32_4x4x4_16b_bf16 v[24:27], v[144:145], v[144:145], 0
    v_exp_f32 v63, v63
    v_mfma_f32_32x32x16_bf16 v[80:95], v[96:99], a[136:139], 4.0
    v_exp_f32 v64, v64
    v_exp_f32 v65, v65
    v_exp_f32 v66, v66
    v_mfma_f32_32x32x16_bf16 v[80:95], v[100:103], a[140:143], v[80:95]
    v_exp_f32 v67, v67
    v_exp_f32 v68, v68
    v_exp_f32 v69, v69
    v_smfmac_f32_32x32x32_bf16 a[0:15], v[132:135], v[56:63], v12
    v_exp_f32 v70, v70
    v_exp_f32 v71, v71
    v_exp_f32 v72, v72
    v_smfmac_f32_16x16x64_bf16 a[96:99], v[20:23], v[56:63], v12
    ds_read_b64_tr_b16 v[140:141], v3 offset:3072
    v_exp_f32 v73, v73
    v_mfma_f32_4x4x4_16b_bf16 v[24:27], v[146:147], v[146:147], v[24:27]
    v_exp_f32 v74, v74
    v_smfmac_f32_32x32x32_bf16 a[16:31], v[128:131], v[64:71], v12
    s_waitcnt lgkmcnt(5)
    v_exp_f32 v75, v75
    v_exp_f32 v76, v76
    v_exp_f32 v77, v77
    v_smfmac_f32_16x16x64_bf16 a[100:103], v[20:23], v[64:71], v12
    ds_read_b64_tr_b16 v[142:143], v3 offset:3328
    v_exp_f32 v78, v78
    v_mfma_f32_4x4x4_16b_bf16 v[24:27], v[148:149], v[148:149], v[24:27]
    v_exp_f32 v79, v79
    v_mfma_f32_32x32x16_bf16 v[48:63], v[96:99], a[144:147], 4.0
    v_exp_f32 v80, v80
    v_exp_f32 v81, v81
    v_exp_f32 v82, v82
    v_mfma_f32_32x32x16_bf16 v[48:63], v[100:103], a[148:151], v[48:63]
    v_exp_f32 v83, v83
    v_exp_f32 v84, v84
    v_exp_f32 v85, v85
    v_smfmac_f32_32x32x32_bf16 a[16:31], v[132:135], v[72:79], v12
    v_exp_f32 v86, v86
    v_exp_f32 v87, v87
    v_exp_f32 v88, v88
    v_smfmac_f32_16x16x64_bf16 a[100:103], v[20:23], v[72:79], v12
    ds_read_b64_tr_b16 v[160:161], v8 offset:8192
    v_exp_f32 v89, v89
    v_mfma_f32_4x4x4_16b_bf16 v[24:27], v[150:151], v[150:151], v[24:27]
    v_exp_f32 v90, v90
    v_smfmac_f32_32x32x32_bf16 a[32:47], v[128:131], v[80:87], v12
    s_waitcnt lgkmcnt(6)
    v_exp_f32 v91, v91
    v_exp_f32 v92, v92
    v_exp_f32 v93, v93
    v_smfmac_f32_16x16x64_bf16 a[104:107], v[20:23], v[80:87], v12
    ds_read_b64_tr_b16 v[162:163], v8 offset:8200
    v_exp_f32 v94, v94
    v_mfma_f32_4x4x4_16b_bf16 v[24:27], v[152:153], v[152:153], v[24:27]
    v_exp_f32 v95, v95
    v_mfma_f32_32x32x16_bf16 v[64:79], v[96:99], a[152:155], 4.0
    v_exp_f32 v48, v48
    v_exp_f32 v49, v49
    v_exp_f32 v50, v50
    v_mfma_f32_32x32x16_bf16 v[64:79], v[100:103], a[156:159], v[64:79]
    v_exp_f32 v51, v51
    v_exp_f32 v52, v52
    v_exp_f32 v53, v53
    v_smfmac_f32_32x32x32_bf16 a[32:47], v[132:135], v[88:95], v12
    v_exp_f32 v54, v54
    v_exp_f32 v55, v55
    v_exp_f32 v56, v56
    v_smfmac_f32_16x16x64_bf16 a[104:107], v[20:23], v[88:95], v12
    ds_read_b64_tr_b16 v[164:165], v9 offset:8192
    v_exp_f32 v57, v57
    v_mfma_f32_4x4x4_16b_bf16 v[24:27], v[154:155], v[154:155], v[24:27]
    v_exp_f32 v58, v58
    v_smfmac_f32_32x32x32_bf16 a[48:63], v[128:131], v[48:55], v12
    s_waitcnt lgkmcnt(7)
    v_exp_f32 v59, v59
    v_exp_f32 v60, v60
    v_exp_f32 v61, v61
    v_smfmac_f32_16x16x64_bf16 a[108:111], v[20:23], v[48:55], v12
    ds_read_b64_tr_b16 v[166:167], v9 offset:8200
    v_exp_f32 v62, v62
    v_mfma_f32_4x4x4_16b_bf16 v[24:27], v[156:157], v[156:157], v[24:27]
    v_exp_f32 v63, v63
    v_mfma_f32_32x32x16_bf16 v[80:95], v[96:99], a[160:163], 4.0
    v_exp_f32 v64, v64
    v_exp_f32 v65, v65
    v_exp_f32 v66, v66
    v_mfma_f32_32x32x16_bf16 v[80:95], v[100:103], a[164:167], v[80:95]
    v_exp_f32 v67, v67
    v_exp_f32 v68, v68
    v_exp_f32 v69, v69
    v_smfmac_f32_32x32x32_bf16 a[48:63], v[132:135], v[56:63], v12
    v_exp_f32 v70, v70
    v_exp_f32 v71, v71
    v_exp_f32 v72, v72
    v_smfmac_f32_16x16x64_bf16 a[108:111], v[20:23], v[56:63], v12
    ds_read_b64_tr_b16 v[168:169], v8 offset:10240
    v_exp_f32 v73, v73
    v_mfma_f32_4x4x4_16b_bf16 v[24:27], v[158:159], v[158:159], v[24:27]
    v_exp_f32 v74, v74
    v_smfmac_f32_32x32x32_bf16 a[64:79], v[128:131], v[64:71], v12
    v_exp_f32 v75, v75
    v_exp_f32 v76, v76
    v_exp_f32 v77, v77
    v_smfmac_f32_16x16x64_bf16 a[112:115], v[20:23], v[64:71], v12
    ds_read_b64_tr_b16 v[170:171], v8 offset:10248
    v_exp_f32 v78, v78
    v_exp_f32 v79, v79
    v_cndmask_b32 v28, v24, v25, s[40:41]
    v_mfma_f32_32x32x16_bf16 v[48:63], v[104:107], v[192:195], 4.0
    v_exp_f32 v80, v80
    v_exp_f32 v81, v81
    v_exp_f32 v82, v82
    v_cndmask_b32 v28, v28, v26, s[42:43]
    v_mfma_f32_32x32x16_bf16 v[48:63], v[108:111], v[196:199], v[48:63]
    s_waitcnt lgkmcnt(6)
    v_exp_f32 v83, v83
    v_exp_f32 v84, v84
    v_exp_f32 v85, v85
    v_cndmask_b32 v28, v28, v27, s[44:45]
    v_smfmac_f32_32x32x32_bf16 a[64:79], v[132:135], v[72:79], v12
    v_exp_f32 v86, v86
    v_exp_f32 v87, v87
    v_exp_f32 v88, v88
    v_sqrt_f32 v28, v28
    v_smfmac_f32_16x16x64_bf16 a[112:115], v[20:23], v[72:79], v12
    ds_read_b64_tr_b16 v[172:173], v9 offset:10240
    v_exp_f32 v89, v89
    v_exp_f32 v90, v90
    v_add_f32 v28, 0x358637bd, v28
    v_smfmac_f32_32x32x32_bf16 a[80:95], v[128:131], v[80:87], v12
    v_exp_f32 v91, v91
    v_exp_f32 v92, v92
    v_exp_f32 v93, v93
    v_rcp_f32 v28, v28
    v_smfmac_f32_16x16x64_bf16 a[116:119], v[20:23], v[80:87], v12
    ds_read_b64_tr_b16 v[174:175], v9 offset:10248
    v_exp_f32 v94, v94
    v_exp_f32 v95, v95
    v_cvt_pk_bf16_f32 v29, v28, v28
    v_cvt_pk_bf16_f32 v30, v28, v28
    v_mfma_f32_32x32x16_bf16 v[64:79], v[104:107], v[200:203], 4.0
    v_exp_f32 v48, v48
    v_exp_f32 v49, v49
    v_exp_f32 v50, v50
    v_permlane32_swap_b32 v29, v30
    v_mfma_f32_32x32x16_bf16 v[64:79], v[108:111], v[204:207], v[64:79]
    v_exp_f32 v51, v51
    v_exp_f32 v52, v52
    v_exp_f32 v53, v53
    v_and_b32 v32, v29, v10
    v_and_b32 v33, v29, v11
    v_smfmac_f32_32x32x32_bf16 a[80:95], v[132:135], v[88:95], v12
    v_exp_f32 v54, v54
    v_exp_f32 v55, v55
    v_exp_f32 v56, v56
    v_and_b32 v34, v30, v10
    v_and_b32 v35, v30, v11
    v_smfmac_f32_16x16x64_bf16 a[116:119], v[20:23], v[88:95], v12
    v_exp_f32 v57, v57
    v_exp_f32 v58, v58
    v_smfmac_f32_32x32x32_bf16 v[208:223], v[136:139], v[48:55], v12
    s_waitcnt lgkmcnt(4)
    v_exp_f32 v59, v59
    v_exp_f32 v60, v60
    v_exp_f32 v61, v61
    v_smfmac_f32_16x16x64_bf16 v[240:243], v[20:23], v[48:55], v12
    v_exp_f32 v62, v62
    v_mfma_f32_4x4x4_16b_bf16 v[176:179], v[160:161], v[32:33], 0
    v_exp_f32 v63, v63
    v_mfma_f32_32x32x16_bf16 v[80:95], v[104:107], a[120:123], 4.0
    v_exp_f32 v64, v64
    v_exp_f32 v65, v65
    v_exp_f32 v66, v66
    v_mfma_f32_32x32x16_bf16 v[80:95], v[108:111], a[124:127], v[80:95]
    v_exp_f32 v67, v67
    v_exp_f32 v68, v68
    v_exp_f32 v69, v69
    v_cvt_pk_bf16_f32 v112, v176, v177
    v_cvt_pk_bf16_f32 v113, v178, v179
    v_smfmac_f32_32x32x32_bf16 v[208:223], v[140:143], v[56:63], v12
    s_waitcnt vmcnt(10)
    v_exp_f32 v70, v70
    v_exp_f32 v71, v71
    v_exp_f32 v72, v72
    v_smfmac_f32_16x16x64_bf16 v[240:243], v[20:23], v[56:63], v12
    ds_read_b64_tr_b16 v[128:129], v3 offset:8192
    v_exp_f32 v73, v73
    v_mfma_f32_4x4x4_16b_bf16 v[180:183], v[162:163], v[32:33], 0
    v_exp_f32 v74, v74
    v_smfmac_f32_32x32x32_bf16 v[224:239], v[136:139], v[64:71], v12
    v_exp_f32 v75, v75
    v_exp_f32 v76, v76
    v_exp_f32 v77, v77
    v_smfmac_f32_16x16x64_bf16 v[244:247], v[20:23], v[64:71], v12
    ds_read_b64_tr_b16 v[130:131], v3 offset:8448
    v_exp_f32 v78, v78
    v_mfma_f32_4x4x4_16b_bf16 v[184:187], v[164:165], v[32:33], 0
    v_exp_f32 v79, v79
    v_cvt_pk_bf16_f32 v114, v180, v181
    v_cvt_pk_bf16_f32 v115, v182, v183
    v_mfma_f32_32x32x16_bf16 v[48:63], v[104:107], a[128:131], 4.0
    v_exp_f32 v80, v80
    v_exp_f32 v81, v81
    v_exp_f32 v82, v82
    v_mfma_f32_32x32x16_bf16 v[48:63], v[108:111], a[132:135], v[48:63]
    v_exp_f32 v83, v83
    v_exp_f32 v84, v84
    v_exp_f32 v85, v85
    v_cvt_pk_bf16_f32 v116, v184, v185
    v_cvt_pk_bf16_f32 v117, v186, v187
    v_smfmac_f32_32x32x32_bf16 v[224:239], v[140:143], v[72:79], v12
    v_exp_f32 v86, v86
    v_exp_f32 v87, v87
    v_exp_f32 v88, v88
    v_smfmac_f32_16x16x64_bf16 v[244:247], v[20:23], v[72:79], v12
    ds_read_b64_tr_b16 v[132:133], v3 offset:9216
    v_exp_f32 v89, v89
    v_mfma_f32_4x4x4_16b_bf16 v[188:191], v[166:167], v[32:33], 0
    v_exp_f32 v90, v90
    v_smfmac_f32_32x32x32_bf16 a[0:15], v[136:139], v[80:87], v12
    s_waitcnt lgkmcnt(3)
    v_exp_f32 v91, v91
    v_exp_f32 v92, v92
    v_exp_f32 v93, v93
    v_smfmac_f32_16x16x64_bf16 a[96:99], v[20:23], v[80:87], v12
    ds_read_b64_tr_b16 v[134:135], v3 offset:9472
    v_exp_f32 v94, v94
    v_mfma_f32_4x4x4_16b_bf16 v[176:179], v[168:169], v[34:35], 0
    v_exp_f32 v95, v95
    v_cvt_pk_bf16_f32 v118, v188, v189
    v_cvt_pk_bf16_f32 v119, v190, v191
    v_mfma_f32_32x32x16_bf16 v[64:79], v[104:107], a[136:139], 4.0
    s_add_u32 m0, s36, 24576
    v_exp_f32 v48, v48
    v_exp_f32 v49, v49
    v_exp_f32 v50, v50
    v_mfma_f32_32x32x16_bf16 v[64:79], v[108:111], a[140:143], v[64:79]
    s_add_u32 s48, s34, 28672
    v_exp_f32 v51, v51
    v_exp_f32 v52, v52
    v_exp_f32 v53, v53
    v_cvt_pk_bf16_f32 v120, v176, v177
    v_cvt_pk_bf16_f32 v121, v178, v179
    v_smfmac_f32_32x32x32_bf16 a[0:15], v[140:143], v[88:95], v12
    v_exp_f32 v54, v54
    v_exp_f32 v55, v55
    v_exp_f32 v56, v56
    v_smfmac_f32_16x16x64_bf16 a[96:99], v[20:23], v[88:95], v12
    buffer_load_dwordx4 v1, s[20:23], s48 offen lds
    v_exp_f32 v57, v57
    v_mfma_f32_4x4x4_16b_bf16 v[180:183], v[170:171], v[34:35], 0
    v_exp_f32 v58, v58
    v_smfmac_f32_32x32x32_bf16 a[16:31], v[136:139], v[48:55], v12
    v_exp_f32 v59, v59
    v_exp_f32 v60, v60
    v_exp_f32 v61, v61
    v_smfmac_f32_16x16x64_bf16 a[100:103], v[20:23], v[48:55], v12
    buffer_load_dwordx4 v1, s[20:23], s48 offen offset:1024 lds
    v_exp_f32 v62, v62
    v_mfma_f32_4x4x4_16b_bf16 v[184:187], v[172:173], v[34:35], 0
    v_exp_f32 v63, v63
    v_cvt_pk_bf16_f32 v122, v180, v181
    v_cvt_pk_bf16_f32 v123, v182, v183
    v_mfma_f32_32x32x16_bf16 v[80:95], v[104:107], a[144:147], 4.0
    v_exp_f32 v64, v64
    v_exp_f32 v65, v65
    v_exp_f32 v66, v66
    v_mfma_f32_32x32x16_bf16 v[80:95], v[108:111], a[148:151], v[80:95]
    v_exp_f32 v67, v67
    v_exp_f32 v68, v68
    v_exp_f32 v69, v69
    v_cvt_pk_bf16_f32 v124, v184, v185
    v_cvt_pk_bf16_f32 v125, v186, v187
    v_smfmac_f32_32x32x32_bf16 a[16:31], v[140:143], v[56:63], v12
    v_exp_f32 v70, v70
    v_exp_f32 v71, v71
    v_exp_f32 v72, v72
    v_smfmac_f32_16x16x64_bf16 a[100:103], v[20:23], v[56:63], v12
    buffer_load_dwordx4 v1, s[20:23], s48 offen offset:2048 lds
    v_exp_f32 v73, v73
    v_mfma_f32_4x4x4_16b_bf16 v[188:191], v[174:175], v[34:35], 0
    v_exp_f32 v74, v74
    v_smfmac_f32_32x32x32_bf16 a[32:47], v[136:139], v[64:71], v12
    v_exp_f32 v75, v75
    v_exp_f32 v76, v76
    v_exp_f32 v77, v77
    v_smfmac_f32_16x16x64_bf16 a[104:107], v[20:23], v[64:71], v12
    buffer_load_dwordx4 v1, s[20:23], s48 offen offset:3072 lds
    v_exp_f32 v78, v78
    v_exp_f32 v79, v79
    v_cvt_pk_bf16_f32 v126, v188, v189
    v_cvt_pk_bf16_f32 v127, v190, v191
    v_mfma_f32_32x32x16_bf16 v[48:63], v[104:107], a[152:155], 4.0
    s_add_u32 m0, s36, 28672
    v_exp_f32 v80, v80
    v_exp_f32 v81, v81
    v_exp_f32 v82, v82
    v_mfma_f32_32x32x16_bf16 v[48:63], v[108:111], a[156:159], v[48:63]
    s_add_u32 s48, s34, 28672
    v_exp_f32 v83, v83
    v_exp_f32 v84, v84
    v_exp_f32 v85, v85
    v_smfmac_f32_32x32x32_bf16 a[32:47], v[140:143], v[72:79], v12
    v_exp_f32 v86, v86
    v_exp_f32 v87, v87
    v_exp_f32 v88, v88
    v_smfmac_f32_16x16x64_bf16 a[104:107], v[20:23], v[72:79], v12
    buffer_load_dwordx4 v2, s[24:27], s48 offen lds
    v_exp_f32 v89, v89
    v_exp_f32 v90, v90
    v_smfmac_f32_32x32x32_bf16 a[48:63], v[136:139], v[80:87], v12
    v_exp_f32 v91, v91
    v_exp_f32 v92, v92
    v_exp_f32 v93, v93
    v_smfmac_f32_16x16x64_bf16 a[108:111], v[20:23], v[80:87], v12
    buffer_load_dwordx4 v2, s[24:27], s48 offen offset:1024 lds
    v_exp_f32 v94, v94
    v_exp_f32 v95, v95
    v_mfma_f32_32x32x16_bf16 v[64:79], v[104:107], a[160:163], 4.0
    v_exp_f32 v48, v48
    v_exp_f32 v49, v49
    v_exp_f32 v50, v50
    v_mfma_f32_32x32x16_bf16 v[64:79], v[108:111], a[164:167], v[64:79]
    v_exp_f32 v51, v51
    v_exp_f32 v52, v52
    v_exp_f32 v53, v53
    v_smfmac_f32_32x32x32_bf16 a[48:63], v[140:143], v[88:95], v12
    v_exp_f32 v54, v54
    v_exp_f32 v55, v55
    v_exp_f32 v56, v56
    v_smfmac_f32_16x16x64_bf16 a[108:111], v[20:23], v[88:95], v12
    buffer_load_dwordx4 v2, s[24:27], s48 offen offset:2048 lds
    v_exp_f32 v57, v57
    v_exp_f32 v58, v58
    v_smfmac_f32_32x32x32_bf16 a[64:79], v[136:139], v[48:55], v12
    v_exp_f32 v59, v59
    v_exp_f32 v60, v60
    v_exp_f32 v61, v61
    v_smfmac_f32_16x16x64_bf16 a[112:115], v[20:23], v[48:55], v12
    buffer_load_dwordx4 v2, s[24:27], s48 offen offset:3072 lds
    v_exp_f32 v62, v62
    v_exp_f32 v63, v63
    v_mfma_f32_32x32x16_bf16 v[80:95], v[112:115], v[192:195], 4.0
    v_exp_f32 v64, v64
    v_exp_f32 v65, v65
    v_exp_f32 v66, v66
    v_mfma_f32_32x32x16_bf16 v[80:95], v[116:119], v[196:199], v[80:95]
    v_exp_f32 v67, v67
    v_exp_f32 v68, v68
    v_exp_f32 v69, v69
    v_smfmac_f32_32x32x32_bf16 a[64:79], v[140:143], v[56:63], v12
    v_exp_f32 v70, v70
    v_exp_f32 v71, v71
    v_exp_f32 v72, v72
    v_smfmac_f32_16x16x64_bf16 a[112:115], v[20:23], v[56:63], v12
    v_exp_f32 v73, v73
    v_exp_f32 v74, v74
    v_smfmac_f32_32x32x32_bf16 a[80:95], v[136:139], v[64:71], v12
    s_waitcnt lgkmcnt(0)
    v_exp_f32 v75, v75
    v_exp_f32 v76, v76
    v_exp_f32 v77, v77
    v_smfmac_f32_16x16x64_bf16 a[116:119], v[20:23], v[64:71], v12
    v_exp_f32 v78, v78
    v_exp_f32 v79, v79
    v_mfma_f32_32x32x16_bf16 v[48:63], v[112:115], v[200:203], 4.0
    v_exp_f32 v80, v80
    v_exp_f32 v81, v81
    v_exp_f32 v82, v82
    v_mfma_f32_32x32x16_bf16 v[48:63], v[116:119], v[204:207], v[48:63]
    v_exp_f32 v83, v83
    v_exp_f32 v84, v84
    v_exp_f32 v85, v85
    v_smfmac_f32_32x32x32_bf16 a[80:95], v[140:143], v[72:79], v12
    s_waitcnt vmcnt(12)
    v_exp_f32 v86, v86
    v_exp_f32 v87, v87
    v_exp_f32 v88, v88
    v_smfmac_f32_16x16x64_bf16 a[116:119], v[20:23], v[72:79], v12
    ds_read_b128 v[144:147], v4 offset:16384
    v_exp_f32 v89, v89
    v_exp_f32 v90, v90
    v_smfmac_f32_32x32x32_bf16 v[208:223], v[128:131], v[80:87], v12
    v_exp_f32 v91, v91
    v_exp_f32 v92, v92
    v_exp_f32 v93, v93
    v_smfmac_f32_16x16x64_bf16 v[240:243], v[20:23], v[80:87], v12
    ds_read_b128 v[148:151], v5 offset:16384
    v_exp_f32 v94, v94
    v_exp_f32 v95, v95
    v_mfma_f32_32x32x16_bf16 v[64:79], v[112:115], a[120:123], 4.0
    v_exp_f32 v48, v48
    v_exp_f32 v49, v49
    v_exp_f32 v50, v50
    v_mfma_f32_32x32x16_bf16 v[64:79], v[116:119], a[124:127], v[64:79]
    v_exp_f32 v51, v51
    v_exp_f32 v52, v52
    v_exp_f32 v53, v53
    v_smfmac_f32_32x32x32_bf16 v[208:223], v[132:135], v[88:95], v12
    v_exp_f32 v54, v54
    v_exp_f32 v55, v55
    v_exp_f32 v56, v56
    v_smfmac_f32_16x16x64_bf16 v[240:243], v[20:23], v[88:95], v12
    ds_read_b128 v[152:155], v6 offset:16384
    v_exp_f32 v57, v57
    v_exp_f32 v58, v58
    v_smfmac_f32_32x32x32_bf16 v[224:239], v[128:131], v[48:55], v12
    v_exp_f32 v59, v59
    v_exp_f32 v60, v60
    v_exp_f32 v61, v61
    v_smfmac_f32_16x16x64_bf16 v[244:247], v[20:23], v[48:55], v12
    ds_read_b128 v[156:159], v7 offset:16384
    v_exp_f32 v62, v62
    v_exp_f32 v63, v63
    v_mfma_f32_32x32x16_bf16 v[80:95], v[112:115], a[128:131], 4.0
    v_exp_f32 v64, v64
    v_exp_f32 v65, v65
    v_exp_f32 v66, v66
    v_mfma_f32_32x32x16_bf16 v[80:95], v[116:119], a[132:135], v[80:95]
    v_exp_f32 v67, v67
    v_exp_f32 v68, v68
    v_exp_f32 v69, v69
    v_smfmac_f32_32x32x32_bf16 v[224:239], v[132:135], v[56:63], v12
    v_exp_f32 v70, v70
    v_exp_f32 v71, v71
    v_exp_f32 v72, v72
    v_smfmac_f32_16x16x64_bf16 v[244:247], v[20:23], v[56:63], v12
    ds_read_b64_tr_b16 v[136:137], v3 offset:10240
    v_exp_f32 v73, v73
    v_exp_f32 v74, v74
    v_smfmac_f32_32x32x32_bf16 a[0:15], v[128:131], v[64:71], v12
    s_waitcnt lgkmcnt(4)
    v_exp_f32 v75, v75
    v_exp_f32 v76, v76
    v_exp_f32 v77, v77
    v_smfmac_f32_16x16x64_bf16 a[96:99], v[20:23], v[64:71], v12
    ds_read_b64_tr_b16 v[138:139], v3 offset:10496
    v_exp_f32 v78, v78
    v_mfma_f32_4x4x4_16b_bf16 v[24:27], v[144:145], v[144:145], 0
    v_exp_f32 v79, v79
    v_mfma_f32_32x32x16_bf16 v[48:63], v[112:115], a[136:139], 4.0
    v_exp_f32 v80, v80
    v_exp_f32 v81, v81
    v_exp_f32 v82, v82
    v_mfma_f32_32x32x16_bf16 v[48:63], v[116:119], a[140:143], v[48:63]
    v_exp_f32 v83, v83
    v_exp_f32 v84, v84
    v_exp_f32 v85, v85
    v_smfmac_f32_32x32x32_bf16 a[0:15], v[132:135], v[72:79], v12
    v_exp_f32 v86, v86
    v_exp_f32 v87, v87
    v_exp_f32 v88, v88
    v_smfmac_f32_16x16x64_bf16 a[96:99], v[20:23], v[72:79], v12
    ds_read_b64_tr_b16 v[140:141], v3 offset:11264
    v_exp_f32 v89, v89
    v_mfma_f32_4x4x4_16b_bf16 v[24:27], v[146:147], v[146:147], v[24:27]
    v_exp_f32 v90, v90
    v_smfmac_f32_32x32x32_bf16 a[16:31], v[128:131], v[80:87], v12
    s_waitcnt lgkmcnt(5)
    v_exp_f32 v91, v91
    v_exp_f32 v92, v92
    v_exp_f32 v93, v93
    v_smfmac_f32_16x16x64_bf16 a[100:103], v[20:23], v[80:87], v12
    ds_read_b64_tr_b16 v[142:143], v3 offset:11520
    v_exp_f32 v94, v94
    v_mfma_f32_4x4x4_16b_bf16 v[24:27], v[148:149], v[148:149], v[24:27]
    v_exp_f32 v95, v95
    v_mfma_f32_32x32x16_bf16 v[64:79], v[112:115], a[144:147], 4.0
    v_exp_f32 v48, v48
    v_exp_f32 v49, v49
    v_exp_f32 v50, v50
    v_mfma_f32_32x32x16_bf16 v[64:79], v[116:119], a[148:151], v[64:79]
    v_exp_f32 v51, v51
    v_exp_f32 v52, v52
    v_exp_f32 v53, v53
    v_smfmac_f32_32x32x32_bf16 a[16:31], v[132:135], v[88:95], v12
    v_exp_f32 v54, v54
    v_exp_f32 v55, v55
    v_exp_f32 v56, v56
    v_smfmac_f32_16x16x64_bf16 a[100:103], v[20:23], v[88:95], v12
    ds_read_b64_tr_b16 v[160:161], v8 offset:16384
    v_exp_f32 v57, v57
    v_mfma_f32_4x4x4_16b_bf16 v[24:27], v[150:151], v[150:151], v[24:27]
    v_exp_f32 v58, v58
    v_smfmac_f32_32x32x32_bf16 a[32:47], v[128:131], v[48:55], v12
    s_waitcnt lgkmcnt(6)
    v_exp_f32 v59, v59
    v_exp_f32 v60, v60
    v_exp_f32 v61, v61
    v_smfmac_f32_16x16x64_bf16 a[104:107], v[20:23], v[48:55], v12
    ds_read_b64_tr_b16 v[162:163], v8 offset:16392
    v_exp_f32 v62, v62
    v_mfma_f32_4x4x4_16b_bf16 v[24:27], v[152:153], v[152:153], v[24:27]
    v_exp_f32 v63, v63
    v_mfma_f32_32x32x16_bf16 v[80:95], v[112:115], a[152:155], 4.0
    v_exp_f32 v64, v64
    v_exp_f32 v65, v65
    v_exp_f32 v66, v66
    v_mfma_f32_32x32x16_bf16 v[80:95], v[116:119], a[156:159], v[80:95]
    v_exp_f32 v67, v67
    v_exp_f32 v68, v68
    v_exp_f32 v69, v69
    v_smfmac_f32_32x32x32_bf16 a[32:47], v[132:135], v[56:63], v12
    v_exp_f32 v70, v70
    v_exp_f32 v71, v71
    v_exp_f32 v72, v72
    v_smfmac_f32_16x16x64_bf16 a[104:107], v[20:23], v[56:63], v12
    ds_read_b64_tr_b16 v[164:165], v9 offset:16384
    v_exp_f32 v73, v73
    v_mfma_f32_4x4x4_16b_bf16 v[24:27], v[154:155], v[154:155], v[24:27]
    v_exp_f32 v74, v74
    v_smfmac_f32_32x32x32_bf16 a[48:63], v[128:131], v[64:71], v12
    s_waitcnt lgkmcnt(7)
    v_exp_f32 v75, v75
    v_exp_f32 v76, v76
    v_exp_f32 v77, v77
    v_smfmac_f32_16x16x64_bf16 a[108:111], v[20:23], v[64:71], v12
    ds_read_b64_tr_b16 v[166:167], v9 offset:16392
    v_exp_f32 v78, v78
    v_mfma_f32_4x4x4_16b_bf16 v[24:27], v[156:157], v[156:157], v[24:27]
    v_exp_f32 v79, v79
    v_mfma_f32_32x32x16_bf16 v[48:63], v[112:115], a[160:163], 4.0
    v_exp_f32 v80, v80
    v_exp_f32 v81, v81
    v_exp_f32 v82, v82
    v_mfma_f32_32x32x16_bf16 v[48:63], v[116:119], a[164:167], v[48:63]
    v_exp_f32 v83, v83
    v_exp_f32 v84, v84
    v_exp_f32 v85, v85
    v_smfmac_f32_32x32x32_bf16 a[48:63], v[132:135], v[72:79], v12
    v_exp_f32 v86, v86
    v_exp_f32 v87, v87
    v_exp_f32 v88, v88
    v_smfmac_f32_16x16x64_bf16 a[108:111], v[20:23], v[72:79], v12
    ds_read_b64_tr_b16 v[168:169], v8 offset:18432
    v_exp_f32 v89, v89
    v_mfma_f32_4x4x4_16b_bf16 v[24:27], v[158:159], v[158:159], v[24:27]
    v_exp_f32 v90, v90
    v_smfmac_f32_32x32x32_bf16 a[64:79], v[128:131], v[80:87], v12
    v_exp_f32 v91, v91
    v_exp_f32 v92, v92
    v_exp_f32 v93, v93
    v_smfmac_f32_16x16x64_bf16 a[112:115], v[20:23], v[80:87], v12
    ds_read_b64_tr_b16 v[170:171], v8 offset:18440
    v_exp_f32 v94, v94
    v_exp_f32 v95, v95
    v_cndmask_b32 v28, v24, v25, s[40:41]
    v_mfma_f32_32x32x16_bf16 v[64:79], v[120:123], v[192:195], 4.0
    v_exp_f32 v48, v48
    v_exp_f32 v49, v49
    v_exp_f32 v50, v50
    v_cndmask_b32 v28, v28, v26, s[42:43]
    v_mfma_f32_32x32x16_bf16 v[64:79], v[124:127], v[196:199], v[64:79]
    s_waitcnt lgkmcnt(6)
    v_exp_f32 v51, v51
    v_exp_f32 v52, v52
    v_exp_f32 v53, v53
    v_cndmask_b32 v28, v28, v27, s[44:45]
    v_smfmac_f32_32x32x32_bf16 a[64:79], v[132:135], v[88:95], v12
L_t3:
    s_cbranch_vccnz L_ret
    v_exp_f32 v54, v54
    v_exp_f32 v55, v55
    v_exp_f32 v56, v56
    v_sqrt_f32 v28, v28
    v_smfmac_f32_16x16x64_bf16 a[112:115], v[20:23], v[88:95], v12
    ds_read_b64_tr_b16 v[172:173], v9 offset:18432
    v_exp_f32 v57, v57
    v_exp_f32 v58, v58
    v_add_f32 v28, 0x358637bd, v28
    v_smfmac_f32_32x32x32_bf16 a[80:95], v[128:131], v[48:55], v12
    v_exp_f32 v59, v59
    v_exp_f32 v60, v60
    v_exp_f32 v61, v61
    v_rcp_f32 v28, v28
    v_smfmac_f32_16x16x64_bf16 a[116:119], v[20:23], v[48:55], v12
    ds_read_b64_tr_b16 v[174:175], v9 offset:18440
    v_exp_f32 v62, v62
    v_exp_f32 v63, v63
    v_cvt_pk_bf16_f32 v29, v28, v28
    v_cvt_pk_bf16_f32 v30, v28, v28
    v_mfma_f32_32x32x16_bf16 v[80:95], v[120:123], v[200:203], 4.0
    v_exp_f32 v64, v64
    v_exp_f32 v65, v65
    v_exp_f32 v66, v66
    v_permlane32_swap_b32 v29, v30
    v_mfma_f32_32x32x16_bf16 v[80:95], v[124:127], v[204:207], v[80:95]
    v_exp_f32 v67, v67
    v_exp_f32 v68, v68
    v_exp_f32 v69, v69
    v_and_b32 v32, v29, v10
    v_and_b32 v33, v29, v11
    v_smfmac_f32_32x32x32_bf16 a[80:95], v[132:135], v[56:63], v12
    v_exp_f32 v70, v70
    v_exp_f32 v71, v71
    v_exp_f32 v72, v72
    v_and_b32 v34, v30, v10
    v_and_b32 v35, v30, v11
    v_smfmac_f32_16x16x64_bf16 a[116:119], v[20:23], v[56:63], v12
    v_exp_f32 v73, v73
    v_exp_f32 v74, v74
    v_smfmac_f32_32x32x32_bf16 v[208:223], v[136:139], v[64:71], v12
    s_waitcnt lgkmcnt(4)
    v_exp_f32 v75, v75
    v_exp_f32 v76, v76
    v_exp_f32 v77, v77
    v_smfmac_f32_16x16x64_bf16 v[240:243], v[20:23], v[64:71], v12
    v_exp_f32 v78, v78
    v_mfma_f32_4x4x4_16b_bf16 v[176:179], v[160:161], v[32:33], 0
    v_exp_f32 v79, v79
    v_mfma_f32_32x32x16_bf16 v[48:63], v[120:123], a[120:123], 4.0
    v_exp_f32 v80, v80
    v_exp_f32 v81, v81
    v_exp_f32 v82, v82
    v_mfma_f32_32x32x16_bf16 v[48:63], v[124:127], a[124:127], v[48:63]
    v_exp_f32 v83, v83
    v_exp_f32 v84, v84
    v_exp_f32 v85, v85
    v_cvt_pk_bf16_f32 v96, v176, v177
    v_cvt_pk_bf16_f32 v97, v178, v179
    v_smfmac_f32_32x32x32_bf16 v[208:223], v[140:143], v[72:79], v12
    s_waitcnt vmcnt(10)
    v_exp_f32 v86, v86
    v_exp_f32 v87, v87
    v_exp_f32 v88, v88
    v_smfmac_f32_16x16x64_bf16 v[240:243], v[20:23], v[72:79], v12
    ds_read_b64_tr_b16 v[128:129], v3 offset:16384
    v_exp_f32 v89, v89
    v_mfma_f32_4x4x4_16b_bf16 v[180:183], v[162:163], v[32:33], 0
    v_exp_f32 v90, v90
    v_smfmac_f32_32x32x32_bf16 v[224:239], v[136:139], v[80:87], v12
    v_exp_f32 v91, v91
    v_exp_f32 v92, v92
    v_exp_f32 v93, v93
    v_smfmac_f32_16x16x64_bf16 v[244:247], v[20:23], v[80:87], v12
    ds_read_b64_tr_b16 v[130:131], v3 offset:16640
    v_exp_f32 v94, v94
    v_mfma_f32_4x4x4_16b_bf16 v[184:187], v[164:165], v[32:33], 0
    v_exp_f32 v95, v95
    v_cvt_pk_bf16_f32 v98, v180, v181
    v_cvt_pk_bf16_f32 v99, v182, v183
    v_mfma_f32_32x32x16_bf16 v[64:79], v[120:123], a[128:131], 4.0
    v_exp_f32 v48, v48
    v_exp_f32 v49, v49
    v_exp_f32 v50, v50
    v_mfma_f32_32x32x16_bf16 v[64:79], v[124:127], a[132:135], v[64:79]
    v_exp_f32 v51, v51
    v_exp_f32 v52, v52
    v_exp_f32 v53, v53
    v_cvt_pk_bf16_f32 v100, v184, v185
    v_cvt_pk_bf16_f32 v101, v186, v187
    v_smfmac_f32_32x32x32_bf16 v[224:239], v[140:143], v[88:95], v12
    v_exp_f32 v54, v54
    v_exp_f32 v55, v55
    v_exp_f32 v56, v56
    v_smfmac_f32_16x16x64_bf16 v[244:247], v[20:23], v[88:95], v12
    ds_read_b64_tr_b16 v[132:133], v3 offset:17408
    v_exp_f32 v57, v57
    v_mfma_f32_4x4x4_16b_bf16 v[188:191], v[166:167], v[32:33], 0
    v_exp_f32 v58, v58
    v_smfmac_f32_32x32x32_bf16 a[0:15], v[136:139], v[48:55], v12
    s_waitcnt lgkmcnt(3)
    v_exp_f32 v59, v59
    v_exp_f32 v60, v60
    v_exp_f32 v61, v61
    v_smfmac_f32_16x16x64_bf16 a[96:99], v[20:23], v[48:55], v12
    ds_read_b64_tr_b16 v[134:135], v3 offset:17664
    v_exp_f32 v62, v62
    v_mfma_f32_4x4x4_16b_bf16 v[176:179], v[168:169], v[34:35], 0
    v_exp_f32 v63, v63
    v_cvt_pk_bf16_f32 v102, v188, v189
    v_cvt_pk_bf16_f32 v103, v190, v191
    v_mfma_f32_32x32x16_bf16 v[80:95], v[120:123], a[136:139], 4.0
    v_exp_f32 v64, v64
    v_exp_f32 v65, v65
    v_exp_f32 v66, v66
    v_mfma_f32_32x32x16_bf16 v[80:95], v[124:127], a[140:143], v[80:95]
    v_exp_f32 v67, v67
    v_exp_f32 v68, v68
    v_exp_f32 v69, v69
    v_cvt_pk_bf16_f32 v104, v176, v177
    v_cvt_pk_bf16_f32 v105, v178, v179
    v_smfmac_f32_32x32x32_bf16 a[0:15], v[140:143], v[56:63], v12
    v_exp_f32 v70, v70
    v_exp_f32 v71, v71
    v_exp_f32 v72, v72
    v_smfmac_f32_16x16x64_bf16 a[96:99], v[20:23], v[56:63], v12
    v_exp_f32 v73, v73
    v_mfma_f32_4x4x4_16b_bf16 v[180:183], v[170:171], v[34:35], 0
    v_exp_f32 v74, v74
    v_smfmac_f32_32x32x32_bf16 a[16:31], v[136:139], v[64:71], v12
    v_exp_f32 v75, v75
    v_exp_f32 v76, v76
    v_exp_f32 v77, v77
    v_smfmac_f32_16x16x64_bf16 a[100:103], v[20:23], v[64:71], v12
    v_exp_f32 v78, v78
    v_mfma_f32_4x4x4_16b_bf16 v[184:187], v[172:173], v[34:35], 0
    v_exp_f32 v79, v79
    v_cvt_pk_bf16_f32 v106, v180, v181
    v_cvt_pk_bf16_f32 v107, v182, v183
    v_mfma_f32_32x32x16_bf16 v[48:63], v[120:123], a[144:147], 4.0
    v_exp_f32 v80, v80
    v_exp_f32 v81, v81
    v_exp_f32 v82, v82
    v_mfma_f32_32x32x16_bf16 v[48:63], v[124:127], a[148:151], v[48:63]
    v_exp_f32 v83, v83
    v_exp_f32 v84, v84
    v_exp_f32 v85, v85
    v_cvt_pk_bf16_f32 v108, v184, v185
    v_cvt_pk_bf16_f32 v109, v186, v187
    v_smfmac_f32_32x32x32_bf16 a[16:31], v[140:143], v[72:79], v12
    v_exp_f32 v86, v86
    v_exp_f32 v87, v87
    v_exp_f32 v88, v88
    v_smfmac_f32_16x16x64_bf16 a[100:103], v[20:23], v[72:79], v12
    v_exp_f32 v89, v89
    v_mfma_f32_4x4x4_16b_bf16 v[188:191], v[174:175], v[34:35], 0
    v_exp_f32 v90, v90
    v_smfmac_f32_32x32x32_bf16 a[32:47], v[136:139], v[80:87], v12
    v_exp_f32 v91, v91
    v_exp_f32 v92, v92
    v_exp_f32 v93, v93
    v_smfmac_f32_16x16x64_bf16 a[104:107], v[20:23], v[80:87], v12
    v_exp_f32 v94, v94
    v_exp_f32 v95, v95
    v_cvt_pk_bf16_f32 v110, v188, v189
    v_cvt_pk_bf16_f32 v111, v190, v191
    v_mfma_f32_32x32x16_bf16 v[64:79], v[120:123], a[152:155], 4.0
    v_exp_f32 v48, v48
    v_exp_f32 v49, v49
    v_exp_f32 v50, v50
    v_mfma_f32_32x32x16_bf16 v[64:79], v[124:127], a[156:159], v[64:79]
    v_exp_f32 v51, v51
    v_exp_f32 v52, v52
    v_exp_f32 v53, v53
    v_smfmac_f32_32x32x32_bf16 a[32:47], v[140:143], v[88:95], v12
    v_exp_f32 v54, v54
    v_exp_f32 v55, v55
    v_exp_f32 v56, v56
    v_smfmac_f32_16x16x64_bf16 a[104:107], v[20:23], v[88:95], v12
    v_exp_f32 v57, v57
    v_exp_f32 v58, v58
    v_smfmac_f32_32x32x32_bf16 a[48:63], v[136:139], v[48:55], v12
    v_exp_f32 v59, v59
    v_exp_f32 v60, v60
    v_exp_f32 v61, v61
    v_smfmac_f32_16x16x64_bf16 a[108:111], v[20:23], v[48:55], v12
    v_exp_f32 v62, v62
    v_exp_f32 v63, v63
    v_mfma_f32_32x32x16_bf16 v[80:95], v[120:123], a[160:163], 4.0
    v_exp_f32 v64, v64
    v_exp_f32 v65, v65
    v_exp_f32 v66, v66
    v_mfma_f32_32x32x16_bf16 v[80:95], v[124:127], a[164:167], v[80:95]
    v_exp_f32 v67, v67
    v_exp_f32 v68, v68
    v_exp_f32 v69, v69
    v_smfmac_f32_32x32x32_bf16 a[48:63], v[140:143], v[56:63], v12
    v_exp_f32 v70, v70
    v_exp_f32 v71, v71
    v_exp_f32 v72, v72
    v_smfmac_f32_16x16x64_bf16 a[108:111], v[20:23], v[56:63], v12
    v_exp_f32 v73, v73
    v_exp_f32 v74, v74
    v_smfmac_f32_32x32x32_bf16 a[64:79], v[136:139], v[64:71], v12
    v_exp_f32 v75, v75
    v_exp_f32 v76, v76
    v_exp_f32 v77, v77
    v_smfmac_f32_16x16x64_bf16 a[112:115], v[20:23], v[64:71], v12
    v_exp_f32 v78, v78
    v_exp_f32 v79, v79
    v_mfma_f32_32x32x16_bf16 v[48:63], v[96:99], v[192:195], 4.0
    v_exp_f32 v80, v80
    v_exp_f32 v81, v81
    v_exp_f32 v82, v82
    v_mfma_f32_32x32x16_bf16 v[48:63], v[100:103], v[196:199], v[48:63]
    v_exp_f32 v83, v83
    v_exp_f32 v84, v84
    v_exp_f32 v85, v85
    v_smfmac_f32_32x32x32_bf16 a[64:79], v[140:143], v[72:79], v12
    v_exp_f32 v86, v86
    v_exp_f32 v87, v87
    v_exp_f32 v88, v88
    v_smfmac_f32_16x16x64_bf16 a[112:115], v[20:23], v[72:79], v12
    v_exp_f32 v89, v89
    v_exp_f32 v90, v90
    v_smfmac_f32_32x32x32_bf16 a[80:95], v[136:139], v[80:87], v12
    s_waitcnt lgkmcnt(0)
    v_exp_f32 v91, v91
    v_exp_f32 v92, v92
    v_exp_f32 v93, v93
    v_smfmac_f32_16x16x64_bf16 a[116:119], v[20:23], v[80:87], v12
    v_exp_f32 v94, v94
    v_exp_f32 v95, v95
    v_mfma_f32_32x32x16_bf16 v[64:79], v[96:99], a[120:123], 4.0
    v_exp_f32 v48, v48
    v_exp_f32 v49, v49
    v_exp_f32 v50, v50
    v_mfma_f32_32x32x16_bf16 v[64:79], v[100:103], a[124:127], v[64:79]
    v_exp_f32 v51, v51
    v_exp_f32 v52, v52
    v_exp_f32 v53, v53
    v_smfmac_f32_32x32x32_bf16 a[80:95], v[140:143], v[88:95], v12
    s_waitcnt vmcnt(4)
    v_exp_f32 v54, v54
    v_exp_f32 v55, v55
    v_exp_f32 v56, v56
    v_smfmac_f32_16x16x64_bf16 a[116:119], v[20:23], v[88:95], v12
    ds_read_b128 v[144:147], v4 offset:24576
    v_exp_f32 v57, v57
    v_exp_f32 v58, v58
    v_smfmac_f32_32x32x32_bf16 v[208:223], v[128:131], v[48:55], v12
    v_exp_f32 v59, v59
    v_exp_f32 v60, v60
    v_exp_f32 v61, v61
    v_smfmac_f32_16x16x64_bf16 v[240:243], v[20:23], v[48:55], v12
    ds_read_b128 v[148:151], v5 offset:24576
    v_exp_f32 v62, v62
    v_exp_f32 v63, v63
    v_mfma_f32_32x32x16_bf16 v[80:95], v[96:99], a[128:131], 4.0
    v_exp_f32 v64, v64
    v_exp_f32 v65, v65
    v_exp_f32 v66, v66
    v_mfma_f32_32x32x16_bf16 v[80:95], v[100:103], a[132:135], v[80:95]
    v_exp_f32 v67, v67
    v_exp_f32 v68, v68
    v_exp_f32 v69, v69
    v_smfmac_f32_32x32x32_bf16 v[208:223], v[132:135], v[56:63], v12
    v_exp_f32 v70, v70
    v_exp_f32 v71, v71
    v_exp_f32 v72, v72
    v_smfmac_f32_16x16x64_bf16 v[240:243], v[20:23], v[56:63], v12
    ds_read_b128 v[152:155], v6 offset:24576
    v_exp_f32 v73, v73
    v_exp_f32 v74, v74
    v_smfmac_f32_32x32x32_bf16 a[0:15], v[128:131], v[64:71], v12
    v_exp_f32 v75, v75
    v_exp_f32 v76, v76
    v_exp_f32 v77, v77
    v_smfmac_f32_16x16x64_bf16 a[96:99], v[20:23], v[64:71], v12
    ds_read_b128 v[156:159], v7 offset:24576
    v_exp_f32 v78, v78
    v_exp_f32 v79, v79
    v_mfma_f32_32x32x16_bf16 v[48:63], v[96:99], a[136:139], 4.0
    v_exp_f32 v80, v80
    v_exp_f32 v81, v81
    v_exp_f32 v82, v82
    v_mfma_f32_32x32x16_bf16 v[48:63], v[100:103], a[140:143], v[48:63]
    v_exp_f32 v83, v83
    v_exp_f32 v84, v84
    v_exp_f32 v85, v85
    v_smfmac_f32_32x32x32_bf16 a[0:15], v[132:135], v[72:79], v12
    v_exp_f32 v86, v86
    v_exp_f32 v87, v87
    v_exp_f32 v88, v88
    v_smfmac_f32_16x16x64_bf16 a[96:99], v[20:23], v[72:79], v12
    ds_read_b64_tr_b16 v[136:137], v3 offset:18432
    v_exp_f32 v89, v89
    v_exp_f32 v90, v90
    v_smfmac_f32_32x32x32_bf16 a[16:31], v[128:131], v[80:87], v12
    s_waitcnt lgkmcnt(4)
    v_exp_f32 v91, v91
    v_exp_f32 v92, v92
    v_exp_f32 v93, v93
    v_smfmac_f32_16x16x64_bf16 a[100:103], v[20:23], v[80:87], v12
    ds_read_b64_tr_b16 v[138:139], v3 offset:18688
    v_exp_f32 v94, v94
    v_mfma_f32_4x4x4_16b_bf16 v[24:27], v[144:145], v[144:145], 0
    v_exp_f32 v95, v95
    v_mfma_f32_32x32x16_bf16 v[64:79], v[96:99], a[144:147], 4.0
    v_exp_f32 v48, v48
    v_exp_f32 v49, v49
    v_exp_f32 v50, v50
    v_mfma_f32_32x32x16_bf16 v[64:79], v[100:103], a[148:151], v[64:79]
    v_exp_f32 v51, v51
    v_exp_f32 v52, v52
    v_exp_f32 v53, v53
    v_smfmac_f32_32x32x32_bf16 a[16:31], v[132:135], v[88:95], v12
    v_exp_f32 v54, v54
    v_exp_f32 v55, v55
    v_exp_f32 v56, v56
    v_smfmac_f32_16x16x64_bf16 a[100:103], v[20:23], v[88:95], v12
    ds_read_b64_tr_b16 v[140:141], v3 offset:19456
    v_exp_f32 v57, v57
    v_mfma_f32_4x4x4_16b_bf16 v[24:27], v[146:147], v[146:147], v[24:27]
    v_exp_f32 v58, v58
    v_smfmac_f32_32x32x32_bf16 a[32:47], v[128:131], v[48:55], v12
    s_waitcnt lgkmcnt(5)
    v_exp_f32 v59, v59
    v_exp_f32 v60, v60
    v_exp_f32 v61, v61
    v_smfmac_f32_16x16x64_bf16 a[104:107], v[20:23], v[48:55], v12
    ds_read_b64_tr_b16 v[142:143], v3 offset:19712
    v_exp_f32 v62, v62
    v_mfma_f32_4x4x4_16b_bf16 v[24:27], v[148:149], v[148:149], v[24:27]
    v_exp_f32 v63, v63
    v_mfma_f32_32x32x16_bf16 v[80:95], v[96:99], a[152:155], 4.0
    v_exp_f32 v64, v64
    v_exp_f32 v65, v65
    v_exp_f32 v66, v66
    v_mfma_f32_32x32x16_bf16 v[80:95], v[100:103], a[156:159], v[80:95]
    v_exp_f32 v67, v67
    v_exp_f32 v68, v68
    v_exp_f32 v69, v69
    v_smfmac_f32_32x32x32_bf16 a[32:47], v[132:135], v[56:63], v12
    v_exp_f32 v70, v70
    v_exp_f32 v71, v71
    v_exp_f32 v72, v72
    v_smfmac_f32_16x16x64_bf16 a[104:107], v[20:23], v[56:63], v12
    ds_read_b64_tr_b16 v[160:161], v8 offset:24576
    v_exp_f32 v73, v73
    v_mfma_f32_4x4x4_16b_bf16 v[24:27], v[150:151], v[150:151], v[24:27]
    v_exp_f32 v74, v74
    v_smfmac_f32_32x32x32_bf16 a[48:63], v[128:131], v[64:71], v12
    s_waitcnt lgkmcnt(6)
    v_exp_f32 v75, v75
    v_exp_f32 v76, v76
    v_exp_f32 v77, v77
    v_smfmac_f32_16x16x64_bf16 a[108:111], v[20:23], v[64:71], v12
    ds_read_b64_tr_b16 v[162:163], v8 offset:24584
    v_exp_f32 v78, v78
    v_mfma_f32_4x4x4_16b_bf16 v[24:27], v[152:153], v[152:153], v[24:27]
    v_exp_f32 v79, v79
    v_mfma_f32_32x32x16_bf16 v[48:63], v[96:99], a[160:163], 4.0
    v_exp_f32 v80, v80
    v_exp_f32 v81, v81
    v_exp_f32 v82, v82
    v_mfma_f32_32x32x16_bf16 v[48:63], v[100:103], a[164:167], v[48:63]
    v_exp_f32 v83, v83
    v_exp_f32 v84, v84
    v_exp_f32 v85, v85
    v_smfmac_f32_32x32x32_bf16 a[48:63], v[132:135], v[72:79], v12
    v_exp_f32 v86, v86
    v_exp_f32 v87, v87
    v_exp_f32 v88, v88
    v_smfmac_f32_16x16x64_bf16 a[108:111], v[20:23], v[72:79], v12
    ds_read_b64_tr_b16 v[164:165], v9 offset:24576
    v_exp_f32 v89, v89
    v_mfma_f32_4x4x4_16b_bf16 v[24:27], v[154:155], v[154:155], v[24:27]
    v_exp_f32 v90, v90
    v_smfmac_f32_32x32x32_bf16 a[64:79], v[128:131], v[80:87], v12
    s_waitcnt lgkmcnt(7)
    v_exp_f32 v91, v91
    v_exp_f32 v92, v92
    v_exp_f32 v93, v93
    v_smfmac_f32_16x16x64_bf16 a[112:115], v[20:23], v[80:87], v12
    ds_read_b64_tr_b16 v[166:167], v9 offset:24584
    v_exp_f32 v94, v94
    v_mfma_f32_4x4x4_16b_bf16 v[24:27], v[156:157], v[156:157], v[24:27]
    v_exp_f32 v95, v95
    v_mfma_f32_32x32x16_bf16 v[64:79], v[104:107], v[192:195], 4.0
    v_exp_f32 v48, v48
    v_exp_f32 v49, v49
    v_exp_f32 v50, v50
    v_mfma_f32_32x32x16_bf16 v[64:79], v[108:111], v[196:199], v[64:79]
    v_exp_f32 v51, v51
    v_exp_f32 v52, v52
    v_exp_f32 v53, v53
    v_smfmac_f32_32x32x32_bf16 a[64:79], v[132:135], v[88:95], v12
    v_exp_f32 v54, v54
    v_exp_f32 v55, v55
    v_exp_f32 v56, v56
    v_smfmac_f32_16x16x64_bf16 a[112:115], v[20:23], v[88:95], v12
    ds_read_b64_tr_b16 v[168:169], v8 offset:26624
    v_exp_f32 v57, v57
    v_mfma_f32_4x4x4_16b_bf16 v[24:27], v[158:159], v[158:159], v[24:27]
    v_exp_f32 v58, v58
    v_smfmac_f32_32x32x32_bf16 a[80:95], v[128:131], v[48:55], v12
    v_exp_f32 v59, v59
    v_exp_f32 v60, v60
    v_exp_f32 v61, v61
    v_smfmac_f32_16x16x64_bf16 a[116:119], v[20:23], v[48:55], v12
    ds_read_b64_tr_b16 v[170:171], v8 offset:26632
    v_exp_f32 v62, v62
    v_exp_f32 v63, v63
    v_cndmask_b32 v28, v24, v25, s[40:41]
    v_mfma_f32_32x32x16_bf16 v[80:95], v[104:107], a[120:123], 4.0
    v_exp_f32 v64, v64
    v_exp_f32 v65, v65
    v_exp_f32 v66, v66
    v_cndmask_b32 v28, v28, v26, s[42:43]
    v_mfma_f32_32x32x16_bf16 v[80:95], v[108:111], a[124:127], v[80:95]
    s_waitcnt lgkmcnt(6)
    v_exp_f32 v67, v67
    v_exp_f32 v68, v68
    v_exp_f32 v69, v69
    v_cndmask_b32 v28, v28, v27, s[44:45]
    v_smfmac_f32_32x32x32_bf16 a[80:95], v[132:135], v[56:63], v12
    v_exp_f32 v70, v70
    v_exp_f32 v71, v71
    v_exp_f32 v72, v72
    v_sqrt_f32 v28, v28
    v_smfmac_f32_16x16x64_bf16 a[116:119], v[20:23], v[56:63], v12
    ds_read_b64_tr_b16 v[172:173], v9 offset:26624
    v_exp_f32 v73, v73
    v_exp_f32 v74, v74
    v_add_f32 v28, 0x358637bd, v28
    v_smfmac_f32_32x32x32_bf16 v[208:223], v[136:139], v[64:71], v12
    v_exp_f32 v75, v75
    v_exp_f32 v76, v76
    v_exp_f32 v77, v77
    v_rcp_f32 v28, v28
    v_smfmac_f32_16x16x64_bf16 v[240:243], v[20:23], v[64:71], v12
    ds_read_b64_tr_b16 v[174:175], v9 offset:26632
    v_exp_f32 v78, v78
    v_exp_f32 v79, v79
    v_cvt_pk_bf16_f32 v29, v28, v28
    v_cvt_pk_bf16_f32 v30, v28, v28
    v_mfma_f32_32x32x16_bf16 v[48:63], v[104:107], a[128:131], 4.0
    v_exp_f32 v80, v80
    v_exp_f32 v81, v81
    v_exp_f32 v82, v82
    v_permlane32_swap_b32 v29, v30
    v_mfma_f32_32x32x16_bf16 v[48:63], v[108:111], a[132:135], v[48:63]
    v_exp_f32 v83, v83
    v_exp_f32 v84, v84
    v_exp_f32 v85, v85
    v_and_b32 v32, v29, v10
    v_and_b32 v33, v29, v11
    v_smfmac_f32_32x32x32_bf16 v[208:223], v[140:143], v[72:79], v12
    v_exp_f32 v86, v86
    v_exp_f32 v87, v87
    v_exp_f32 v88, v88
    v_and_b32 v34, v30, v10
    v_and_b32 v35, v30, v11
    v_smfmac_f32_16x16x64_bf16 v[240:243], v[20:23], v[72:79], v12
    v_exp_f32 v89, v89
    v_exp_f32 v90, v90
    v_smfmac_f32_32x32x32_bf16 a[0:15], v[136:139], v[80:87], v12
    s_waitcnt lgkmcnt(4)
    v_exp_f32 v91, v91
    v_exp_f32 v92, v92
    v_exp_f32 v93, v93
    v_smfmac_f32_16x16x64_bf16 a[96:99], v[20:23], v[80:87], v12
    v_exp_f32 v94, v94
    v_mfma_f32_4x4x4_16b_bf16 v[176:179], v[160:161], v[32:33], 0
    v_exp_f32 v95, v95
    v_mfma_f32_32x32x16_bf16 v[64:79], v[104:107], a[136:139], 4.0
    v_exp_f32 v48, v48
    v_exp_f32 v49, v49
    v_exp_f32 v50, v50
    v_mfma_f32_32x32x16_bf16 v[64:79], v[108:111], a[140:143], v[64:79]
    v_exp_f32 v51, v51
    v_exp_f32 v52, v52
    v_exp_f32 v53, v53
    v_cvt_pk_bf16_f32 v112, v176, v177
    v_cvt_pk_bf16_f32 v113, v178, v179
    v_smfmac_f32_32x32x32_bf16 a[0:15], v[140:143], v[88:95], v12
    s_waitcnt vmcnt(2)
    v_exp_f32 v54, v54
    v_exp_f32 v55, v55
    v_exp_f32 v56, v56
    v_smfmac_f32_16x16x64_bf16 a[96:99], v[20:23], v[88:95], v12
    ds_read_b64_tr_b16 a[168:169], v3 offset:24576
    v_exp_f32 v57, v57
    v_mfma_f32_4x4x4_16b_bf16 v[180:183], v[162:163], v[32:33], 0
    v_exp_f32 v58, v58
    v_smfmac_f32_32x32x32_bf16 a[16:31], v[136:139], v[48:55], v12
    v_exp_f32 v59, v59
    v_exp_f32 v60, v60
    v_exp_f32 v61, v61
    v_smfmac_f32_16x16x64_bf16 a[100:103], v[20:23], v[48:55], v12
    ds_read_b64_tr_b16 a[170:171], v3 offset:24832
    v_exp_f32 v62, v62
    v_mfma_f32_4x4x4_16b_bf16 v[184:187], v[164:165], v[32:33], 0
    v_exp_f32 v63, v63
    v_cvt_pk_bf16_f32 v114, v180, v181
    v_cvt_pk_bf16_f32 v115, v182, v183
    v_mfma_f32_32x32x16_bf16 v[80:95], v[104:107], a[144:147], 4.0
    v_exp_f32 v64, v64
    v_exp_f32 v65, v65
    v_exp_f32 v66, v66
    v_mfma_f32_32x32x16_bf16 v[80:95], v[108:111], a[148:151], v[80:95]
    v_exp_f32 v67, v67
    v_exp_f32 v68, v68
    v_exp_f32 v69, v69
    v_cvt_pk_bf16_f32 v116, v184, v185
    v_cvt_pk_bf16_f32 v117, v186, v187
    v_smfmac_f32_32x32x32_bf16 a[16:31], v[140:143], v[56:63], v12
    v_exp_f32 v70, v70
    v_exp_f32 v71, v71
    v_exp_f32 v72, v72
    v_smfmac_f32_16x16x64_bf16 a[100:103], v[20:23], v[56:63], v12
    ds_read_b64_tr_b16 a[172:173], v3 offset:25600
    v_exp_f32 v73, v73
    v_mfma_f32_4x4x4_16b_bf16 v[188:191], v[166:167], v[32:33], 0
    v_exp_f32 v74, v74
    v_smfmac_f32_32x32x32_bf16 a[32:47], v[136:139], v[64:71], v12
    s_waitcnt lgkmcnt(3)
    v_exp_f32 v75, v75
    v_exp_f32 v76, v76
    v_exp_f32 v77, v77
    v_smfmac_f32_16x16x64_bf16 a[104:107], v[20:23], v[64:71], v12
    ds_read_b64_tr_b16 a[174:175], v3 offset:25856
    v_exp_f32 v78, v78
    v_mfma_f32_4x4x4_16b_bf16 v[176:179], v[168:169], v[34:35], 0
    v_exp_f32 v79, v79
    v_cvt_pk_bf16_f32 v118, v188, v189
    v_cvt_pk_bf16_f32 v119, v190, v191
    v_mfma_f32_32x32x16_bf16 v[48:63], v[104:107], a[152:155], 4.0
    v_exp_f32 v80, v80
    v_exp_f32 v81, v81
    v_exp_f32 v82, v82
    v_mfma_f32_32x32x16_bf16 v[48:63], v[108:111], a[156:159], v[48:63]
    v_exp_f32 v83, v83
    v_exp_f32 v84, v84
    v_exp_f32 v85, v85
    v_cvt_pk_bf16_f32 v120, v176, v177
    v_cvt_pk_bf16_f32 v121, v178, v179
    v_smfmac_f32_32x32x32_bf16 a[32:47], v[140:143], v[72:79], v12
    s_waitcnt vmcnt(0)
    v_exp_f32 v86, v86
    v_exp_f32 v87, v87
    v_exp_f32 v88, v88
    v_smfmac_f32_16x16x64_bf16 a[104:107], v[20:23], v[72:79], v12
    ds_read_b64_tr_b16 a[176:177], v3 offset:26624
    v_exp_f32 v89, v89
    v_mfma_f32_4x4x4_16b_bf16 v[180:183], v[170:171], v[34:35], 0
    v_exp_f32 v90, v90
    v_smfmac_f32_32x32x32_bf16 a[48:63], v[136:139], v[80:87], v12
    v_exp_f32 v91, v91
    v_exp_f32 v92, v92
    v_exp_f32 v93, v93
    v_smfmac_f32_16x16x64_bf16 a[108:111], v[20:23], v[80:87], v12
    ds_read_b64_tr_b16 a[178:179], v3 offset:26880
    v_exp_f32 v94, v94
    v_mfma_f32_4x4x4_16b_bf16 v[184:187], v[172:173], v[34:35], 0
    v_exp_f32 v95, v95
    v_cvt_pk_bf16_f32 v122, v180, v181
    v_cvt_pk_bf16_f32 v123, v182, v183
    v_mfma_f32_32x32x16_bf16 v[64:79], v[104:107], a[160:163], 4.0
    v_exp_f32 v48, v48
    v_exp_f32 v49, v49
    v_exp_f32 v50, v50
    v_mfma_f32_32x32x16_bf16 v[64:79], v[108:111], a[164:167], v[64:79]
    v_exp_f32 v51, v51
    v_exp_f32 v52, v52
    v_exp_f32 v53, v53
    v_cvt_pk_bf16_f32 v124, v184, v185
    v_cvt_pk_bf16_f32 v125, v186, v187
    v_smfmac_f32_32x32x32_bf16 a[48:63], v[140:143], v[88:95], v12
    v_exp_f32 v54, v54
    v_exp_f32 v55, v55
    v_exp_f32 v56, v56
    v_smfmac_f32_16x16x64_bf16 a[108:111], v[20:23], v[88:95], v12
    ds_read_b64_tr_b16 a[180:181], v3 offset:27648
    v_exp_f32 v57, v57
    v_mfma_f32_4x4x4_16b_bf16 v[188:191], v[174:175], v[34:35], 0
    v_exp_f32 v58, v58
    v_smfmac_f32_32x32x32_bf16 a[64:79], v[136:139], v[48:55], v12
    v_exp_f32 v59, v59
    v_exp_f32 v60, v60
    v_exp_f32 v61, v61
    v_smfmac_f32_16x16x64_bf16 a[112:115], v[20:23], v[48:55], v12
    ds_read_b64_tr_b16 a[182:183], v3 offset:27904
    v_exp_f32 v62, v62
    v_exp_f32 v63, v63
    v_cvt_pk_bf16_f32 v126, v188, v189
    v_cvt_pk_bf16_f32 v127, v190, v191
    v_mfma_f32_32x32x16_bf16 v[80:95], v[112:115], a[120:123], 4.0
    v_exp_f32 v64, v64
    v_exp_f32 v65, v65
    v_exp_f32 v66, v66
    v_mfma_f32_32x32x16_bf16 v[80:95], v[116:119], a[124:127], v[80:95]
    v_exp_f32 v67, v67
    v_exp_f32 v68, v68
    v_exp_f32 v69, v69
    v_smfmac_f32_32x32x32_bf16 a[64:79], v[140:143], v[56:63], v12
    v_exp_f32 v70, v70
    v_exp_f32 v71, v71
    v_exp_f32 v72, v72
    v_smfmac_f32_16x16x64_bf16 a[112:115], v[20:23], v[56:63], v12
    v_exp_f32 v73, v73
    v_exp_f32 v74, v74
    v_smfmac_f32_32x32x32_bf16 a[80:95], v[136:139], v[64:71], v12
    s_waitcnt lgkmcnt(4)
    v_exp_f32 v75, v75
    v_exp_f32 v76, v76
    v_exp_f32 v77, v77
    v_smfmac_f32_16x16x64_bf16 a[116:119], v[20:23], v[64:71], v12
    v_exp_f32 v78, v78
    v_exp_f32 v79, v79
    v_mfma_f32_32x32x16_bf16 v[48:63], v[120:123], a[120:123], 4.0
    v_exp_f32 v80, v80
    v_exp_f32 v81, v81
    v_exp_f32 v82, v82
    v_mfma_f32_32x32x16_bf16 v[48:63], v[124:127], a[124:127], v[48:63]
    v_exp_f32 v83, v83
    v_exp_f32 v84, v84
    v_exp_f32 v85, v85
    v_smfmac_f32_32x32x32_bf16 a[80:95], v[140:143], v[72:79], v12
    s_waitcnt lgkmcnt(0)
    v_exp_f32 v86, v86
    v_exp_f32 v87, v87
    v_exp_f32 v88, v88
    v_smfmac_f32_16x16x64_bf16 a[116:119], v[20:23], v[72:79], v12
    v_exp_f32 v89, v89
    v_exp_f32 v90, v90
    v_smfmac_f32_32x32x32_bf16 a[0:15], a[168:171], v[80:87], v12
    v_exp_f32 v91, v91
    v_exp_f32 v92, v92
    v_exp_f32 v93, v93
    v_smfmac_f32_16x16x64_bf16 a[96:99], v[20:23], v[80:87], v12
    v_exp_f32 v94, v94
    v_exp_f32 v95, v95
    v_mfma_f32_32x32x16_bf16 v[64:79], v[112:115], a[136:139], 4.0
    v_exp_f32 v48, v48
    v_exp_f32 v49, v49
    v_exp_f32 v50, v50
    v_mfma_f32_32x32x16_bf16 v[64:79], v[116:119], a[140:143], v[64:79]
    v_exp_f32 v51, v51
    v_exp_f32 v52, v52
    v_exp_f32 v53, v53
    v_smfmac_f32_32x32x32_bf16 a[0:15], a[172:175], v[88:95], v12
    v_exp_f32 v54, v54
    v_exp_f32 v55, v55
    v_exp_f32 v56, v56
    v_smfmac_f32_16x16x64_bf16 a[96:99], v[20:23], v[88:95], v12
    v_exp_f32 v57, v57
    v_exp_f32 v58, v58
    v_smfmac_f32_32x32x32_bf16 a[0:15], a[176:179], v[48:55], v12
    v_exp_f32 v59, v59
    v_exp_f32 v60, v60
    v_exp_f32 v61, v61
    v_smfmac_f32_16x16x64_bf16 a[96:99], v[20:23], v[48:55], v12
    v_exp_f32 v62, v62
    v_exp_f32 v63, v63
    v_mfma_f32_32x32x16_bf16 v[80:95], v[120:123], a[136:139], 4.0
    v_exp_f32 v64, v64
    v_exp_f32 v65, v65
    v_exp_f32 v66, v66
    v_mfma_f32_32x32x16_bf16 v[80:95], v[124:127], a[140:143], v[80:95]
    v_exp_f32 v67, v67
    v_exp_f32 v68, v68
    v_exp_f32 v69, v69
    v_smfmac_f32_32x32x32_bf16 a[0:15], a[180:183], v[56:63], v12
    v_exp_f32 v70, v70
    v_exp_f32 v71, v71
    v_exp_f32 v72, v72
    v_smfmac_f32_16x16x64_bf16 a[96:99], v[20:23], v[56:63], v12
    v_exp_f32 v73, v73
    v_exp_f32 v74, v74
    v_smfmac_f32_32x32x32_bf16 a[32:47], a[168:171], v[64:71], v12
    v_exp_f32 v75, v75
    v_exp_f32 v76, v76
    v_exp_f32 v77, v77
    v_smfmac_f32_16x16x64_bf16 a[104:107], v[20:23], v[64:71], v12
    v_exp_f32 v78, v78
    v_exp_f32 v79, v79
    v_mfma_f32_32x32x16_bf16 v[48:63], v[112:115], a[152:155], 4.0
    v_exp_f32 v80, v80
    v_exp_f32 v81, v81
    v_exp_f32 v82, v82
    v_mfma_f32_32x32x16_bf16 v[48:63], v[116:119], a[156:159], v[48:63]
    ds_write_b128 v14, a[0:3]
    v_exp_f32 v83, v83
    v_exp_f32 v84, v84
    v_exp_f32 v85, v85
    v_smfmac_f32_32x32x32_bf16 a[32:47], a[172:175], v[72:79], v12
    v_exp_f32 v86, v86
    v_exp_f32 v87, v87
    v_exp_f32 v88, v88
    v_smfmac_f32_16x16x64_bf16 a[104:107], v[20:23], v[72:79], v12
    ds_write_b128 v14, a[4:7] offset:1024
    v_exp_f32 v89, v89
    v_exp_f32 v90, v90
    v_smfmac_f32_32x32x32_bf16 a[32:47], a[176:179], v[80:87], v12
    v_exp_f32 v91, v91
    v_exp_f32 v92, v92
    v_exp_f32 v93, v93
    v_smfmac_f32_16x16x64_bf16 a[104:107], v[20:23], v[80:87], v12
    ds_write_b128 v14, a[8:11] offset:2048
    v_exp_f32 v94, v94
    v_exp_f32 v95, v95
    v_mfma_f32_32x32x16_bf16 v[64:79], v[120:123], a[152:155], 4.0
    v_exp_f32 v48, v48
    v_exp_f32 v49, v49
    v_exp_f32 v50, v50
    v_mfma_f32_32x32x16_bf16 v[64:79], v[124:127], a[156:159], v[64:79]
    v_exp_f32 v51, v51
    v_exp_f32 v52, v52
    v_exp_f32 v53, v53
    v_smfmac_f32_32x32x32_bf16 a[32:47], a[180:183], v[88:95], v12
    v_exp_f32 v54, v54
    v_exp_f32 v55, v55
    v_exp_f32 v56, v56
    v_smfmac_f32_16x16x64_bf16 a[104:107], v[20:23], v[88:95], v12
    ds_write_b128 v14, a[12:15] offset:3072
    v_exp_f32 v57, v57
    v_exp_f32 v58, v58
    v_smfmac_f32_32x32x32_bf16 a[64:79], a[168:171], v[48:55], v12
    v_exp_f32 v59, v59
    v_exp_f32 v60, v60
    v_exp_f32 v61, v61
    v_smfmac_f32_16x16x64_bf16 a[112:115], v[20:23], v[48:55], v12
    ds_write_b32 v14, a96 offset:4096
    v_exp_f32 v62, v62
    v_exp_f32 v63, v63
    v_mfma_f32_32x32x16_bf16 v[80:95], v[112:115], v[192:195], 4.0
    v_exp_f32 v64, v64
    v_exp_f32 v65, v65
    v_exp_f32 v66, v66
    v_mfma_f32_32x32x16_bf16 v[80:95], v[116:119], v[196:199], v[80:95]
    ds_write_b128 v14, a[32:35] offset:10240
    v_exp_f32 v67, v67
    v_exp_f32 v68, v68
    v_exp_f32 v69, v69
    v_smfmac_f32_32x32x32_bf16 a[64:79], a[172:175], v[56:63], v12
L_t4:
    s_cbranch_vccnz L_ret
    v_exp_f32 v70, v70
    v_exp_f32 v71, v71
    v_exp_f32 v72, v72
    v_smfmac_f32_16x16x64_bf16 a[112:115], v[20:23], v[56:63], v12
    ds_write_b128 v14, a[36:39] offset:11264
    v_exp_f32 v73, v73
    v_exp_f32 v74, v74
    v_smfmac_f32_32x32x32_bf16 a[64:79], a[176:179], v[64:71], v12
    v_exp_f32 v75, v75
    v_exp_f32 v76, v76
    v_exp_f32 v77, v77
    v_smfmac_f32_16x16x64_bf16 a[112:115], v[20:23], v[64:71], v12
    ds_write_b128 v14, a[40:43] offset:12288
    v_exp_f32 v78, v78
    v_exp_f32 v79, v79
    v_mfma_f32_32x32x16_bf16 v[48:63], v[120:123], v[192:195], 4.0
    v_exp_f32 v80, v80
    v_exp_f32 v81, v81
    v_exp_f32 v82, v82
    v_mfma_f32_32x32x16_bf16 v[48:63], v[124:127], v[196:199], v[48:63]
    v_exp_f32 v83, v83
    v_exp_f32 v84, v84
    v_exp_f32 v85, v85
    v_smfmac_f32_32x32x32_bf16 a[64:79], a[180:183], v[72:79], v12
    v_exp_f32 v86, v86
    v_exp_f32 v87, v87
    v_exp_f32 v88, v88
    v_smfmac_f32_16x16x64_bf16 a[112:115], v[20:23], v[72:79], v12
    ds_write_b128 v14, a[44:47] offset:13312
    v_exp_f32 v89, v89
    v_exp_f32 v90, v90
    v_smfmac_f32_32x32x32_bf16 v[208:223], a[168:171], v[80:87], v12
    v_exp_f32 v91, v91
    v_exp_f32 v92, v92
    v_exp_f32 v93, v93
    v_smfmac_f32_16x16x64_bf16 v[240:243], v[20:23], v[80:87], v12
    ds_write_b32 v14, a104 offset:14336
    v_exp_f32 v94, v94
    v_exp_f32 v95, v95
    v_mfma_f32_32x32x16_bf16 v[64:79], v[112:115], a[128:131], 4.0
    v_exp_f32 v48, v48
    v_exp_f32 v49, v49
    v_exp_f32 v50, v50
    v_mfma_f32_32x32x16_bf16 v[64:79], v[116:119], a[132:135], v[64:79]
    ds_write_b128 v14, a[64:67] offset:20480
    v_exp_f32 v51, v51
    v_exp_f32 v52, v52
    v_exp_f32 v53, v53
    v_smfmac_f32_32x32x32_bf16 v[208:223], a[172:175], v[88:95], v12
    ds_write_b128 v14, a[68:71] offset:21504
    v_exp_f32 v54, v54
    v_exp_f32 v55, v55
    v_exp_f32 v56, v56
    v_smfmac_f32_16x16x64_bf16 v[240:243], v[20:23], v[88:95], v12
    ds_write_b128 v14, a[72:75] offset:22528
    v_exp_f32 v57, v57
    v_exp_f32 v58, v58
    v_smfmac_f32_32x32x32_bf16 v[208:223], a[176:179], v[48:55], v12
    ds_write_b128 v14, a[76:79] offset:23552
    v_exp_f32 v59, v59
    v_exp_f32 v60, v60
    v_exp_f32 v61, v61
    v_smfmac_f32_16x16x64_bf16 v[240:243], v[20:23], v[48:55], v12
    ds_write_b32 v14, a112 offset:24576
    v_exp_f32 v62, v62
    v_exp_f32 v63, v63
    v_mfma_f32_32x32x16_bf16 v[80:95], v[120:123], a[128:131], 4.0
    v_exp_f32 v64, v64
    v_exp_f32 v65, v65
    v_exp_f32 v66, v66
    v_mfma_f32_32x32x16_bf16 v[80:95], v[124:127], a[132:135], v[80:95]
    s_waitcnt lgkmcnt(0)
    v_exp_f32 v67, v67
    v_exp_f32 v68, v68
    v_exp_f32 v69, v69
    v_smfmac_f32_32x32x32_bf16 v[208:223], a[180:183], v[56:63], v12
    s_barrier
    ds_read_b128 v[144:147], v248
    v_exp_f32 v70, v70
    v_exp_f32 v71, v71
    v_exp_f32 v72, v72
    v_smfmac_f32_16x16x64_bf16 v[240:243], v[20:23], v[56:63], v12
    ds_read_b128 v[148:151], v248 offset:1024
    ds_read_b128 v[152:155], v248 offset:2048
    v_exp_f32 v73, v73
    v_exp_f32 v74, v74
    v_smfmac_f32_32x32x32_bf16 a[16:31], a[168:171], v[64:71], v12
    ds_read_b128 v[156:159], v248 offset:3072
    ds_read_b32 v8, v248 offset:4096
    v_exp_f32 v75, v75
    v_exp_f32 v76, v76
    v_exp_f32 v77, v77
    v_smfmac_f32_16x16x64_bf16 a[100:103], v[20:23], v[64:71], v12
    ds_read_b128 v[160:163], v249 offset:10240
    ds_read_b128 v[164:167], v249 offset:11264
    v_exp_f32 v78, v78
    v_exp_f32 v79, v79
    v_mfma_f32_32x32x16_bf16 v[48:63], v[112:115], a[144:147], 4.0
    ds_read_b128 v[168:171], v249 offset:12288
    v_exp_f32 v80, v80
    v_exp_f32 v81, v81
    v_exp_f32 v82, v82
    v_mfma_f32_32x32x16_bf16 v[48:63], v[116:119], a[148:151], v[48:63]
    ds_read_b128 v[172:175], v249 offset:13312
    v_exp_f32 v83, v83
    v_exp_f32 v84, v84
    v_exp_f32 v85, v85
    v_smfmac_f32_32x32x32_bf16 a[16:31], a[172:175], v[72:79], v12
    ds_read_b32 v9, v249 offset:14336
    ds_read_b128 v[176:179], v250 offset:20480
    v_exp_f32 v86, v86
    v_exp_f32 v87, v87
    v_exp_f32 v88, v88
    v_smfmac_f32_16x16x64_bf16 a[100:103], v[20:23], v[72:79], v12
    s_waitcnt lgkmcnt(6)
    ds_read_b128 v[180:183], v250 offset:21504
    v_exp_f32 v89, v89
    v_exp_f32 v90, v90
    v_pk_add_f32 v[208:209], v[208:209], v[144:145]
    v_pk_add_f32 v[210:211], v[210:211], v[146:147]
    v_pk_add_f32 v[212:213], v[212:213], v[148:149]
    v_pk_add_f32 v[214:215], v[214:215], v[150:151]
    v_pk_add_f32 v[216:217], v[216:217], v[152:153]
    v_pk_add_f32 v[218:219], v[218:219], v[154:155]
    v_smfmac_f32_32x32x32_bf16 a[16:31], a[176:179], v[80:87], v12
    ds_read_b128 v[184:187], v250 offset:22528
    v_exp_f32 v91, v91
    v_exp_f32 v92, v92
    v_exp_f32 v93, v93
    v_smfmac_f32_16x16x64_bf16 a[100:103], v[20:23], v[80:87], v12
    s_waitcnt lgkmcnt(3)
    ds_read_b128 v[188:191], v250 offset:23552
    v_exp_f32 v94, v94
    v_exp_f32 v95, v95
    v_pk_add_f32 v[220:221], v[220:221], v[156:157]
    v_pk_add_f32 v[222:223], v[222:223], v[158:159]
    v_pk_add_f32 v[208:209], v[208:209], v[160:161]
    v_pk_add_f32 v[210:211], v[210:211], v[162:163]
    v_pk_add_f32 v[212:213], v[212:213], v[164:165]
    v_pk_add_f32 v[214:215], v[214:215], v[166:167]
    v_mfma_f32_32x32x16_bf16 v[64:79], v[120:123], a[144:147], 4.0
    ds_read_b32 v10, v250 offset:24576
    v_exp_f32 v48, v48
    v_exp_f32 v49, v49
    v_exp_f32 v50, v50
    v_mfma_f32_32x32x16_bf16 v[64:79], v[124:127], a[148:151], v[64:79]
    v_exp_f32 v51, v51
    v_exp_f32 v52, v52
    v_exp_f32 v53, v53
    v_smfmac_f32_32x32x32_bf16 a[16:31], a[180:183], v[88:95], v12
    v_exp_f32 v54, v54
    v_exp_f32 v55, v55
    v_exp_f32 v56, v56
    v_smfmac_f32_16x16x64_bf16 a[100:103], v[20:23], v[88:95], v12
    s_waitcnt lgkmcnt(0)
    v_exp_f32 v57, v57
    v_exp_f32 v58, v58
    v_pk_add_f32 v[216:217], v[216:217], v[168:169]
    v_pk_add_f32 v[218:219], v[218:219], v[170:171]
    v_pk_add_f32 v[220:221], v[220:221], v[172:173]
    v_pk_add_f32 v[222:223], v[222:223], v[174:175]
    v_pk_add_f32 v[208:209], v[208:209], v[176:177]
    v_pk_add_f32 v[210:211], v[210:211], v[178:179]
    v_smfmac_f32_32x32x32_bf16 a[48:63], a[168:171], v[48:55], v12
    v_exp_f32 v59, v59
    v_exp_f32 v60, v60
    v_exp_f32 v61, v61
    v_add_f32 v240, v240, v8
    v_add_f32 v240, v240, v9
    v_add_f32 v240, v240, v10
    v_rcp_f32 v240, v240
    v_smfmac_f32_16x16x64_bf16 a[108:111], v[20:23], v[48:55], v12
    v_exp_f32 v62, v62
    v_exp_f32 v63, v63
    v_pk_add_f32 v[212:213], v[212:213], v[180:181]
    v_pk_add_f32 v[214:215], v[214:215], v[182:183]
    v_pk_add_f32 v[216:217], v[216:217], v[184:185]
    v_pk_add_f32 v[218:219], v[218:219], v[186:187]
    v_pk_add_f32 v[220:221], v[220:221], v[188:189]
    v_pk_add_f32 v[222:223], v[222:223], v[190:191]
    v_mfma_f32_32x32x16_bf16 v[80:95], v[112:115], a[160:163], 4.0
    v_exp_f32 v64, v64
    v_exp_f32 v65, v65
    v_exp_f32 v66, v66
    v_mfma_f32_32x32x16_bf16 v[80:95], v[116:119], a[164:167], v[80:95]
    ds_write_b128 v14, a[16:19] offset:5120
    v_exp_f32 v67, v67
    v_exp_f32 v68, v68
    v_exp_f32 v69, v69
    v_smfmac_f32_32x32x32_bf16 a[48:63], a[172:175], v[56:63], v12
    ds_write_b128 v14, a[20:23] offset:6144
    v_exp_f32 v70, v70
    v_exp_f32 v71, v71
    v_exp_f32 v72, v72
    v_smfmac_f32_16x16x64_bf16 a[108:111], v[20:23], v[56:63], v12
    ds_write_b128 v14, a[24:27] offset:7168
    v_exp_f32 v73, v73
    v_exp_f32 v74, v74
    v_pk_mul_f32 v[208:209], v[208:209], v[240:241] op_sel_hi:[1,0]
    v_pk_mul_f32 v[210:211], v[210:211], v[240:241] op_sel_hi:[1,0]
    v_pk_mul_f32 v[212:213], v[212:213], v[240:241] op_sel_hi:[1,0]
    v_pk_mul_f32 v[214:215], v[214:215], v[240:241] op_sel_hi:[1,0]
    v_smfmac_f32_32x32x32_bf16 a[48:63], a[176:179], v[64:71], v12
    ds_write_b128 v14, a[28:31] offset:8192
    v_exp_f32 v75, v75
    v_exp_f32 v76, v76
    v_exp_f32 v77, v77
    v_cvt_pk_bf16_f32 v4, v208, v209
    v_cvt_pk_bf16_f32 v5, v210, v211
    v_cvt_pk_bf16_f32 v6, v212, v213
    v_cvt_pk_bf16_f32 v7, v214, v215
    v_smfmac_f32_16x16x64_bf16 a[108:111], v[20:23], v[64:71], v12
    ds_write_b32 v14, a100 offset:9216
    v_exp_f32 v78, v78
    v_exp_f32 v79, v79
    v_pk_mul_f32 v[216:217], v[216:217], v[240:241] op_sel_hi:[1,0]
    v_pk_mul_f32 v[218:219], v[218:219], v[240:241] op_sel_hi:[1,0]
    v_pk_mul_f32 v[220:221], v[220:221], v[240:241] op_sel_hi:[1,0]
    v_pk_mul_f32 v[222:223], v[222:223], v[240:241] op_sel_hi:[1,0]
    v_mfma_f32_32x32x16_bf16 v[48:63], v[120:123], a[160:163], 4.0
    ds_write_b128 v251, v[4:7] offset:30720
    v_exp_f32 v80, v80
    v_exp_f32 v81, v81
    v_exp_f32 v82, v82
    v_cvt_pk_bf16_f32 v24, v216, v217
    v_cvt_pk_bf16_f32 v25, v218, v219
    v_cvt_pk_bf16_f32 v26, v220, v221
    v_cvt_pk_bf16_f32 v27, v222, v223
    v_mfma_f32_32x32x16_bf16 v[48:63], v[124:127], a[164:167], v[48:63]
    ds_write_b128 v252, v[24:27] offset:30720
    v_exp_f32 v83, v83
    v_exp_f32 v84, v84
    v_exp_f32 v85, v85
    v_smfmac_f32_32x32x32_bf16 a[48:63], a[180:183], v[72:79], v12
    ds_read_b128 v[28:31], v14 offset:30720
    v_exp_f32 v86, v86
    v_exp_f32 v87, v87
    v_exp_f32 v88, v88
    v_smfmac_f32_16x16x64_bf16 a[108:111], v[20:23], v[72:79], v12
    ds_read_b128 v[32:35], v14 offset:31744
    v_exp_f32 v89, v89
    v_exp_f32 v90, v90
    v_smfmac_f32_32x32x32_bf16 a[80:95], a[168:171], v[80:87], v12
    v_exp_f32 v91, v91
    v_exp_f32 v92, v92
    v_exp_f32 v93, v93
    v_smfmac_f32_16x16x64_bf16 a[116:119], v[20:23], v[80:87], v12
    s_waitcnt lgkmcnt(1)
    buffer_store_dwordx4 v[28:31], v253, s[28:31], s35 offen sc0 sc1
    v_exp_f32 v94, v94
    v_exp_f32 v95, v95
    v_mfma_f32_32x32x16_bf16 v[64:79], v[96:99], v[200:203], 4.0
    s_waitcnt lgkmcnt(0)
    buffer_store_dwordx4 v[32:35], v253, s[28:31], s35 offen offset:1024 sc0 sc1
    v_exp_f32 v48, v48
    v_exp_f32 v49, v49
    v_exp_f32 v50, v50
    v_mfma_f32_32x32x16_bf16 v[64:79], v[100:103], v[204:207], v[64:79]
    ds_write_b128 v14, a[48:51] offset:15360
    v_exp_f32 v51, v51
    v_exp_f32 v52, v52
    v_exp_f32 v53, v53
    v_smfmac_f32_32x32x32_bf16 a[80:95], a[172:175], v[88:95], v12
    ds_write_b128 v14, a[52:55] offset:16384
    v_exp_f32 v54, v54
    v_exp_f32 v55, v55
    v_exp_f32 v56, v56
    v_smfmac_f32_16x16x64_bf16 a[116:119], v[20:23], v[88:95], v12
    ds_write_b128 v14, a[56:59] offset:17408
    v_exp_f32 v57, v57
    v_exp_f32 v58, v58
    v_smfmac_f32_32x32x32_bf16 a[80:95], a[176:179], v[48:55], v12
    ds_write_b128 v14, a[60:63] offset:18432
    v_exp_f32 v59, v59
    v_exp_f32 v60, v60
    v_exp_f32 v61, v61
    v_smfmac_f32_16x16x64_bf16 a[116:119], v[20:23], v[48:55], v12
    ds_write_b32 v14, a108 offset:19456
    v_exp_f32 v62, v62
    v_exp_f32 v63, v63
    v_mfma_f32_32x32x16_bf16 v[80:95], v[104:107], v[200:203], 4.0
    v_exp_f32 v64, v64
    v_exp_f32 v65, v65
    v_exp_f32 v66, v66
    v_mfma_f32_32x32x16_bf16 v[80:95], v[108:111], v[204:207], v[80:95]
    s_waitcnt lgkmcnt(0)
    v_exp_f32 v67, v67
    v_exp_f32 v68, v68
    v_exp_f32 v69, v69
    v_smfmac_f32_32x32x32_bf16 a[80:95], a[180:183], v[56:63], v12
    s_barrier
    ds_read_b128 v[144:147], v248 offset:5120
    v_exp_f32 v70, v70
    v_exp_f32 v71, v71
    v_exp_f32 v72, v72
    v_smfmac_f32_16x16x64_bf16 a[116:119], v[20:23], v[56:63], v12
    ds_read_b128 v[148:151], v248 offset:6144
    ds_read_b128 v[152:155], v248 offset:7168
    v_exp_f32 v73, v73
    v_exp_f32 v74, v74
    v_smfmac_f32_32x32x32_bf16 v[224:239], v[128:131], v[64:71], v12
    ds_read_b128 v[156:159], v248 offset:8192
    ds_read_b32 v11, v248 offset:9216
    v_exp_f32 v75, v75
    v_exp_f32 v76, v76
    v_exp_f32 v77, v77
    v_smfmac_f32_16x16x64_bf16 v[244:247], v[20:23], v[64:71], v12
    ds_read_b128 v[160:163], v249 offset:15360
    ds_read_b128 v[164:167], v249 offset:16384
    v_exp_f32 v78, v78
    v_exp_f32 v79, v79
    v_mfma_f32_32x32x16_bf16 v[48:63], v[112:115], v[200:203], 4.0
    ds_read_b128 v[168:171], v249 offset:17408
    v_exp_f32 v80, v80
    v_exp_f32 v81, v81
    v_exp_f32 v82, v82
    v_mfma_f32_32x32x16_bf16 v[48:63], v[116:119], v[204:207], v[48:63]
    ds_write_b128 v14, a[80:83] offset:25600
    v_exp_f32 v83, v83
    v_exp_f32 v84, v84
    v_exp_f32 v85, v85
    v_smfmac_f32_32x32x32_bf16 v[224:239], v[132:135], v[72:79], v12
    ds_write_b128 v14, a[84:87] offset:26624
    v_exp_f32 v86, v86
    v_exp_f32 v87, v87
    v_exp_f32 v88, v88
    v_smfmac_f32_16x16x64_bf16 v[244:247], v[20:23], v[72:79], v12
    ds_write_b128 v14, a[88:91] offset:27648
    v_exp_f32 v89, v89
    v_exp_f32 v90, v90
    v_smfmac_f32_32x32x32_bf16 v[224:239], v[136:139], v[80:87], v12
    ds_write_b128 v14, a[92:95] offset:28672
    v_exp_f32 v91, v91
    v_exp_f32 v92, v92
    v_exp_f32 v93, v93
    v_smfmac_f32_16x16x64_bf16 v[244:247], v[20:23], v[80:87], v12
    ds_write_b32 v14, a116 offset:29696
    v_exp_f32 v94, v94
    v_exp_f32 v95, v95
    v_mfma_f32_32x32x16_bf16 v[64:79], v[120:123], v[200:203], 4.0
    ds_read_b128 v[172:175], v249 offset:18432
    ds_read_b32 v1, v249 offset:19456
    v_exp_f32 v48, v48
    v_exp_f32 v49, v49
    v_exp_f32 v50, v50
    v_mfma_f32_32x32x16_bf16 v[64:79], v[124:127], v[204:207], v[64:79]
    s_waitcnt lgkmcnt(2)
    v_exp_f32 v51, v51
    v_exp_f32 v52, v52
    v_exp_f32 v53, v53
    v_smfmac_f32_32x32x32_bf16 v[224:239], v[140:143], v[88:95], v12
    s_barrier
    ds_read_b128 v[176:179], v250 offset:25600
    v_exp_f32 v54, v54
    v_exp_f32 v55, v55
    v_exp_f32 v56, v56
    v_smfmac_f32_16x16x64_bf16 v[244:247], v[20:23], v[88:95], v12
    s_waitcnt lgkmcnt(1)
    ds_read_b128 v[180:183], v250 offset:26624
    v_exp_f32 v57, v57
    v_exp_f32 v58, v58
    v_pk_add_f32 v[144:145], v[144:145], v[160:161]
    v_pk_add_f32 v[146:147], v[146:147], v[162:163]
    v_pk_add_f32 v[148:149], v[148:149], v[164:165]
    v_pk_add_f32 v[150:151], v[150:151], v[166:167]
    v_smfmac_f32_32x32x32_bf16 v[224:239], a[168:171], v[48:55], v12
    ds_read_b128 v[184:187], v250 offset:27648
    v_exp_f32 v59, v59
    v_exp_f32 v60, v60
    v_exp_f32 v61, v61
    v_add_f32 v11, v11, v1
    v_smfmac_f32_16x16x64_bf16 v[244:247], v[20:23], v[48:55], v12
    ds_read_b128 v[188:191], v250 offset:28672
    ds_read_b32 v3, v250 offset:29696
    v_exp_f32 v62, v62
    v_exp_f32 v63, v63
    v_pk_add_f32 v[152:153], v[152:153], v[168:169]
    v_pk_add_f32 v[154:155], v[154:155], v[170:171]
    v_pk_add_f32 v[156:157], v[156:157], v[172:173]
    v_pk_add_f32 v[158:159], v[158:159], v[174:175]
    v_exp_f32 v64, v64
    v_exp_f32 v65, v65
    v_exp_f32 v66, v66
    v_exp_f32 v67, v67
    v_exp_f32 v68, v68
    v_exp_f32 v69, v69
    s_waitcnt lgkmcnt(0)
    v_pk_add_f32 v[144:145], v[144:145], v[176:177]
    v_pk_add_f32 v[146:147], v[146:147], v[178:179]
    v_pk_add_f32 v[148:149], v[148:149], v[180:181]
    v_pk_add_f32 v[150:151], v[150:151], v[182:183]
    v_pk_add_f32 v[152:153], v[152:153], v[184:185]
    v_pk_add_f32 v[154:155], v[154:155], v[186:187]
    v_pk_add_f32 v[156:157], v[156:157], v[188:189]
    v_pk_add_f32 v[158:159], v[158:159], v[190:191]
    v_add_f32 v11, v11, v3
    v_smfmac_f32_32x32x32_bf16 v[224:239], a[172:175], v[56:63], v12
    v_exp_f32 v70, v70
    v_exp_f32 v71, v71
    v_exp_f32 v72, v72
    v_smfmac_f32_16x16x64_bf16 v[244:247], v[20:23], v[56:63], v12
    v_exp_f32 v73, v73
    v_exp_f32 v74, v74
    v_smfmac_f32_32x32x32_bf16 v[224:239], a[176:179], v[64:71], v12
    v_exp_f32 v75, v75
    v_exp_f32 v76, v76
    v_exp_f32 v77, v77
    v_smfmac_f32_16x16x64_bf16 v[244:247], v[20:23], v[64:71], v12
    v_exp_f32 v78, v78
    v_exp_f32 v79, v79
    s_nop 1
    v_smfmac_f32_16x16x64_bf16 v[244:247], v[20:23], v[72:79], v12
    v_smfmac_f32_32x32x32_bf16 v[224:239], a[180:183], v[72:79], v12
    s_nop 6
    v_add_f32 v244, v244, v11
    v_rcp_f32 v244, v244
    s_nop 2
    v_pk_add_f32 v[224:225], v[224:225], v[144:145]
    v_pk_add_f32 v[226:227], v[226:227], v[146:147]
    v_pk_add_f32 v[228:229], v[228:229], v[148:149]
    v_pk_add_f32 v[230:231], v[230:231], v[150:151]
    v_pk_mul_f32 v[224:225], v[224:225], v[244:245] op_sel_hi:[1,0]
    v_pk_mul_f32 v[226:227], v[226:227], v[244:245] op_sel_hi:[1,0]
    v_pk_mul_f32 v[228:229], v[228:229], v[244:245] op_sel_hi:[1,0]
    v_pk_mul_f32 v[230:231], v[230:231], v[244:245] op_sel_hi:[1,0]
    v_cvt_pk_bf16_f32 v4, v224, v225
    v_cvt_pk_bf16_f32 v5, v226, v227
    v_cvt_pk_bf16_f32 v6, v228, v229
    v_cvt_pk_bf16_f32 v7, v230, v231
    ds_write_b128 v251, v[4:7] offset:30720
    v_pk_add_f32 v[232:233], v[232:233], v[152:153]
    v_pk_add_f32 v[234:235], v[234:235], v[154:155]
    v_pk_add_f32 v[236:237], v[236:237], v[156:157]
    v_pk_add_f32 v[238:239], v[238:239], v[158:159]
    v_pk_mul_f32 v[232:233], v[232:233], v[244:245] op_sel_hi:[1,0]
    v_pk_mul_f32 v[234:235], v[234:235], v[244:245] op_sel_hi:[1,0]
    v_pk_mul_f32 v[236:237], v[236:237], v[244:245] op_sel_hi:[1,0]
    v_pk_mul_f32 v[238:239], v[238:239], v[244:245] op_sel_hi:[1,0]
    v_cvt_pk_bf16_f32 v24, v232, v233
    v_cvt_pk_bf16_f32 v25, v234, v235
    v_cvt_pk_bf16_f32 v26, v236, v237
    v_cvt_pk_bf16_f32 v27, v238, v239
    ds_write_b128 v252, v[24:27] offset:30720
    ds_read_b128 v[160:163], v14 offset:30720
    ds_read_b128 v[164:167], v14 offset:31744
    s_waitcnt lgkmcnt(1)
    buffer_store_dwordx4 v[160:163], v253, s[28:31], s35 offen offset:2048 sc0 sc1
    s_waitcnt lgkmcnt(0)
    buffer_store_dwordx4 v[164:167], v253, s[28:31], s35 offen offset:3072 sc0 sc1
    s_endpgm
L_slow:
    s_waitcnt vmcnt(0) lgkmcnt(0)
    s_nop 15
    v_mov_b32 v36, 4286578688
    v_mov_b32 v37, 4286578688
    v_mov_b32 v38, 4286578688
    v_mov_b32 v39, 4286578688
    v_mov_b32 v40, 4286578688
    v_mov_b32 v41, 4286578688
    v_mov_b32 v42, 4286578688
    v_mov_b32 v43, 4286578688
    v_max3_f32 v36, v36, v48, v49
    v_max3_f32 v36, v36, v50, v51
    v_mfma_f32_32x32x16_bf16 v[64:79], v[96:99], a[120:123], 4.0
    v_max3_f32 v36, v36, v52, v53
    v_max3_f32 v36, v36, v54, v55
    v_mfma_f32_32x32x16_bf16 v[64:79], v[100:103], a[124:127], v[64:79]
    v_max3_f32 v36, v36, v56, v57
    ds_read_b128 v[144:147], v4
    ds_read_b128 v[148:151], v5
    v_max3_f32 v36, v36, v58, v59
    v_max3_f32 v36, v36, v60, v61
    ds_read_b128 v[152:155], v6
    ds_read_b128 v[156:159], v7
    v_max3_f32 v36, v36, v62, v63
    v_mfma_f32_32x32x16_bf16 v[80:95], v[96:99], a[136:139], 4.0
    ds_read_b64_tr_b16 v[160:161], v8
    s_nop 1
    v_max3_f32 v38, v38, v64, v65
    v_mfma_f32_32x32x16_bf16 v[80:95], v[100:103], a[140:143], v[80:95]
    ds_read_b64_tr_b16 v[162:163], v8 offset:8
    v_max3_f32 v38, v38, v66, v67
    v_max3_f32 v38, v38, v68, v69
    s_waitcnt lgkmcnt(4)
    ds_read_b64_tr_b16 v[164:165], v9
    v_max3_f32 v38, v38, v70, v71
    ds_read_b64_tr_b16 v[166:167], v9 offset:8
    v_max3_f32 v38, v38, v72, v73
    v_mfma_f32_4x4x4_16b_bf16 v[24:27], v[144:145], v[144:145], 0
    s_nop 1
    v_mfma_f32_4x4x4_16b_bf16 v[24:27], v[146:147], v[146:147], v[24:27]
    s_nop 1
    v_mfma_f32_4x4x4_16b_bf16 v[24:27], v[148:149], v[148:149], v[24:27]
    s_nop 1
    v_mfma_f32_4x4x4_16b_bf16 v[24:27], v[150:151], v[150:151], v[24:27]
    s_waitcnt lgkmcnt(4)
    v_max3_f32 v38, v38, v74, v75
    v_max3_f32 v38, v38, v76, v77
    ds_read_b64_tr_b16 v[168:169], v8 offset:2048
    v_mfma_f32_4x4x4_16b_bf16 v[24:27], v[152:153], v[152:153], v[24:27]
    v_max3_f32 v38, v38, v78, v79
    s_nop 0
    v_mfma_f32_4x4x4_16b_bf16 v[24:27], v[154:155], v[154:155], v[24:27]
    s_nop 1
    v_mfma_f32_4x4x4_16b_bf16 v[24:27], v[156:157], v[156:157], v[24:27]
    s_nop 1
    v_mfma_f32_4x4x4_16b_bf16 v[24:27], v[158:159], v[158:159], v[24:27]
    v_mfma_f32_32x32x16_bf16 v[48:63], v[96:99], a[152:155], 4.0
    v_max3_f32 v40, v40, v80, v81
    s_nop 2
    v_cndmask_b32 v28, v24, v25, s[40:41]
    v_mfma_f32_32x32x16_bf16 v[48:63], v[100:103], a[156:159], v[48:63]
    v_max3_f32 v40, v40, v82, v83
    v_cndmask_b32 v28, v28, v26, s[42:43]
    v_cndmask_b32 v28, v28, v27, s[44:45]
    v_sqrt_f32 v28, v28
    v_max3_f32 v40, v40, v84, v85
    v_add_f32 v28, 0x358637bd, v28
    v_rcp_f32 v28, v28
    s_waitcnt lgkmcnt(1)
    v_cvt_pk_bf16_f32 v29, v28, v28
    v_cvt_pk_bf16_f32 v30, v28, v28
    v_max3_f32 v40, v40, v86, v87
    s_nop 0
    v_permlane32_swap_b32 v29, v30
    v_and_b32 v32, v29, v10
    v_and_b32 v33, v29, v11
    ds_read_b64_tr_b16 v[170:171], v8 offset:2056
    v_max3_f32 v40, v40, v88, v89
    v_mfma_f32_4x4x4_16b_bf16 v[176:179], v[160:161], v[32:33], 0
    v_and_b32 v34, v30, v10
    v_mfma_f32_4x4x4_16b_bf16 v[180:183], v[162:163], v[32:33], 0
    v_and_b32 v35, v30, v11
    ds_read_b64_tr_b16 v[174:175], v9 offset:2056
    v_max3_f32 v40, v40, v90, v91
    v_max3_f32 v40, v40, v92, v93
    ds_read_b64_tr_b16 v[172:173], v9 offset:2048
    v_mfma_f32_4x4x4_16b_bf16 v[184:187], v[164:165], v[32:33], 0
    v_cvt_pk_bf16_f32 v104, v176, v177
    v_mfma_f32_4x4x4_16b_bf16 v[188:191], v[166:167], v[32:33], 0
    v_cvt_pk_bf16_f32 v105, v178, v179
    v_max3_f32 v40, v40, v94, v95
    v_cvt_pk_bf16_f32 v106, v180, v181
    v_cvt_pk_bf16_f32 v107, v182, v183
    v_cvt_pk_bf16_f32 v108, v184, v185
    v_cvt_pk_bf16_f32 v109, v186, v187
    v_max3_f32 v42, v42, v48, v49
    v_cvt_pk_bf16_f32 v110, v188, v189
    v_cvt_pk_bf16_f32 v111, v190, v191
    v_max3_f32 v42, v42, v50, v51
    v_mfma_f32_32x32x16_bf16 v[64:79], v[104:107], v[192:195], 4.0
    v_max3_f32 v42, v42, v52, v53
    v_max3_f32 v42, v42, v54, v55
    v_mfma_f32_32x32x16_bf16 v[64:79], v[108:111], v[196:199], v[64:79]
    v_max3_f32 v42, v42, v56, v57
    v_max3_f32 v42, v42, v58, v59
    v_max3_f32 v42, v42, v60, v61
    ds_read_b128 v[144:147], v4 offset:8192
    ds_read_b128 v[148:151], v5 offset:8192
    v_max3_f32 v42, v42, v62, v63
    v_mfma_f32_32x32x16_bf16 v[80:95], v[104:107], a[120:123], 4.0
    s_nop 4
    v_max3_f32 v36, v36, v64, v65
    v_mfma_f32_32x32x16_bf16 v[80:95], v[108:111], a[124:127], v[80:95]
    ds_read_b128 v[152:155], v6 offset:8192
    v_max3_f32 v36, v36, v66, v67
    v_max3_f32 v36, v36, v68, v69
    ds_read_b128 v[156:159], v7 offset:8192
    v_max3_f32 v36, v36, v70, v71
    s_waitcnt lgkmcnt(3)
    ds_read_b64_tr_b16 v[160:161], v8 offset:8192
    v_max3_f32 v36, v36, v72, v73
    v_mfma_f32_4x4x4_16b_bf16 v[24:27], v[144:145], v[144:145], 0
    s_nop 0
    s_nop 0
    v_mfma_f32_4x4x4_16b_bf16 v[24:27], v[146:147], v[146:147], v[24:27]
    s_waitcnt lgkmcnt(3)
    v_max3_f32 v36, v36, v74, v75
    v_max3_f32 v36, v36, v76, v77
    ds_read_b64_tr_b16 v[162:163], v8 offset:8200
    v_mfma_f32_4x4x4_16b_bf16 v[24:27], v[148:149], v[148:149], v[24:27]
    v_max3_f32 v36, v36, v78, v79
    s_nop 0
    v_mfma_f32_4x4x4_16b_bf16 v[24:27], v[150:151], v[150:151], v[24:27]
    v_mfma_f32_32x32x16_bf16 v[48:63], v[104:107], a[136:139], 4.0
    v_max3_f32 v38, v38, v80, v81
    v_mfma_f32_32x32x16_bf16 v[48:63], v[108:111], a[140:143], v[48:63]
    v_max3_f32 v38, v38, v82, v83
    v_max3_f32 v38, v38, v84, v85
    v_max3_f32 v38, v38, v86, v87
    s_waitcnt lgkmcnt(2)
    ds_read_b64_tr_b16 v[164:165], v9 offset:8192
    v_max3_f32 v38, v38, v88, v89
    v_mfma_f32_4x4x4_16b_bf16 v[24:27], v[152:153], v[152:153], v[24:27]
    s_nop 0
    s_nop 0
    v_mfma_f32_4x4x4_16b_bf16 v[24:27], v[154:155], v[154:155], v[24:27]
    v_max3_f32 v38, v38, v90, v91
    v_max3_f32 v38, v38, v92, v93
    ds_read_b64_tr_b16 v[166:167], v9 offset:8200
    v_mfma_f32_4x4x4_16b_bf16 v[24:27], v[156:157], v[156:157], v[24:27]
    v_max3_f32 v38, v38, v94, v95
    s_nop 0
    v_mfma_f32_4x4x4_16b_bf16 v[24:27], v[158:159], v[158:159], v[24:27]
    v_mfma_f32_32x32x16_bf16 v[64:79], v[104:107], a[152:155], 4.0
    s_add_u32 m0, s36, 16384
    v_max3_f32 v40, v40, v48, v49
    s_nop 1
    v_cndmask_b32 v28, v24, v25, s[40:41]
    v_mfma_f32_32x32x16_bf16 v[64:79], v[108:111], a[156:159], v[64:79]
    s_add_u32 s48, s34, 8192
    v_max3_f32 v40, v40, v50, v51
    v_cndmask_b32 v28, v28, v26, s[42:43]
    v_cndmask_b32 v28, v28, v27, s[44:45]
    v_sqrt_f32 v28, v28
    v_max3_f32 v40, v40, v52, v53
    v_add_f32 v28, 0x358637bd, v28
    v_rcp_f32 v28, v28
    buffer_load_dwordx4 v1, s[20:23], s48 offen lds
    buffer_load_dwordx4 v1, s[20:23], s48 offen offset:1024 lds
    v_mul_f32 v28, v28, v13
    v_cvt_pk_bf16_f32 v29, v28, v28
    v_cvt_pk_bf16_f32 v30, v28, v28
    v_max3_f32 v40, v40, v54, v55
    s_nop 0
    v_permlane32_swap_b32 v29, v30
    v_and_b32 v44, v29, v10
    v_and_b32 v45, v29, v11
    s_waitcnt lgkmcnt(0)
    v_max3_f32 v40, v40, v56, v57
    v_mfma_f32_4x4x4_16b_bf16 v[176:179], v[160:161], v[44:45], 0
    v_and_b32 v46, v30, v10
    v_mfma_f32_4x4x4_16b_bf16 v[180:183], v[162:163], v[44:45], 0
    v_and_b32 v47, v30, v11
    buffer_load_dwordx4 v1, s[20:23], s48 offen offset:2048 lds
    buffer_load_dwordx4 v1, s[20:23], s48 offen offset:3072 lds
    v_max3_f32 v40, v40, v58, v59
    v_max3_f32 v40, v40, v60, v61
    v_mfma_f32_4x4x4_16b_bf16 v[184:187], v[164:165], v[44:45], 0
    v_cvt_pk_bf16_f32 v200, v176, v177
    v_mfma_f32_4x4x4_16b_bf16 v[188:191], v[166:167], v[44:45], 0
    v_cvt_pk_bf16_f32 v201, v178, v179
    v_max3_f32 v40, v40, v62, v63
    v_cvt_pk_bf16_f32 v202, v180, v181
    v_cvt_pk_bf16_f32 v203, v182, v183
    v_cvt_pk_bf16_f32 v204, v184, v185
    v_cvt_pk_bf16_f32 v205, v186, v187
    v_max3_f32 v42, v42, v64, v65
    v_cvt_pk_bf16_f32 v206, v188, v189
    v_cvt_pk_bf16_f32 v207, v190, v191
    ds_write_b128 v15, v[200:203] offset:2048
    v_max3_f32 v42, v42, v66, v67
    v_mfma_f32_32x32x16_bf16 v[80:95], v[96:99], v[200:203], 4.0
    v_max3_f32 v42, v42, v68, v69
    v_max3_f32 v42, v42, v70, v71
    v_mfma_f32_32x32x16_bf16 v[80:95], v[100:103], v[204:207], v[80:95]
    v_max3_f32 v42, v42, v72, v73
    v_max3_f32 v42, v42, v74, v75
    v_max3_f32 v42, v42, v76, v77
    ds_write_b128 v15, v[204:207] offset:3072
    v_max3_f32 v42, v42, v78, v79
    v_mfma_f32_32x32x16_bf16 v[48:63], v[104:107], v[200:203], 4.0
    s_waitcnt lgkmcnt(0)
    s_nop 4
    v_max3_f32 v37, v37, v80, v81
    v_mfma_f32_32x32x16_bf16 v[48:63], v[108:111], v[204:207], v[48:63]
    s_barrier
    v_max3_f32 v37, v37, v82, v83
    v_max3_f32 v37, v37, v84, v85
    ds_read_b128 a[128:131], v16 offset:2048
    v_max3_f32 v37, v37, v86, v87
    ds_read_b128 a[132:135], v16 offset:3072
    v_max3_f32 v37, v37, v88, v89
    v_mfma_f32_4x4x4_16b_bf16 v[176:179], v[168:169], v[34:35], 0
    v_max3_f32 v37, v37, v90, v91
    v_max3_f32 v37, v37, v92, v93
    s_waitcnt lgkmcnt(0)
    ds_read_b128 a[144:147], v17 offset:2048
    v_mfma_f32_4x4x4_16b_bf16 v[180:183], v[170:171], v[34:35], 0
    v_max3_f32 v37, v37, v94, v95
    v_cvt_pk_bf16_f32 v112, v176, v177
    v_cvt_pk_bf16_f32 v113, v178, v179
    v_mfma_f32_32x32x16_bf16 v[64:79], v[96:99], a[128:131], 4.0
    v_max3_f32 v37, v37, v48, v49
    v_mfma_f32_32x32x16_bf16 v[64:79], v[100:103], a[132:135], v[64:79]
    v_max3_f32 v37, v37, v50, v51
    v_max3_f32 v37, v37, v52, v53
    v_cvt_pk_bf16_f32 v114, v180, v181
    v_cvt_pk_bf16_f32 v115, v182, v183
    ds_read_b128 a[148:151], v17 offset:3072
    v_max3_f32 v37, v37, v54, v55
    ds_read_b128 a[160:163], v18 offset:2048
    v_max3_f32 v37, v37, v56, v57
    v_mfma_f32_4x4x4_16b_bf16 v[184:187], v[172:173], v[34:35], 0
    s_waitcnt lgkmcnt(1)
    v_max3_f32 v37, v37, v58, v59
    v_max3_f32 v37, v37, v60, v61
    ds_read_b128 a[164:167], v18 offset:3072
    v_mfma_f32_4x4x4_16b_bf16 v[188:191], v[174:175], v[34:35], 0
    v_max3_f32 v37, v37, v62, v63
    v_cvt_pk_bf16_f32 v116, v184, v185
    v_cvt_pk_bf16_f32 v117, v186, v187
    v_mfma_f32_32x32x16_bf16 v[80:95], v[96:99], a[144:147], 4.0
    ds_read_b64_tr_b16 v[168:169], v8 offset:10240
    v_max3_f32 v39, v39, v64, v65
    v_mfma_f32_32x32x16_bf16 v[80:95], v[100:103], a[148:151], v[80:95]
    ds_read_b64_tr_b16 v[170:171], v8 offset:10248
    v_max3_f32 v39, v39, v66, v67
    v_max3_f32 v39, v39, v68, v69
    v_cvt_pk_bf16_f32 v118, v188, v189
    v_cvt_pk_bf16_f32 v119, v190, v191
    v_max3_f32 v39, v39, v70, v71
    ds_read_b64_tr_b16 v[172:173], v9 offset:10240
    v_max3_f32 v39, v39, v72, v73
    s_waitcnt lgkmcnt(3)
    v_max3_f32 v39, v39, v74, v75
    v_max3_f32 v39, v39, v76, v77
    ds_read_b64_tr_b16 v[174:175], v9 offset:10248
    v_max3_f32 v39, v39, v78, v79
    v_mfma_f32_32x32x16_bf16 v[48:63], v[96:99], a[160:163], 4.0
    v_max3_f32 v41, v41, v80, v81
    v_mfma_f32_32x32x16_bf16 v[48:63], v[100:103], a[164:167], v[48:63]
    v_max3_f32 v41, v41, v82, v83
    v_max3_f32 v41, v41, v84, v85
    v_max3_f32 v41, v41, v86, v87
    v_max3_f32 v41, v41, v88, v89
    v_max3_f32 v41, v41, v90, v91
    v_max3_f32 v41, v41, v92, v93
    v_max3_f32 v41, v41, v94, v95
    v_mfma_f32_32x32x16_bf16 v[64:79], v[104:107], a[128:131], 4.0
    s_nop 3
    v_max3_f32 v43, v43, v48, v49
    v_mfma_f32_32x32x16_bf16 v[64:79], v[108:111], a[132:135], v[64:79]
    v_max3_f32 v43, v43, v50, v51
    v_max3_f32 v43, v43, v52, v53
    s_waitcnt lgkmcnt(0)
    v_max3_f32 v43, v43, v54, v55
    v_max3_f32 v43, v43, v56, v57
    v_mfma_f32_4x4x4_16b_bf16 v[176:179], v[168:169], v[46:47], 0
    v_max3_f32 v43, v43, v58, v59
    v_max3_f32 v43, v43, v60, v61
    v_mfma_f32_4x4x4_16b_bf16 v[180:183], v[170:171], v[46:47], 0
    v_max3_f32 v43, v43, v62, v63
    s_nop 0
    v_cvt_pk_bf16_f32 v120, v176, v177
    v_cvt_pk_bf16_f32 v121, v178, v179
    v_mfma_f32_32x32x16_bf16 v[80:95], v[104:107], a[144:147], 4.0
    v_max3_f32 v39, v39, v64, v65
    v_mfma_f32_32x32x16_bf16 v[80:95], v[108:111], a[148:151], v[80:95]
    v_max3_f32 v39, v39, v66, v67
    v_max3_f32 v39, v39, v68, v69
    v_cvt_pk_bf16_f32 v122, v180, v181
    v_cvt_pk_bf16_f32 v123, v182, v183
    v_max3_f32 v39, v39, v70, v71
    v_max3_f32 v39, v39, v72, v73
    v_mfma_f32_4x4x4_16b_bf16 v[184:187], v[172:173], v[46:47], 0
    v_max3_f32 v39, v39, v74, v75
    v_max3_f32 v39, v39, v76, v77
    v_mfma_f32_4x4x4_16b_bf16 v[188:191], v[174:175], v[46:47], 0
    v_max3_f32 v39, v39, v78, v79
    s_nop 0
    v_cvt_pk_bf16_f32 v124, v184, v185
    v_cvt_pk_bf16_f32 v125, v186, v187
    v_mfma_f32_32x32x16_bf16 v[48:63], v[104:107], a[160:163], 4.0
    v_max3_f32 v41, v41, v80, v81
    v_mfma_f32_32x32x16_bf16 v[48:63], v[108:111], a[164:167], v[48:63]
    v_max3_f32 v41, v41, v82, v83
    v_max3_f32 v41, v41, v84, v85
    v_cvt_pk_bf16_f32 v126, v188, v189
    v_cvt_pk_bf16_f32 v127, v190, v191
    v_max3_f32 v41, v41, v86, v87
    v_max3_f32 v41, v41, v88, v89
    v_max3_f32 v41, v41, v90, v91
    v_max3_f32 v41, v41, v92, v93
    v_max3_f32 v41, v41, v94, v95
    v_mfma_f32_32x32x16_bf16 v[64:79], v[112:115], v[192:195], 4.0
    s_add_u32 m0, s36, 24576
    s_nop 0
    v_max3_f32 v43, v43, v48, v49
    v_mfma_f32_32x32x16_bf16 v[64:79], v[116:119], v[196:199], v[64:79]
    s_add_u32 s48, s34, 12288
    v_max3_f32 v43, v43, v50, v51
    v_max3_f32 v43, v43, v52, v53
    buffer_load_dwordx4 v1, s[20:23], s48 offen lds
    buffer_load_dwordx4 v1, s[20:23], s48 offen offset:1024 lds
    v_max3_f32 v43, v43, v54, v55
    v_max3_f32 v43, v43, v56, v57
    buffer_load_dwordx4 v1, s[20:23], s48 offen offset:2048 lds
    buffer_load_dwordx4 v1, s[20:23], s48 offen offset:3072 lds
    v_max3_f32 v43, v43, v58, v59
    v_max3_f32 v43, v43, v60, v61
    v_max3_f32 v43, v43, v62, v63
    v_mfma_f32_32x32x16_bf16 v[80:95], v[112:115], v[200:203], 4.0
    v_max3_f32 v36, v36, v64, v65
    v_mfma_f32_32x32x16_bf16 v[80:95], v[116:119], v[204:207], v[80:95]
    v_max3_f32 v36, v36, v66, v67
    v_max3_f32 v36, v36, v68, v69
    s_waitcnt vmcnt(4)
    v_max3_f32 v36, v36, v70, v71
    ds_read_b128 v[144:147], v4 offset:16384
    v_max3_f32 v36, v36, v72, v73
    v_max3_f32 v36, v36, v74, v75
    v_max3_f32 v36, v36, v76, v77
    ds_read_b128 v[148:151], v5 offset:16384
    v_max3_f32 v36, v36, v78, v79
    v_mfma_f32_32x32x16_bf16 v[48:63], v[112:115], a[120:123], 4.0
    s_nop 0
    v_max3_f32 v37, v37, v80, v81
    v_mfma_f32_32x32x16_bf16 v[48:63], v[116:119], a[124:127], v[48:63]
    v_max3_f32 v37, v37, v82, v83
    v_max3_f32 v37, v37, v84, v85
    v_max3_f32 v37, v37, v86, v87
    ds_read_b128 v[152:155], v6 offset:16384
    v_max3_f32 v37, v37, v88, v89
    v_max3_f32 v37, v37, v90, v91
    v_max3_f32 v37, v37, v92, v93
    ds_read_b128 v[156:159], v7 offset:16384
    v_max3_f32 v37, v37, v94, v95
    v_mfma_f32_32x32x16_bf16 v[64:79], v[112:115], a[128:131], 4.0
    s_nop 1
    v_max3_f32 v38, v38, v48, v49
    v_mfma_f32_32x32x16_bf16 v[64:79], v[116:119], a[132:135], v[64:79]
    v_max3_f32 v38, v38, v50, v51
    v_max3_f32 v38, v38, v52, v53
    v_max3_f32 v38, v38, v54, v55
    v_max3_f32 v38, v38, v56, v57
    s_waitcnt lgkmcnt(3)
    v_max3_f32 v38, v38, v58, v59
    v_max3_f32 v38, v38, v60, v61
    v_mfma_f32_4x4x4_16b_bf16 v[24:27], v[144:145], v[144:145], 0
    v_max3_f32 v38, v38, v62, v63
    v_mfma_f32_32x32x16_bf16 v[80:95], v[112:115], a[136:139], 4.0
    s_nop 1
    v_max3_f32 v39, v39, v64, v65
    v_mfma_f32_32x32x16_bf16 v[80:95], v[116:119], a[140:143], v[80:95]
    v_max3_f32 v39, v39, v66, v67
    v_max3_f32 v39, v39, v68, v69
    v_max3_f32 v39, v39, v70, v71
    v_max3_f32 v39, v39, v72, v73
    v_mfma_f32_4x4x4_16b_bf16 v[24:27], v[146:147], v[146:147], v[24:27]
    s_waitcnt lgkmcnt(2)
    v_max3_f32 v39, v39, v74, v75
    v_max3_f32 v39, v39, v76, v77
    v_mfma_f32_4x4x4_16b_bf16 v[24:27], v[148:149], v[148:149], v[24:27]
    v_max3_f32 v39, v39, v78, v79
    v_mfma_f32_32x32x16_bf16 v[48:63], v[112:115], a[144:147], 4.0
    s_nop 0
    v_max3_f32 v40, v40, v80, v81
    v_mfma_f32_32x32x16_bf16 v[48:63], v[116:119], a[148:151], v[48:63]
    v_max3_f32 v40, v40, v82, v83
    v_max3_f32 v40, v40, v84, v85
    v_max3_f32 v40, v40, v86, v87
    ds_read_b64_tr_b16 v[160:161], v8 offset:16384
    v_max3_f32 v40, v40, v88, v89
    v_mfma_f32_4x4x4_16b_bf16 v[24:27], v[150:151], v[150:151], v[24:27]
    s_waitcnt lgkmcnt(2)
    v_max3_f32 v40, v40, v90, v91
    v_max3_f32 v40, v40, v92, v93
    ds_read_b64_tr_b16 v[162:163], v8 offset:16392
    v_mfma_f32_4x4x4_16b_bf16 v[24:27], v[152:153], v[152:153], v[24:27]
    v_max3_f32 v40, v40, v94, v95
    v_mfma_f32_32x32x16_bf16 v[64:79], v[112:115], a[152:155], 4.0
    v_max3_f32 v41, v41, v48, v49
    v_mfma_f32_32x32x16_bf16 v[64:79], v[116:119], a[156:159], v[64:79]
    v_max3_f32 v41, v41, v50, v51
    v_max3_f32 v41, v41, v52, v53
    v_max3_f32 v41, v41, v54, v55
    ds_read_b64_tr_b16 v[164:165], v9 offset:16384
    v_max3_f32 v41, v41, v56, v57
    v_mfma_f32_4x4x4_16b_bf16 v[24:27], v[154:155], v[154:155], v[24:27]
    s_waitcnt lgkmcnt(3)
    v_max3_f32 v41, v41, v58, v59
    v_max3_f32 v41, v41, v60, v61
    ds_read_b64_tr_b16 v[166:167], v9 offset:16392
    v_mfma_f32_4x4x4_16b_bf16 v[24:27], v[156:157], v[156:157], v[24:27]
    v_max3_f32 v41, v41, v62, v63
    v_mfma_f32_32x32x16_bf16 v[80:95], v[112:115], a[160:163], 4.0
    v_max3_f32 v42, v42, v64, v65
    v_mfma_f32_32x32x16_bf16 v[80:95], v[116:119], a[164:167], v[80:95]
    v_max3_f32 v42, v42, v66, v67
    v_max3_f32 v42, v42, v68, v69
    v_max3_f32 v42, v42, v70, v71
    ds_read_b64_tr_b16 v[168:169], v8 offset:18432
    v_max3_f32 v42, v42, v72, v73
    v_mfma_f32_4x4x4_16b_bf16 v[24:27], v[158:159], v[158:159], v[24:27]
    v_max3_f32 v42, v42, v74, v75
    v_max3_f32 v42, v42, v76, v77
    ds_read_b64_tr_b16 v[170:171], v8 offset:18440
    v_max3_f32 v42, v42, v78, v79
    s_nop 0
    v_cndmask_b32 v28, v24, v25, s[40:41]
    v_mfma_f32_32x32x16_bf16 v[48:63], v[120:123], v[192:195], 4.0
    v_max3_f32 v43, v43, v80, v81
    v_cndmask_b32 v28, v28, v26, s[42:43]
    v_mfma_f32_32x32x16_bf16 v[48:63], v[124:127], v[196:199], v[48:63]
    v_max3_f32 v43, v43, v82, v83
    v_max3_f32 v43, v43, v84, v85
    v_cndmask_b32 v28, v28, v27, s[44:45]
    v_max3_f32 v43, v43, v86, v87
    v_sqrt_f32 v28, v28
    ds_read_b64_tr_b16 v[172:173], v9 offset:18432
    v_max3_f32 v43, v43, v88, v89
    v_add_f32 v28, 0x358637bd, v28
    v_max3_f32 v43, v43, v90, v91
    v_max3_f32 v43, v43, v92, v93
    v_rcp_f32 v28, v28
    ds_read_b64_tr_b16 v[174:175], v9 offset:18440
    v_max3_f32 v43, v43, v94, v95
    v_cvt_pk_bf16_f32 v29, v28, v28
    v_cvt_pk_bf16_f32 v30, v28, v28
    v_mfma_f32_32x32x16_bf16 v[64:79], v[120:123], v[200:203], 4.0
    v_max3_f32 v36, v36, v48, v49
    v_permlane32_swap_b32 v29, v30
    v_mfma_f32_32x32x16_bf16 v[64:79], v[124:127], v[204:207], v[64:79]
    v_max3_f32 v36, v36, v50, v51
    v_max3_f32 v36, v36, v52, v53
    v_and_b32 v32, v29, v10
    v_and_b32 v33, v29, v11
    v_max3_f32 v36, v36, v54, v55
    v_and_b32 v34, v30, v10
    v_and_b32 v35, v30, v11
    v_max3_f32 v36, v36, v56, v57
    s_waitcnt lgkmcnt(4)
    v_max3_f32 v36, v36, v58, v59
    v_max3_f32 v36, v36, v60, v61
    v_mfma_f32_4x4x4_16b_bf16 v[176:179], v[160:161], v[32:33], 0
    v_max3_f32 v36, v36, v62, v63
    v_mfma_f32_32x32x16_bf16 v[80:95], v[120:123], a[120:123], 4.0
    v_max3_f32 v37, v37, v64, v65
    v_mfma_f32_32x32x16_bf16 v[80:95], v[124:127], a[124:127], v[80:95]
    v_max3_f32 v37, v37, v66, v67
    v_max3_f32 v37, v37, v68, v69
    v_cvt_pk_bf16_f32 v96, v176, v177
    v_cvt_pk_bf16_f32 v97, v178, v179
    v_max3_f32 v37, v37, v70, v71
    v_max3_f32 v37, v37, v72, v73
    v_mfma_f32_4x4x4_16b_bf16 v[180:183], v[162:163], v[32:33], 0
    v_max3_f32 v37, v37, v74, v75
    v_max3_f32 v37, v37, v76, v77
    v_mfma_f32_4x4x4_16b_bf16 v[184:187], v[164:165], v[32:33], 0
    v_max3_f32 v37, v37, v78, v79
    s_nop 0
    v_cvt_pk_bf16_f32 v98, v180, v181
    v_cvt_pk_bf16_f32 v99, v182, v183
    v_mfma_f32_32x32x16_bf16 v[48:63], v[120:123], a[128:131], 4.0
    v_max3_f32 v38, v38, v80, v81
    v_mfma_f32_32x32x16_bf16 v[48:63], v[124:127], a[132:135], v[48:63]
    v_max3_f32 v38, v38, v82, v83
    v_max3_f32 v38, v38, v84, v85
    v_cvt_pk_bf16_f32 v100, v184, v185
    v_cvt_pk_bf16_f32 v101, v186, v187
    v_max3_f32 v38, v38, v86, v87
    v_max3_f32 v38, v38, v88, v89
    v_mfma_f32_4x4x4_16b_bf16 v[188:191], v[166:167], v[32:33], 0
    s_waitcnt lgkmcnt(0)
    v_max3_f32 v38, v38, v90, v91
    v_max3_f32 v38, v38, v92, v93
    v_mfma_f32_4x4x4_16b_bf16 v[176:179], v[168:169], v[34:35], 0
    v_max3_f32 v38, v38, v94, v95
    v_cvt_pk_bf16_f32 v102, v188, v189
    v_cvt_pk_bf16_f32 v103, v190, v191
    v_mfma_f32_32x32x16_bf16 v[64:79], v[120:123], a[136:139], 4.0
    s_add_u32 m0, s36, 0
    v_max3_f32 v39, v39, v48, v49
    v_mfma_f32_32x32x16_bf16 v[64:79], v[124:127], a[140:143], v[64:79]
    s_add_u32 s48, s34, 16384
    v_max3_f32 v39, v39, v50, v51
    v_max3_f32 v39, v39, v52, v53
    v_cvt_pk_bf16_f32 v104, v176, v177
    v_cvt_pk_bf16_f32 v105, v178, v179
    v_max3_f32 v39, v39, v54, v55
    buffer_load_dwordx4 v1, s[20:23], s48 offen lds
    v_max3_f32 v39, v39, v56, v57
    v_mfma_f32_4x4x4_16b_bf16 v[180:183], v[170:171], v[34:35], 0
    v_max3_f32 v39, v39, v58, v59
    v_max3_f32 v39, v39, v60, v61
    buffer_load_dwordx4 v1, s[20:23], s48 offen offset:1024 lds
    v_mfma_f32_4x4x4_16b_bf16 v[184:187], v[172:173], v[34:35], 0
    v_max3_f32 v39, v39, v62, v63
    v_cvt_pk_bf16_f32 v106, v180, v181
    v_cvt_pk_bf16_f32 v107, v182, v183
    v_mfma_f32_32x32x16_bf16 v[80:95], v[120:123], a[144:147], 4.0
    v_max3_f32 v40, v40, v64, v65
    v_mfma_f32_32x32x16_bf16 v[80:95], v[124:127], a[148:151], v[80:95]
    v_max3_f32 v40, v40, v66, v67
    v_max3_f32 v40, v40, v68, v69
    v_cvt_pk_bf16_f32 v108, v184, v185
    v_cvt_pk_bf16_f32 v109, v186, v187
    v_max3_f32 v40, v40, v70, v71
    buffer_load_dwordx4 v1, s[20:23], s48 offen offset:2048 lds
    v_max3_f32 v40, v40, v72, v73
    v_mfma_f32_4x4x4_16b_bf16 v[188:191], v[174:175], v[34:35], 0
    v_max3_f32 v40, v40, v74, v75
    v_max3_f32 v40, v40, v76, v77
    buffer_load_dwordx4 v1, s[20:23], s48 offen offset:3072 lds
    v_max3_f32 v40, v40, v78, v79
    s_nop 0
    v_cvt_pk_bf16_f32 v110, v188, v189
    v_cvt_pk_bf16_f32 v111, v190, v191
    v_mfma_f32_32x32x16_bf16 v[48:63], v[120:123], a[152:155], 4.0
    v_max3_f32 v41, v41, v80, v81
    v_mfma_f32_32x32x16_bf16 v[48:63], v[124:127], a[156:159], v[48:63]
    v_max3_f32 v41, v41, v82, v83
    v_max3_f32 v41, v41, v84, v85
    v_max3_f32 v41, v41, v86, v87
    v_max3_f32 v41, v41, v88, v89
    v_max3_f32 v41, v41, v90, v91
    v_max3_f32 v41, v41, v92, v93
    v_max3_f32 v41, v41, v94, v95
    v_mfma_f32_32x32x16_bf16 v[64:79], v[120:123], a[160:163], 4.0
    s_nop 3
    v_max3_f32 v42, v42, v48, v49
    v_mfma_f32_32x32x16_bf16 v[64:79], v[124:127], a[164:167], v[64:79]
    v_max3_f32 v42, v42, v50, v51
    v_max3_f32 v42, v42, v52, v53
    v_max3_f32 v42, v42, v54, v55
    v_max3_f32 v42, v42, v56, v57
    v_max3_f32 v42, v42, v58, v59
    v_max3_f32 v42, v42, v60, v61
    v_max3_f32 v42, v42, v62, v63
    v_mfma_f32_32x32x16_bf16 v[80:95], v[96:99], v[192:195], 4.0
    s_nop 3
    v_max3_f32 v43, v43, v64, v65
    v_mfma_f32_32x32x16_bf16 v[80:95], v[100:103], v[196:199], v[80:95]
    v_max3_f32 v43, v43, v66, v67
    v_max3_f32 v43, v43, v68, v69
    v_max3_f32 v43, v43, v70, v71
    v_max3_f32 v43, v43, v72, v73
    v_max3_f32 v43, v43, v74, v75
    v_max3_f32 v43, v43, v76, v77
    v_max3_f32 v43, v43, v78, v79
    v_mfma_f32_32x32x16_bf16 v[48:63], v[96:99], v[200:203], 4.0
    s_nop 3
    v_max3_f32 v36, v36, v80, v81
    v_mfma_f32_32x32x16_bf16 v[48:63], v[100:103], v[204:207], v[48:63]
    v_max3_f32 v36, v36, v82, v83
    v_max3_f32 v36, v36, v84, v85
    s_waitcnt vmcnt(4)
    v_max3_f32 v36, v36, v86, v87
    ds_read_b128 v[144:147], v4 offset:24576
    v_max3_f32 v36, v36, v88, v89
    v_max3_f32 v36, v36, v90, v91
    v_max3_f32 v36, v36, v92, v93
    ds_read_b128 v[148:151], v5 offset:24576
    v_max3_f32 v36, v36, v94, v95
    v_mfma_f32_32x32x16_bf16 v[64:79], v[96:99], a[120:123], 4.0
    s_nop 0
    v_max3_f32 v37, v37, v48, v49
    v_mfma_f32_32x32x16_bf16 v[64:79], v[100:103], a[124:127], v[64:79]
    v_max3_f32 v37, v37, v50, v51
    v_max3_f32 v37, v37, v52, v53
    v_max3_f32 v37, v37, v54, v55
    ds_read_b128 v[152:155], v6 offset:24576
    v_max3_f32 v37, v37, v56, v57
    v_max3_f32 v37, v37, v58, v59
    v_max3_f32 v37, v37, v60, v61
    ds_read_b128 v[156:159], v7 offset:24576
    v_max3_f32 v37, v37, v62, v63
    v_mfma_f32_32x32x16_bf16 v[80:95], v[96:99], a[128:131], 4.0
    s_nop 1
    v_max3_f32 v38, v38, v64, v65
    v_mfma_f32_32x32x16_bf16 v[80:95], v[100:103], a[132:135], v[80:95]
    v_max3_f32 v38, v38, v66, v67
    v_max3_f32 v38, v38, v68, v69
    v_max3_f32 v38, v38, v70, v71
    v_max3_f32 v38, v38, v72, v73
    s_waitcnt lgkmcnt(3)
    v_max3_f32 v38, v38, v74, v75
    v_max3_f32 v38, v38, v76, v77
    v_mfma_f32_4x4x4_16b_bf16 v[24:27], v[144:145], v[144:145], 0
    v_max3_f32 v38, v38, v78, v79
    v_mfma_f32_32x32x16_bf16 v[48:63], v[96:99], a[136:139], 4.0
    s_nop 1
    v_max3_f32 v39, v39, v80, v81
    v_mfma_f32_32x32x16_bf16 v[48:63], v[100:103], a[140:143], v[48:63]
    v_max3_f32 v39, v39, v82, v83
    v_max3_f32 v39, v39, v84, v85
    v_max3_f32 v39, v39, v86, v87
    v_max3_f32 v39, v39, v88, v89
    v_mfma_f32_4x4x4_16b_bf16 v[24:27], v[146:147], v[146:147], v[24:27]
    s_waitcnt lgkmcnt(2)
    v_max3_f32 v39, v39, v90, v91
    v_max3_f32 v39, v39, v92, v93
    v_mfma_f32_4x4x4_16b_bf16 v[24:27], v[148:149], v[148:149], v[24:27]
    v_max3_f32 v39, v39, v94, v95
    v_mfma_f32_32x32x16_bf16 v[64:79], v[96:99], a[144:147], 4.0
    s_nop 0
    v_max3_f32 v40, v40, v48, v49
    v_mfma_f32_32x32x16_bf16 v[64:79], v[100:103], a[148:151], v[64:79]
    v_max3_f32 v40, v40, v50, v51
    v_max3_f32 v40, v40, v52, v53
    v_max3_f32 v40, v40, v54, v55
    ds_read_b64_tr_b16 v[160:161], v8 offset:24576
    v_max3_f32 v40, v40, v56, v57
    v_mfma_f32_4x4x4_16b_bf16 v[24:27], v[150:151], v[150:151], v[24:27]
    s_waitcnt lgkmcnt(2)
    v_max3_f32 v40, v40, v58, v59
    v_max3_f32 v40, v40, v60, v61
    ds_read_b64_tr_b16 v[162:163], v8 offset:24584
    v_mfma_f32_4x4x4_16b_bf16 v[24:27], v[152:153], v[152:153], v[24:27]
    v_max3_f32 v40, v40, v62, v63
    v_mfma_f32_32x32x16_bf16 v[80:95], v[96:99], a[152:155], 4.0
    v_max3_f32 v41, v41, v64, v65
    v_mfma_f32_32x32x16_bf16 v[80:95], v[100:103], a[156:159], v[80:95]
    v_max3_f32 v41, v41, v66, v67
    v_max3_f32 v41, v41, v68, v69
    v_max3_f32 v41, v41, v70, v71
    ds_read_b64_tr_b16 v[164:165], v9 offset:24576
    v_max3_f32 v41, v41, v72, v73
    v_mfma_f32_4x4x4_16b_bf16 v[24:27], v[154:155], v[154:155], v[24:27]
    s_waitcnt lgkmcnt(3)
    v_max3_f32 v41, v41, v74, v75
    v_max3_f32 v41, v41, v76, v77
    ds_read_b64_tr_b16 v[166:167], v9 offset:24584
    v_mfma_f32_4x4x4_16b_bf16 v[24:27], v[156:157], v[156:157], v[24:27]
    v_max3_f32 v41, v41, v78, v79
    v_mfma_f32_32x32x16_bf16 v[48:63], v[96:99], a[160:163], 4.0
    v_max3_f32 v42, v42, v80, v81
    v_mfma_f32_32x32x16_bf16 v[48:63], v[100:103], a[164:167], v[48:63]
    v_max3_f32 v42, v42, v82, v83
    v_max3_f32 v42, v42, v84, v85
    v_max3_f32 v42, v42, v86, v87
    ds_read_b64_tr_b16 v[168:169], v8 offset:26624
    v_max3_f32 v42, v42, v88, v89
    v_mfma_f32_4x4x4_16b_bf16 v[24:27], v[158:159], v[158:159], v[24:27]
    v_max3_f32 v42, v42, v90, v91
    v_max3_f32 v42, v42, v92, v93
    ds_read_b64_tr_b16 v[170:171], v8 offset:26632
    v_max3_f32 v42, v42, v94, v95
    s_nop 0
    v_cndmask_b32 v28, v24, v25, s[40:41]
    v_mfma_f32_32x32x16_bf16 v[64:79], v[104:107], v[192:195], 4.0
    v_max3_f32 v43, v43, v48, v49
    v_cndmask_b32 v28, v28, v26, s[42:43]
    v_mfma_f32_32x32x16_bf16 v[64:79], v[108:111], v[196:199], v[64:79]
    v_max3_f32 v43, v43, v50, v51
    v_max3_f32 v43, v43, v52, v53
    v_cndmask_b32 v28, v28, v27, s[44:45]
    v_max3_f32 v43, v43, v54, v55
    v_sqrt_f32 v28, v28
    ds_read_b64_tr_b16 v[172:173], v9 offset:26624
    v_max3_f32 v43, v43, v56, v57
    v_add_f32 v28, 0x358637bd, v28
    v_max3_f32 v43, v43, v58, v59
    v_max3_f32 v43, v43, v60, v61
    v_rcp_f32 v28, v28
    ds_read_b64_tr_b16 v[174:175], v9 offset:26632
    v_max3_f32 v43, v43, v62, v63
    v_cvt_pk_bf16_f32 v29, v28, v28
    v_cvt_pk_bf16_f32 v30, v28, v28
    v_mfma_f32_32x32x16_bf16 v[80:95], v[104:107], v[200:203], 4.0
    v_max3_f32 v36, v36, v64, v65
    v_permlane32_swap_b32 v29, v30
    v_mfma_f32_32x32x16_bf16 v[80:95], v[108:111], v[204:207], v[80:95]
    v_max3_f32 v36, v36, v66, v67
    v_max3_f32 v36, v36, v68, v69
    v_and_b32 v32, v29, v10
    v_and_b32 v33, v29, v11
    v_max3_f32 v36, v36, v70, v71
    v_and_b32 v34, v30, v10
    v_and_b32 v35, v30, v11
    v_max3_f32 v36, v36, v72, v73
    s_waitcnt lgkmcnt(4)
    v_max3_f32 v36, v36, v74, v75
    v_max3_f32 v36, v36, v76, v77
    v_mfma_f32_4x4x4_16b_bf16 v[176:179], v[160:161], v[32:33], 0
    v_max3_f32 v36, v36, v78, v79
    v_mfma_f32_32x32x16_bf16 v[48:63], v[104:107], a[120:123], 4.0
    v_max3_f32 v37, v37, v80, v81
    v_mfma_f32_32x32x16_bf16 v[48:63], v[108:111], a[124:127], v[48:63]
    v_max3_f32 v37, v37, v82, v83
    v_max3_f32 v37, v37, v84, v85
    v_cvt_pk_bf16_f32 v112, v176, v177
    v_cvt_pk_bf16_f32 v113, v178, v179
    v_max3_f32 v37, v37, v86, v87
    v_max3_f32 v37, v37, v88, v89
    v_mfma_f32_4x4x4_16b_bf16 v[180:183], v[162:163], v[32:33], 0
    v_max3_f32 v37, v37, v90, v91
    v_max3_f32 v37, v37, v92, v93
    v_mfma_f32_4x4x4_16b_bf16 v[184:187], v[164:165], v[32:33], 0
    v_max3_f32 v37, v37, v94, v95
    s_nop 0
    v_cvt_pk_bf16_f32 v114, v180, v181
    v_cvt_pk_bf16_f32 v115, v182, v183
    v_mfma_f32_32x32x16_bf16 v[64:79], v[104:107], a[128:131], 4.0
    v_max3_f32 v38, v38, v48, v49
    v_mfma_f32_32x32x16_bf16 v[64:79], v[108:111], a[132:135], v[64:79]
    v_max3_f32 v38, v38, v50, v51
    v_max3_f32 v38, v38, v52, v53
    v_cvt_pk_bf16_f32 v116, v184, v185
    v_cvt_pk_bf16_f32 v117, v186, v187
    v_max3_f32 v38, v38, v54, v55
    v_max3_f32 v38, v38, v56, v57
    v_mfma_f32_4x4x4_16b_bf16 v[188:191], v[166:167], v[32:33], 0
    s_waitcnt lgkmcnt(0)
    v_max3_f32 v38, v38, v58, v59
    v_max3_f32 v38, v38, v60, v61
    v_mfma_f32_4x4x4_16b_bf16 v[176:179], v[168:169], v[34:35], 0
    v_max3_f32 v38, v38, v62, v63
    v_cvt_pk_bf16_f32 v118, v188, v189
    v_cvt_pk_bf16_f32 v119, v190, v191
    v_mfma_f32_32x32x16_bf16 v[80:95], v[104:107], a[136:139], 4.0
    s_add_u32 m0, s36, 8192
    v_max3_f32 v39, v39, v64, v65
    v_mfma_f32_32x32x16_bf16 v[80:95], v[108:111], a[140:143], v[80:95]
    s_add_u32 s48, s34, 20480
    v_max3_f32 v39, v39, v66, v67
    v_max3_f32 v39, v39, v68, v69
    v_cvt_pk_bf16_f32 v120, v176, v177
    v_cvt_pk_bf16_f32 v121, v178, v179
    v_max3_f32 v39, v39, v70, v71
    buffer_load_dwordx4 v1, s[20:23], s48 offen lds
    v_max3_f32 v39, v39, v72, v73
    v_mfma_f32_4x4x4_16b_bf16 v[180:183], v[170:171], v[34:35], 0
    v_max3_f32 v39, v39, v74, v75
    v_max3_f32 v39, v39, v76, v77
    buffer_load_dwordx4 v1, s[20:23], s48 offen offset:1024 lds
    v_mfma_f32_4x4x4_16b_bf16 v[184:187], v[172:173], v[34:35], 0
    v_max3_f32 v39, v39, v78, v79
    v_cvt_pk_bf16_f32 v122, v180, v181
    v_cvt_pk_bf16_f32 v123, v182, v183
    v_mfma_f32_32x32x16_bf16 v[48:63], v[104:107], a[144:147], 4.0
    v_max3_f32 v40, v40, v80, v81
    v_mfma_f32_32x32x16_bf16 v[48:63], v[108:111], a[148:151], v[48:63]
    v_max3_f32 v40, v40, v82, v83
    v_max3_f32 v40, v40, v84, v85
    v_cvt_pk_bf16_f32 v124, v184, v185
    v_cvt_pk_bf16_f32 v125, v186, v187
    v_max3_f32 v40, v40, v86, v87
    buffer_load_dwordx4 v1, s[20:23], s48 offen offset:2048 lds
    v_max3_f32 v40, v40, v88, v89
    v_mfma_f32_4x4x4_16b_bf16 v[188:191], v[174:175], v[34:35], 0
    v_max3_f32 v40, v40, v90, v91
    v_max3_f32 v40, v40, v92, v93
    buffer_load_dwordx4 v1, s[20:23], s48 offen offset:3072 lds
    v_max3_f32 v40, v40, v94, v95
    s_nop 0
    v_cvt_pk_bf16_f32 v126, v188, v189
    v_cvt_pk_bf16_f32 v127, v190, v191
    v_mfma_f32_32x32x16_bf16 v[64:79], v[104:107], a[152:155], 4.0
    v_max3_f32 v41, v41, v48, v49
    v_mfma_f32_32x32x16_bf16 v[64:79], v[108:111], a[156:159], v[64:79]
    v_max3_f32 v41, v41, v50, v51
    v_max3_f32 v41, v41, v52, v53
    v_max3_f32 v41, v41, v54, v55
    v_max3_f32 v41, v41, v56, v57
    v_max3_f32 v41, v41, v58, v59
    v_max3_f32 v41, v41, v60, v61
    v_max3_f32 v41, v41, v62, v63
    v_mfma_f32_32x32x16_bf16 v[80:95], v[104:107], a[160:163], 4.0
    s_nop 3
    v_max3_f32 v42, v42, v64, v65
    v_mfma_f32_32x32x16_bf16 v[80:95], v[108:111], a[164:167], v[80:95]
    v_max3_f32 v42, v42, v66, v67
    v_max3_f32 v42, v42, v68, v69
    v_max3_f32 v42, v42, v70, v71
    v_max3_f32 v42, v42, v72, v73
    v_max3_f32 v42, v42, v74, v75
    v_max3_f32 v42, v42, v76, v77
    v_max3_f32 v42, v42, v78, v79
    v_mfma_f32_32x32x16_bf16 v[48:63], v[112:115], v[192:195], 4.0
    s_nop 3
    v_max3_f32 v43, v43, v80, v81
    v_mfma_f32_32x32x16_bf16 v[48:63], v[116:119], v[196:199], v[48:63]
    v_max3_f32 v43, v43, v82, v83
    v_max3_f32 v43, v43, v84, v85
    v_max3_f32 v43, v43, v86, v87
    v_max3_f32 v43, v43, v88, v89
    v_max3_f32 v43, v43, v90, v91
    v_max3_f32 v43, v43, v92, v93
    v_max3_f32 v43, v43, v94, v95
    v_mfma_f32_32x32x16_bf16 v[64:79], v[112:115], v[200:203], 4.0
    s_nop 3
    v_max3_f32 v36, v36, v48, v49
    v_mfma_f32_32x32x16_bf16 v[64:79], v[116:119], v[204:207], v[64:79]
    v_max3_f32 v36, v36, v50, v51
    v_max3_f32 v36, v36, v52, v53
    s_waitcnt vmcnt(4)
    v_max3_f32 v36, v36, v54, v55
    ds_read_b128 v[144:147], v4
    v_max3_f32 v36, v36, v56, v57
    v_max3_f32 v36, v36, v58, v59
    v_max3_f32 v36, v36, v60, v61
    ds_read_b128 v[148:151], v5
    v_max3_f32 v36, v36, v62, v63
    v_mfma_f32_32x32x16_bf16 v[80:95], v[112:115], a[120:123], 4.0
    s_nop 0
    v_max3_f32 v37, v37, v64, v65
    v_mfma_f32_32x32x16_bf16 v[80:95], v[116:119], a[124:127], v[80:95]
    v_max3_f32 v37, v37, v66, v67
    v_max3_f32 v37, v37, v68, v69
    v_max3_f32 v37, v37, v70, v71
    ds_read_b128 v[152:155], v6
    v_max3_f32 v37, v37, v72, v73
    v_max3_f32 v37, v37, v74, v75
    v_max3_f32 v37, v37, v76, v77
    ds_read_b128 v[156:159], v7
    v_max3_f32 v37, v37, v78, v79
    v_mfma_f32_32x32x16_bf16 v[48:63], v[112:115], a[128:131], 4.0
    s_nop 1
    v_max3_f32 v38, v38, v80, v81
    v_mfma_f32_32x32x16_bf16 v[48:63], v[116:119], a[132:135], v[48:63]
    v_max3_f32 v38, v38, v82, v83
    v_max3_f32 v38, v38, v84, v85
    v_max3_f32 v38, v38, v86, v87
    v_max3_f32 v38, v38, v88, v89
    s_waitcnt lgkmcnt(3)
    v_max3_f32 v38, v38, v90, v91
    v_max3_f32 v38, v38, v92, v93
    v_mfma_f32_4x4x4_16b_bf16 v[24:27], v[144:145], v[144:145], 0
    v_max3_f32 v38, v38, v94, v95
    v_mfma_f32_32x32x16_bf16 v[64:79], v[112:115], a[136:139], 4.0
    s_nop 1
    v_max3_f32 v39, v39, v48, v49
    v_mfma_f32_32x32x16_bf16 v[64:79], v[116:119], a[140:143], v[64:79]
    v_max3_f32 v39, v39, v50, v51
    v_max3_f32 v39, v39, v52, v53
    v_max3_f32 v39, v39, v54, v55
    v_max3_f32 v39, v39, v56, v57
    v_mfma_f32_4x4x4_16b_bf16 v[24:27], v[146:147], v[146:147], v[24:27]
    s_waitcnt lgkmcnt(2)
    v_max3_f32 v39, v39, v58, v59
    v_max3_f32 v39, v39, v60, v61
    v_mfma_f32_4x4x4_16b_bf16 v[24:27], v[148:149], v[148:149], v[24:27]
    v_max3_f32 v39, v39, v62, v63
    v_mfma_f32_32x32x16_bf16 v[80:95], v[112:115], a[144:147], 4.0
    s_nop 0
    v_max3_f32 v40, v40, v64, v65
    v_mfma_f32_32x32x16_bf16 v[80:95], v[116:119], a[148:151], v[80:95]
    v_max3_f32 v40, v40, v66, v67
    v_max3_f32 v40, v40, v68, v69
    v_max3_f32 v40, v40, v70, v71
    ds_read_b64_tr_b16 v[160:161], v8
    v_max3_f32 v40, v40, v72, v73
    v_mfma_f32_4x4x4_16b_bf16 v[24:27], v[150:151], v[150:151], v[24:27]
    s_waitcnt lgkmcnt(2)
    v_max3_f32 v40, v40, v74, v75
    v_max3_f32 v40, v40, v76, v77
    ds_read_b64_tr_b16 v[162:163], v8 offset:8
    v_mfma_f32_4x4x4_16b_bf16 v[24:27], v[152:153], v[152:153], v[24:27]
    v_max3_f32 v40, v40, v78, v79
    v_mfma_f32_32x32x16_bf16 v[48:63], v[112:115], a[152:155], 4.0
    v_max3_f32 v41, v41, v80, v81
    v_mfma_f32_32x32x16_bf16 v[48:63], v[116:119], a[156:159], v[48:63]
    v_max3_f32 v41, v41, v82, v83
    v_max3_f32 v41, v41, v84, v85
    v_max3_f32 v41, v41, v86, v87
    ds_read_b64_tr_b16 v[164:165], v9
    v_max3_f32 v41, v41, v88, v89
    v_mfma_f32_4x4x4_16b_bf16 v[24:27], v[154:155], v[154:155], v[24:27]
    s_waitcnt lgkmcnt(3)
    v_max3_f32 v41, v41, v90, v91
    v_max3_f32 v41, v41, v92, v93
    ds_read_b64_tr_b16 v[166:167], v9 offset:8
    v_mfma_f32_4x4x4_16b_bf16 v[24:27], v[156:157], v[156:157], v[24:27]
    v_max3_f32 v41, v41, v94, v95
    v_mfma_f32_32x32x16_bf16 v[64:79], v[112:115], a[160:163], 4.0
    v_max3_f32 v42, v42, v48, v49
    v_mfma_f32_32x32x16_bf16 v[64:79], v[116:119], a[164:167], v[64:79]
    v_max3_f32 v42, v42, v50, v51
    v_max3_f32 v42, v42, v52, v53
    v_max3_f32 v42, v42, v54, v55
    ds_read_b64_tr_b16 v[168:169], v8 offset:2048
    v_max3_f32 v42, v42, v56, v57
    v_mfma_f32_4x4x4_16b_bf16 v[24:27], v[158:159], v[158:159], v[24:27]
    v_max3_f32 v42, v42, v58, v59
    v_max3_f32 v42, v42, v60, v61
    ds_read_b64_tr_b16 v[170:171], v8 offset:2056
    v_max3_f32 v42, v42, v62, v63
    s_nop 0
    v_cndmask_b32 v28, v24, v25, s[40:41]
    v_mfma_f32_32x32x16_bf16 v[80:95], v[120:123], v[192:195], 4.0
    v_max3_f32 v43, v43, v64, v65
    v_cndmask_b32 v28, v28, v26, s[42:43]
    v_mfma_f32_32x32x16_bf16 v[80:95], v[124:127], v[196:199], v[80:95]
    v_max3_f32 v43, v43, v66, v67
    v_max3_f32 v43, v43, v68, v69
    v_cndmask_b32 v28, v28, v27, s[44:45]
    v_max3_f32 v43, v43, v70, v71
    v_sqrt_f32 v28, v28
    ds_read_b64_tr_b16 v[172:173], v9 offset:2048
    v_max3_f32 v43, v43, v72, v73
    v_add_f32 v28, 0x358637bd, v28
    v_max3_f32 v43, v43, v74, v75
    v_max3_f32 v43, v43, v76, v77
    v_rcp_f32 v28, v28
    ds_read_b64_tr_b16 v[174:175], v9 offset:2056
    v_max3_f32 v43, v43, v78, v79
    v_cvt_pk_bf16_f32 v29, v28, v28
    v_cvt_pk_bf16_f32 v30, v28, v28
    v_mfma_f32_32x32x16_bf16 v[48:63], v[120:123], v[200:203], 4.0
    v_max3_f32 v36, v36, v80, v81
    v_permlane32_swap_b32 v29, v30
    v_mfma_f32_32x32x16_bf16 v[48:63], v[124:127], v[204:207], v[48:63]
    v_max3_f32 v36, v36, v82, v83
    v_max3_f32 v36, v36, v84, v85
    v_and_b32 v32, v29, v10
    v_and_b32 v33, v29, v11
    v_max3_f32 v36, v36, v86, v87
    v_and_b32 v34, v30, v10
    v_and_b32 v35, v30, v11
    v_max3_f32 v36, v36, v88, v89
    s_waitcnt lgkmcnt(4)
    v_max3_f32 v36, v36, v90, v91
    v_max3_f32 v36, v36, v92, v93
    v_mfma_f32_4x4x4_16b_bf16 v[176:179], v[160:161], v[32:33], 0
    v_max3_f32 v36, v36, v94, v95
    v_mfma_f32_32x32x16_bf16 v[64:79], v[120:123], a[120:123], 4.0
    v_max3_f32 v37, v37, v48, v49
    v_mfma_f32_32x32x16_bf16 v[64:79], v[124:127], a[124:127], v[64:79]
    v_max3_f32 v37, v37, v50, v51
    v_max3_f32 v37, v37, v52, v53
    v_cvt_pk_bf16_f32 v96, v176, v177
    v_cvt_pk_bf16_f32 v97, v178, v179
    v_max3_f32 v37, v37, v54, v55
    v_max3_f32 v37, v37, v56, v57
    v_mfma_f32_4x4x4_16b_bf16 v[180:183], v[162:163], v[32:33], 0
    v_max3_f32 v37, v37, v58, v59
    v_max3_f32 v37, v37, v60, v61
    v_mfma_f32_4x4x4_16b_bf16 v[184:187], v[164:165], v[32:33], 0
    v_max3_f32 v37, v37, v62, v63
    s_nop 0
    v_cvt_pk_bf16_f32 v98, v180, v181
    v_cvt_pk_bf16_f32 v99, v182, v183
    v_mfma_f32_32x32x16_bf16 v[80:95], v[120:123], a[128:131], 4.0
    v_max3_f32 v38, v38, v64, v65
    v_mfma_f32_32x32x16_bf16 v[80:95], v[124:127], a[132:135], v[80:95]
    v_max3_f32 v38, v38, v66, v67
    v_max3_f32 v38, v38, v68, v69
    v_cvt_pk_bf16_f32 v100, v184, v185
    v_cvt_pk_bf16_f32 v101, v186, v187
    v_max3_f32 v38, v38, v70, v71
    v_max3_f32 v38, v38, v72, v73
    v_mfma_f32_4x4x4_16b_bf16 v[188:191], v[166:167], v[32:33], 0
    s_waitcnt lgkmcnt(0)
    v_max3_f32 v38, v38, v74, v75
    v_max3_f32 v38, v38, v76, v77
    v_mfma_f32_4x4x4_16b_bf16 v[176:179], v[168:169], v[34:35], 0
    v_max3_f32 v38, v38, v78, v79
    v_cvt_pk_bf16_f32 v102, v188, v189
    v_cvt_pk_bf16_f32 v103, v190, v191
    v_mfma_f32_32x32x16_bf16 v[48:63], v[120:123], a[136:139], 4.0
    s_add_u32 m0, s36, 16384
    v_max3_f32 v39, v39, v80, v81
    v_mfma_f32_32x32x16_bf16 v[48:63], v[124:127], a[140:143], v[48:63]
    s_add_u32 s48, s34, 24576
    v_max3_f32 v39, v39, v82, v83
    v_max3_f32 v39, v39, v84, v85
    v_cvt_pk_bf16_f32 v104, v176, v177
    v_cvt_pk_bf16_f32 v105, v178, v179
    v_max3_f32 v39, v39, v86, v87
    buffer_load_dwordx4 v1, s[20:23], s48 offen lds
    v_max3_f32 v39, v39, v88, v89
    v_mfma_f32_4x4x4_16b_bf16 v[180:183], v[170:171], v[34:35], 0
    v_max3_f32 v39, v39, v90, v91
    v_max3_f32 v39, v39, v92, v93
    buffer_load_dwordx4 v1, s[20:23], s48 offen offset:1024 lds
    v_mfma_f32_4x4x4_16b_bf16 v[184:187], v[172:173], v[34:35], 0
    v_max3_f32 v39, v39, v94, v95
    v_cvt_pk_bf16_f32 v106, v180, v181
    v_cvt_pk_bf16_f32 v107, v182, v183
    v_mfma_f32_32x32x16_bf16 v[64:79], v[120:123], a[144:147], 4.0
    v_max3_f32 v40, v40, v48, v49
    v_mfma_f32_32x32x16_bf16 v[64:79], v[124:127], a[148:151], v[64:79]
    v_max3_f32 v40, v40, v50, v51
    v_max3_f32 v40, v40, v52, v53
    v_cvt_pk_bf16_f32 v108, v184, v185
    v_cvt_pk_bf16_f32 v109, v186, v187
    v_max3_f32 v40, v40, v54, v55
    buffer_load_dwordx4 v1, s[20:23], s48 offen offset:2048 lds
    v_max3_f32 v40, v40, v56, v57
    v_mfma_f32_4x4x4_16b_bf16 v[188:191], v[174:175], v[34:35], 0
    v_max3_f32 v40, v40, v58, v59
    v_max3_f32 v40, v40, v60, v61
    buffer_load_dwordx4 v1, s[20:23], s48 offen offset:3072 lds
    v_max3_f32 v40, v40, v62, v63
    s_nop 0
    v_cvt_pk_bf16_f32 v110, v188, v189
    v_cvt_pk_bf16_f32 v111, v190, v191
    v_mfma_f32_32x32x16_bf16 v[80:95], v[120:123], a[152:155], 4.0
    v_max3_f32 v41, v41, v64, v65
    v_mfma_f32_32x32x16_bf16 v[80:95], v[124:127], a[156:159], v[80:95]
    v_max3_f32 v41, v41, v66, v67
    v_max3_f32 v41, v41, v68, v69
    v_max3_f32 v41, v41, v70, v71
    v_max3_f32 v41, v41, v72, v73
    v_max3_f32 v41, v41, v74, v75
    v_max3_f32 v41, v41, v76, v77
    v_max3_f32 v41, v41, v78, v79
    v_mfma_f32_32x32x16_bf16 v[48:63], v[120:123], a[160:163], 4.0
    s_nop 3
    v_max3_f32 v42, v42, v80, v81
    v_mfma_f32_32x32x16_bf16 v[48:63], v[124:127], a[164:167], v[48:63]
    v_max3_f32 v42, v42, v82, v83
    v_max3_f32 v42, v42, v84, v85
    v_max3_f32 v42, v42, v86, v87
    v_max3_f32 v42, v42, v88, v89
    v_max3_f32 v42, v42, v90, v91
    v_max3_f32 v42, v42, v92, v93
    v_max3_f32 v42, v42, v94, v95
    v_mfma_f32_32x32x16_bf16 v[64:79], v[96:99], v[192:195], 4.0
    s_nop 3
    v_max3_f32 v43, v43, v48, v49
    v_mfma_f32_32x32x16_bf16 v[64:79], v[100:103], v[196:199], v[64:79]
    v_max3_f32 v43, v43, v50, v51
    v_max3_f32 v43, v43, v52, v53
    v_max3_f32 v43, v43, v54, v55
    v_max3_f32 v43, v43, v56, v57
    v_max3_f32 v43, v43, v58, v59
    v_max3_f32 v43, v43, v60, v61
    v_max3_f32 v43, v43, v62, v63
    v_mfma_f32_32x32x16_bf16 v[80:95], v[96:99], v[200:203], 4.0
    s_nop 3
    v_max3_f32 v36, v36, v64, v65
    v_mfma_f32_32x32x16_bf16 v[80:95], v[100:103], v[204:207], v[80:95]
    v_max3_f32 v36, v36, v66, v67
    v_max3_f32 v36, v36, v68, v69
    s_waitcnt vmcnt(4)
    v_max3_f32 v36, v36, v70, v71
    ds_read_b128 v[144:147], v4 offset:8192
    v_max3_f32 v36, v36, v72, v73
    v_max3_f32 v36, v36, v74, v75
    v_max3_f32 v36, v36, v76, v77
    ds_read_b128 v[148:151], v5 offset:8192
    v_max3_f32 v36, v36, v78, v79
    v_mfma_f32_32x32x16_bf16 v[48:63], v[96:99], a[120:123], 4.0
    s_nop 0
    v_max3_f32 v37, v37, v80, v81
    v_mfma_f32_32x32x16_bf16 v[48:63], v[100:103], a[124:127], v[48:63]
    v_max3_f32 v37, v37, v82, v83
    v_max3_f32 v37, v37, v84, v85
    v_max3_f32 v37, v37, v86, v87
    ds_read_b128 v[152:155], v6 offset:8192
    v_max3_f32 v37, v37, v88, v89
    v_max3_f32 v37, v37, v90, v91
    v_max3_f32 v37, v37, v92, v93
    ds_read_b128 v[156:159], v7 offset:8192
    v_max3_f32 v37, v37, v94, v95
    v_mfma_f32_32x32x16_bf16 v[64:79], v[96:99], a[128:131], 4.0
    s_nop 1
    v_max3_f32 v38, v38, v48, v49
    v_mfma_f32_32x32x16_bf16 v[64:79], v[100:103], a[132:135], v[64:79]
    v_max3_f32 v38, v38, v50, v51
    v_max3_f32 v38, v38, v52, v53
    v_max3_f32 v38, v38, v54, v55
    v_max3_f32 v38, v38, v56, v57
    s_waitcnt lgkmcnt(3)
    v_max3_f32 v38, v38, v58, v59
    v_max3_f32 v38, v38, v60, v61
    v_mfma_f32_4x4x4_16b_bf16 v[24:27], v[144:145], v[144:145], 0
    v_max3_f32 v38, v38, v62, v63
    v_mfma_f32_32x32x16_bf16 v[80:95], v[96:99], a[136:139], 4.0
    s_nop 1
    v_max3_f32 v39, v39, v64, v65
    v_mfma_f32_32x32x16_bf16 v[80:95], v[100:103], a[140:143], v[80:95]
    v_max3_f32 v39, v39, v66, v67
    v_max3_f32 v39, v39, v68, v69
    v_max3_f32 v39, v39, v70, v71
    v_max3_f32 v39, v39, v72, v73
    v_mfma_f32_4x4x4_16b_bf16 v[24:27], v[146:147], v[146:147], v[24:27]
    s_waitcnt lgkmcnt(2)
    v_max3_f32 v39, v39, v74, v75
    v_max3_f32 v39, v39, v76, v77
    v_mfma_f32_4x4x4_16b_bf16 v[24:27], v[148:149], v[148:149], v[24:27]
    v_max3_f32 v39, v39, v78, v79
    v_mfma_f32_32x32x16_bf16 v[48:63], v[96:99], a[144:147], 4.0
    s_nop 0
    v_max3_f32 v40, v40, v80, v81
    v_mfma_f32_32x32x16_bf16 v[48:63], v[100:103], a[148:151], v[48:63]
    v_max3_f32 v40, v40, v82, v83
    v_max3_f32 v40, v40, v84, v85
    v_max3_f32 v40, v40, v86, v87
    ds_read_b64_tr_b16 v[160:161], v8 offset:8192
    v_max3_f32 v40, v40, v88, v89
    v_mfma_f32_4x4x4_16b_bf16 v[24:27], v[150:151], v[150:151], v[24:27]
    s_waitcnt lgkmcnt(2)
    v_max3_f32 v40, v40, v90, v91
    v_max3_f32 v40, v40, v92, v93
    ds_read_b64_tr_b16 v[162:163], v8 offset:8200
    v_mfma_f32_4x4x4_16b_bf16 v[24:27], v[152:153], v[152:153], v[24:27]
    v_max3_f32 v40, v40, v94, v95
    v_mfma_f32_32x32x16_bf16 v[64:79], v[96:99], a[152:155], 4.0
    v_max3_f32 v41, v41, v48, v49
    v_mfma_f32_32x32x16_bf16 v[64:79], v[100:103], a[156:159], v[64:79]
    v_max3_f32 v41, v41, v50, v51
    v_max3_f32 v41, v41, v52, v53
    v_max3_f32 v41, v41, v54, v55
    ds_read_b64_tr_b16 v[164:165], v9 offset:8192
    v_max3_f32 v41, v41, v56, v57
    v_mfma_f32_4x4x4_16b_bf16 v[24:27], v[154:155], v[154:155], v[24:27]
    s_waitcnt lgkmcnt(3)
    v_max3_f32 v41, v41, v58, v59
    v_max3_f32 v41, v41, v60, v61
    ds_read_b64_tr_b16 v[166:167], v9 offset:8200
    v_mfma_f32_4x4x4_16b_bf16 v[24:27], v[156:157], v[156:157], v[24:27]
    v_max3_f32 v41, v41, v62, v63
    v_mfma_f32_32x32x16_bf16 v[80:95], v[96:99], a[160:163], 4.0
    v_max3_f32 v42, v42, v64, v65
    v_mfma_f32_32x32x16_bf16 v[80:95], v[100:103], a[164:167], v[80:95]
    v_max3_f32 v42, v42, v66, v67
    v_max3_f32 v42, v42, v68, v69
    v_max3_f32 v42, v42, v70, v71
    ds_read_b64_tr_b16 v[168:169], v8 offset:10240
    v_max3_f32 v42, v42, v72, v73
    v_mfma_f32_4x4x4_16b_bf16 v[24:27], v[158:159], v[158:159], v[24:27]
    v_max3_f32 v42, v42, v74, v75
    v_max3_f32 v42, v42, v76, v77
    ds_read_b64_tr_b16 v[170:171], v8 offset:10248
    v_max3_f32 v42, v42, v78, v79
    s_nop 0
    v_cndmask_b32 v28, v24, v25, s[40:41]
    v_mfma_f32_32x32x16_bf16 v[48:63], v[104:107], v[192:195], 4.0
    v_max3_f32 v43, v43, v80, v81
    v_cndmask_b32 v28, v28, v26, s[42:43]
    v_mfma_f32_32x32x16_bf16 v[48:63], v[108:111], v[196:199], v[48:63]
    v_max3_f32 v43, v43, v82, v83
    v_max3_f32 v43, v43, v84, v85
    v_cndmask_b32 v28, v28, v27, s[44:45]
    v_max3_f32 v43, v43, v86, v87
    v_sqrt_f32 v28, v28
    ds_read_b64_tr_b16 v[172:173], v9 offset:10240
    v_max3_f32 v43, v43, v88, v89
    v_add_f32 v28, 0x358637bd, v28
    v_max3_f32 v43, v43, v90, v91
    v_max3_f32 v43, v43, v92, v93
    v_rcp_f32 v28, v28
    ds_read_b64_tr_b16 v[174:175], v9 offset:10248
    v_max3_f32 v43, v43, v94, v95
    v_cvt_pk_bf16_f32 v29, v28, v28
    v_cvt_pk_bf16_f32 v30, v28, v28
    v_mfma_f32_32x32x16_bf16 v[64:79], v[104:107], v[200:203], 4.0
    v_max3_f32 v36, v36, v48, v49
    v_permlane32_swap_b32 v29, v30
    v_mfma_f32_32x32x16_bf16 v[64:79], v[108:111], v[204:207], v[64:79]
    v_max3_f32 v36, v36, v50, v51
    v_max3_f32 v36, v36, v52, v53
    v_and_b32 v32, v29, v10
    v_and_b32 v33, v29, v11
    v_max3_f32 v36, v36, v54, v55
    v_and_b32 v34, v30, v10
    v_and_b32 v35, v30, v11
    v_max3_f32 v36, v36, v56, v57
    s_waitcnt lgkmcnt(4)
    v_max3_f32 v36, v36, v58, v59
    v_max3_f32 v36, v36, v60, v61
    v_mfma_f32_4x4x4_16b_bf16 v[176:179], v[160:161], v[32:33], 0
    v_max3_f32 v36, v36, v62, v63
    v_mfma_f32_32x32x16_bf16 v[80:95], v[104:107], a[120:123], 4.0
    v_max3_f32 v37, v37, v64, v65
    v_mfma_f32_32x32x16_bf16 v[80:95], v[108:111], a[124:127], v[80:95]
    v_max3_f32 v37, v37, v66, v67
    v_max3_f32 v37, v37, v68, v69
    v_cvt_pk_bf16_f32 v112, v176, v177
    v_cvt_pk_bf16_f32 v113, v178, v179
    v_max3_f32 v37, v37, v70, v71
    v_max3_f32 v37, v37, v72, v73
    v_mfma_f32_4x4x4_16b_bf16 v[180:183], v[162:163], v[32:33], 0
    v_max3_f32 v37, v37, v74, v75
    v_max3_f32 v37, v37, v76, v77
    v_mfma_f32_4x4x4_16b_bf16 v[184:187], v[164:165], v[32:33], 0
    v_max3_f32 v37, v37, v78, v79
    s_nop 0
    v_cvt_pk_bf16_f32 v114, v180, v181
    v_cvt_pk_bf16_f32 v115, v182, v183
    v_mfma_f32_32x32x16_bf16 v[48:63], v[104:107], a[128:131], 4.0
    v_max3_f32 v38, v38, v80, v81
    v_mfma_f32_32x32x16_bf16 v[48:63], v[108:111], a[132:135], v[48:63]
    v_max3_f32 v38, v38, v82, v83
    v_max3_f32 v38, v38, v84, v85
    v_cvt_pk_bf16_f32 v116, v184, v185
    v_cvt_pk_bf16_f32 v117, v186, v187
    v_max3_f32 v38, v38, v86, v87
    v_max3_f32 v38, v38, v88, v89
    v_mfma_f32_4x4x4_16b_bf16 v[188:191], v[166:167], v[32:33], 0
    s_waitcnt lgkmcnt(0)
    v_max3_f32 v38, v38, v90, v91
    v_max3_f32 v38, v38, v92, v93
    v_mfma_f32_4x4x4_16b_bf16 v[176:179], v[168:169], v[34:35], 0
    v_max3_f32 v38, v38, v94, v95
    v_cvt_pk_bf16_f32 v118, v188, v189
    v_cvt_pk_bf16_f32 v119, v190, v191
    v_mfma_f32_32x32x16_bf16 v[64:79], v[104:107], a[136:139], 4.0
    s_add_u32 m0, s36, 24576
    v_max3_f32 v39, v39, v48, v49
    v_mfma_f32_32x32x16_bf16 v[64:79], v[108:111], a[140:143], v[64:79]
    s_add_u32 s48, s34, 28672
    v_max3_f32 v39, v39, v50, v51
    v_max3_f32 v39, v39, v52, v53
    v_cvt_pk_bf16_f32 v120, v176, v177
    v_cvt_pk_bf16_f32 v121, v178, v179
    v_max3_f32 v39, v39, v54, v55
    buffer_load_dwordx4 v1, s[20:23], s48 offen lds
    v_max3_f32 v39, v39, v56, v57
    v_mfma_f32_4x4x4_16b_bf16 v[180:183], v[170:171], v[34:35], 0
    v_max3_f32 v39, v39, v58, v59
    v_max3_f32 v39, v39, v60, v61
    buffer_load_dwordx4 v1, s[20:23], s48 offen offset:1024 lds
    v_mfma_f32_4x4x4_16b_bf16 v[184:187], v[172:173], v[34:35], 0
    v_max3_f32 v39, v39, v62, v63
    v_cvt_pk_bf16_f32 v122, v180, v181
    v_cvt_pk_bf16_f32 v123, v182, v183
    v_mfma_f32_32x32x16_bf16 v[80:95], v[104:107], a[144:147], 4.0
    v_max3_f32 v40, v40, v64, v65
    v_mfma_f32_32x32x16_bf16 v[80:95], v[108:111], a[148:151], v[80:95]
    v_max3_f32 v40, v40, v66, v67
    v_max3_f32 v40, v40, v68, v69
    v_cvt_pk_bf16_f32 v124, v184, v185
    v_cvt_pk_bf16_f32 v125, v186, v187
    v_max3_f32 v40, v40, v70, v71
    buffer_load_dwordx4 v1, s[20:23], s48 offen offset:2048 lds
    v_max3_f32 v40, v40, v72, v73
    v_mfma_f32_4x4x4_16b_bf16 v[188:191], v[174:175], v[34:35], 0
    v_max3_f32 v40, v40, v74, v75
    v_max3_f32 v40, v40, v76, v77
    buffer_load_dwordx4 v1, s[20:23], s48 offen offset:3072 lds
    v_max3_f32 v40, v40, v78, v79
    s_nop 0
    v_cvt_pk_bf16_f32 v126, v188, v189
    v_cvt_pk_bf16_f32 v127, v190, v191
    v_mfma_f32_32x32x16_bf16 v[48:63], v[104:107], a[152:155], 4.0
    v_max3_f32 v41, v41, v80, v81
    v_mfma_f32_32x32x16_bf16 v[48:63], v[108:111], a[156:159], v[48:63]
    v_max3_f32 v41, v41, v82, v83
    v_max3_f32 v41, v41, v84, v85
    v_max3_f32 v41, v41, v86, v87
    v_max3_f32 v41, v41, v88, v89
    v_max3_f32 v41, v41, v90, v91
    v_max3_f32 v41, v41, v92, v93
    v_max3_f32 v41, v41, v94, v95
    v_mfma_f32_32x32x16_bf16 v[64:79], v[104:107], a[160:163], 4.0
    s_nop 3
    v_max3_f32 v42, v42, v48, v49
    v_mfma_f32_32x32x16_bf16 v[64:79], v[108:111], a[164:167], v[64:79]
    v_max3_f32 v42, v42, v50, v51
    v_max3_f32 v42, v42, v52, v53
    v_max3_f32 v42, v42, v54, v55
    v_max3_f32 v42, v42, v56, v57
    v_max3_f32 v42, v42, v58, v59
    v_max3_f32 v42, v42, v60, v61
    v_max3_f32 v42, v42, v62, v63
    v_mfma_f32_32x32x16_bf16 v[80:95], v[112:115], v[192:195], 4.0
    s_nop 3
    v_max3_f32 v43, v43, v64, v65
    v_mfma_f32_32x32x16_bf16 v[80:95], v[116:119], v[196:199], v[80:95]
    v_max3_f32 v43, v43, v66, v67
    v_max3_f32 v43, v43, v68, v69
    v_max3_f32 v43, v43, v70, v71
    v_max3_f32 v43, v43, v72, v73
    v_max3_f32 v43, v43, v74, v75
    v_max3_f32 v43, v43, v76, v77
    v_max3_f32 v43, v43, v78, v79
    v_mfma_f32_32x32x16_bf16 v[48:63], v[112:115], v[200:203], 4.0
    s_nop 3
    v_max3_f32 v36, v36, v80, v81
    v_mfma_f32_32x32x16_bf16 v[48:63], v[116:119], v[204:207], v[48:63]
    v_max3_f32 v36, v36, v82, v83
    v_max3_f32 v36, v36, v84, v85
    s_waitcnt vmcnt(4)
    v_max3_f32 v36, v36, v86, v87
    ds_read_b128 v[144:147], v4 offset:16384
    v_max3_f32 v36, v36, v88, v89
    v_max3_f32 v36, v36, v90, v91
    v_max3_f32 v36, v36, v92, v93
    ds_read_b128 v[148:151], v5 offset:16384
    v_max3_f32 v36, v36, v94, v95
    v_mfma_f32_32x32x16_bf16 v[64:79], v[112:115], a[120:123], 4.0
    s_nop 0
    v_max3_f32 v37, v37, v48, v49
    v_mfma_f32_32x32x16_bf16 v[64:79], v[116:119], a[124:127], v[64:79]
    v_max3_f32 v37, v37, v50, v51
    v_max3_f32 v37, v37, v52, v53
    v_max3_f32 v37, v37, v54, v55
    ds_read_b128 v[152:155], v6 offset:16384
    v_max3_f32 v37, v37, v56, v57
    v_max3_f32 v37, v37, v58, v59
    v_max3_f32 v37, v37, v60, v61
    ds_read_b128 v[156:159], v7 offset:16384
    v_max3_f32 v37, v37, v62, v63
    v_mfma_f32_32x32x16_bf16 v[80:95], v[112:115], a[128:131], 4.0
    s_nop 1
    v_max3_f32 v38, v38, v64, v65
    v_mfma_f32_32x32x16_bf16 v[80:95], v[116:119], a[132:135], v[80:95]
    v_max3_f32 v38, v38, v66, v67
    v_max3_f32 v38, v38, v68, v69
    v_max3_f32 v38, v38, v70, v71
    v_max3_f32 v38, v38, v72, v73
    s_waitcnt lgkmcnt(3)
    v_max3_f32 v38, v38, v74, v75
    v_max3_f32 v38, v38, v76, v77
    v_mfma_f32_4x4x4_16b_bf16 v[24:27], v[144:145], v[144:145], 0
    v_max3_f32 v38, v38, v78, v79
    v_mfma_f32_32x32x16_bf16 v[48:63], v[112:115], a[136:139], 4.0
    s_nop 1
    v_max3_f32 v39, v39, v80, v81
    v_mfma_f32_32x32x16_bf16 v[48:63], v[116:119], a[140:143], v[48:63]
    v_max3_f32 v39, v39, v82, v83
    v_max3_f32 v39, v39, v84, v85
    v_max3_f32 v39, v39, v86, v87
    v_max3_f32 v39, v39, v88, v89
    v_mfma_f32_4x4x4_16b_bf16 v[24:27], v[146:147], v[146:147], v[24:27]
    s_waitcnt lgkmcnt(2)
    v_max3_f32 v39, v39, v90, v91
    v_max3_f32 v39, v39, v92, v93
    v_mfma_f32_4x4x4_16b_bf16 v[24:27], v[148:149], v[148:149], v[24:27]
    v_max3_f32 v39, v39, v94, v95
    v_mfma_f32_32x32x16_bf16 v[64:79], v[112:115], a[144:147], 4.0
    s_nop 0
    v_max3_f32 v40, v40, v48, v49
    v_mfma_f32_32x32x16_bf16 v[64:79], v[116:119], a[148:151], v[64:79]
    v_max3_f32 v40, v40, v50, v51
    v_max3_f32 v40, v40, v52, v53
    v_max3_f32 v40, v40, v54, v55
    ds_read_b64_tr_b16 v[160:161], v8 offset:16384
    v_max3_f32 v40, v40, v56, v57
    v_mfma_f32_4x4x4_16b_bf16 v[24:27], v[150:151], v[150:151], v[24:27]
    s_waitcnt lgkmcnt(2)
    v_max3_f32 v40, v40, v58, v59
    v_max3_f32 v40, v40, v60, v61
    ds_read_b64_tr_b16 v[162:163], v8 offset:16392
    v_mfma_f32_4x4x4_16b_bf16 v[24:27], v[152:153], v[152:153], v[24:27]
    v_max3_f32 v40, v40, v62, v63
    v_mfma_f32_32x32x16_bf16 v[80:95], v[112:115], a[152:155], 4.0
    v_max3_f32 v41, v41, v64, v65
    v_mfma_f32_32x32x16_bf16 v[80:95], v[116:119], a[156:159], v[80:95]
    v_max3_f32 v41, v41, v66, v67
    v_max3_f32 v41, v41, v68, v69
    v_max3_f32 v41, v41, v70, v71
    ds_read_b64_tr_b16 v[164:165], v9 offset:16384
    v_max3_f32 v41, v41, v72, v73
    v_mfma_f32_4x4x4_16b_bf16 v[24:27], v[154:155], v[154:155], v[24:27]
    s_waitcnt lgkmcnt(3)
    v_max3_f32 v41, v41, v74, v75
    v_max3_f32 v41, v41, v76, v77
    ds_read_b64_tr_b16 v[166:167], v9 offset:16392
    v_mfma_f32_4x4x4_16b_bf16 v[24:27], v[156:157], v[156:157], v[24:27]
    v_max3_f32 v41, v41, v78, v79
    v_mfma_f32_32x32x16_bf16 v[48:63], v[112:115], a[160:163], 4.0
    v_max3_f32 v42, v42, v80, v81
    v_mfma_f32_32x32x16_bf16 v[48:63], v[116:119], a[164:167], v[48:63]
    v_max3_f32 v42, v42, v82, v83
    v_max3_f32 v42, v42, v84, v85
    v_max3_f32 v42, v42, v86, v87
    ds_read_b64_tr_b16 v[168:169], v8 offset:18432
    v_max3_f32 v42, v42, v88, v89
    v_mfma_f32_4x4x4_16b_bf16 v[24:27], v[158:159], v[158:159], v[24:27]
    v_max3_f32 v42, v42, v90, v91
    v_max3_f32 v42, v42, v92, v93
    ds_read_b64_tr_b16 v[170:171], v8 offset:18440
    v_max3_f32 v42, v42, v94, v95
    s_nop 0
    v_cndmask_b32 v28, v24, v25, s[40:41]
    v_mfma_f32_32x32x16_bf16 v[64:79], v[120:123], v[192:195], 4.0
    v_max3_f32 v43, v43, v48, v49
    v_cndmask_b32 v28, v28, v26, s[42:43]
    v_mfma_f32_32x32x16_bf16 v[64:79], v[124:127], v[196:199], v[64:79]
    v_max3_f32 v43, v43, v50, v51
    v_max3_f32 v43, v43, v52, v53
    v_cndmask_b32 v28, v28, v27, s[44:45]
    v_max3_f32 v43, v43, v54, v55
    v_sqrt_f32 v28, v28
    ds_read_b64_tr_b16 v[172:173], v9 offset:18432
    v_max3_f32 v43, v43, v56, v57
    v_add_f32 v28, 0x358637bd, v28
    v_max3_f32 v43, v43, v58, v59
    v_max3_f32 v43, v43, v60, v61
    v_rcp_f32 v28, v28
    ds_read_b64_tr_b16 v[174:175], v9 offset:18440
    v_max3_f32 v43, v43, v62, v63
    v_cvt_pk_bf16_f32 v29, v28, v28
    v_cvt_pk_bf16_f32 v30, v28, v28
    v_mfma_f32_32x32x16_bf16 v[80:95], v[120:123], v[200:203], 4.0
    v_max3_f32 v36, v36, v64, v65
    v_permlane32_swap_b32 v29, v30
    v_mfma_f32_32x32x16_bf16 v[80:95], v[124:127], v[204:207], v[80:95]
    v_max3_f32 v36, v36, v66, v67
    v_max3_f32 v36, v36, v68, v69
    v_and_b32 v32, v29, v10
    v_and_b32 v33, v29, v11
    v_max3_f32 v36, v36, v70, v71
    v_and_b32 v34, v30, v10
    v_and_b32 v35, v30, v11
    v_max3_f32 v36, v36, v72, v73
    s_waitcnt lgkmcnt(4)
    v_max3_f32 v36, v36, v74, v75
    v_max3_f32 v36, v36, v76, v77
    v_mfma_f32_4x4x4_16b_bf16 v[176:179], v[160:161], v[32:33], 0
    v_max3_f32 v36, v36, v78, v79
    v_mfma_f32_32x32x16_bf16 v[48:63], v[120:123], a[120:123], 4.0
    v_max3_f32 v37, v37, v80, v81
    v_mfma_f32_32x32x16_bf16 v[48:63], v[124:127], a[124:127], v[48:63]
    v_max3_f32 v37, v37, v82, v83
    v_max3_f32 v37, v37, v84, v85
    v_cvt_pk_bf16_f32 v96, v176, v177
    v_cvt_pk_bf16_f32 v97, v178, v179
    v_max3_f32 v37, v37, v86, v87
    v_max3_f32 v37, v37, v88, v89
    v_mfma_f32_4x4x4_16b_bf16 v[180:183], v[162:163], v[32:33], 0
    v_max3_f32 v37, v37, v90, v91
    v_max3_f32 v37, v37, v92, v93
    v_mfma_f32_4x4x4_16b_bf16 v[184:187], v[164:165], v[32:33], 0
    v_max3_f32 v37, v37, v94, v95
    s_nop 0
    v_cvt_pk_bf16_f32 v98, v180, v181
    v_cvt_pk_bf16_f32 v99, v182, v183
    v_mfma_f32_32x32x16_bf16 v[64:79], v[120:123], a[128:131], 4.0
    v_max3_f32 v38, v38, v48, v49
    v_mfma_f32_32x32x16_bf16 v[64:79], v[124:127], a[132:135], v[64:79]
    v_max3_f32 v38, v38, v50, v51
    v_max3_f32 v38, v38, v52, v53
    v_cvt_pk_bf16_f32 v100, v184, v185
    v_cvt_pk_bf16_f32 v101, v186, v187
    v_max3_f32 v38, v38, v54, v55
    v_max3_f32 v38, v38, v56, v57
    v_mfma_f32_4x4x4_16b_bf16 v[188:191], v[166:167], v[32:33], 0
    s_waitcnt lgkmcnt(0)
    v_max3_f32 v38, v38, v58, v59
    v_max3_f32 v38, v38, v60, v61
    v_mfma_f32_4x4x4_16b_bf16 v[176:179], v[168:169], v[34:35], 0
    v_max3_f32 v38, v38, v62, v63
    v_cvt_pk_bf16_f32 v102, v188, v189
    v_cvt_pk_bf16_f32 v103, v190, v191
    v_mfma_f32_32x32x16_bf16 v[80:95], v[120:123], a[136:139], 4.0
    v_max3_f32 v39, v39, v64, v65
    v_mfma_f32_32x32x16_bf16 v[80:95], v[124:127], a[140:143], v[80:95]
    v_max3_f32 v39, v39, v66, v67
    v_max3_f32 v39, v39, v68, v69
    v_cvt_pk_bf16_f32 v104, v176, v177
    v_cvt_pk_bf16_f32 v105, v178, v179
    v_max3_f32 v39, v39, v70, v71
    v_max3_f32 v39, v39, v72, v73
    v_mfma_f32_4x4x4_16b_bf16 v[180:183], v[170:171], v[34:35], 0
    v_max3_f32 v39, v39, v74, v75
    v_max3_f32 v39, v39, v76, v77
    v_mfma_f32_4x4x4_16b_bf16 v[184:187], v[172:173], v[34:35], 0
    v_max3_f32 v39, v39, v78, v79
    s_nop 0
    v_cvt_pk_bf16_f32 v106, v180, v181
    v_cvt_pk_bf16_f32 v107, v182, v183
    v_mfma_f32_32x32x16_bf16 v[48:63], v[120:123], a[144:147], 4.0
    v_max3_f32 v40, v40, v80, v81
    v_mfma_f32_32x32x16_bf16 v[48:63], v[124:127], a[148:151], v[48:63]
    v_max3_f32 v40, v40, v82, v83
    v_max3_f32 v40, v40, v84, v85
    v_cvt_pk_bf16_f32 v108, v184, v185
    v_cvt_pk_bf16_f32 v109, v186, v187
    v_max3_f32 v40, v40, v86, v87
    v_max3_f32 v40, v40, v88, v89
    v_mfma_f32_4x4x4_16b_bf16 v[188:191], v[174:175], v[34:35], 0
    v_max3_f32 v40, v40, v90, v91
    v_max3_f32 v40, v40, v92, v93
    v_max3_f32 v40, v40, v94, v95
    s_nop 1
    v_cvt_pk_bf16_f32 v110, v188, v189
    v_cvt_pk_bf16_f32 v111, v190, v191
    v_mfma_f32_32x32x16_bf16 v[64:79], v[120:123], a[152:155], 4.0
    v_max3_f32 v41, v41, v48, v49
    v_mfma_f32_32x32x16_bf16 v[64:79], v[124:127], a[156:159], v[64:79]
    v_max3_f32 v41, v41, v50, v51
    v_max3_f32 v41, v41, v52, v53
    v_max3_f32 v41, v41, v54, v55
    v_max3_f32 v41, v41, v56, v57
    v_max3_f32 v41, v41, v58, v59
    v_max3_f32 v41, v41, v60, v61
    v_max3_f32 v41, v41, v62, v63
    v_mfma_f32_32x32x16_bf16 v[80:95], v[120:123], a[160:163], 4.0
    s_nop 3
    v_max3_f32 v42, v42, v64, v65
    v_mfma_f32_32x32x16_bf16 v[80:95], v[124:127], a[164:167], v[80:95]
    v_max3_f32 v42, v42, v66, v67
    v_max3_f32 v42, v42, v68, v69
    v_max3_f32 v42, v42, v70, v71
    v_max3_f32 v42, v42, v72, v73
    v_max3_f32 v42, v42, v74, v75
    v_max3_f32 v42, v42, v76, v77
    v_max3_f32 v42, v42, v78, v79
    v_mfma_f32_32x32x16_bf16 v[48:63], v[96:99], v[192:195], 4.0
    s_nop 3
    v_max3_f32 v43, v43, v80, v81
    v_mfma_f32_32x32x16_bf16 v[48:63], v[100:103], v[196:199], v[48:63]
    v_max3_f32 v43, v43, v82, v83
    v_max3_f32 v43, v43, v84, v85
    v_max3_f32 v43, v43, v86, v87
    v_max3_f32 v43, v43, v88, v89
    v_max3_f32 v43, v43, v90, v91
    v_max3_f32 v43, v43, v92, v93
    v_max3_f32 v43, v43, v94, v95
    v_mfma_f32_32x32x16_bf16 v[64:79], v[96:99], a[120:123], 4.0
    s_nop 3
    v_max3_f32 v36, v36, v48, v49
    v_mfma_f32_32x32x16_bf16 v[64:79], v[100:103], a[124:127], v[64:79]
    v_max3_f32 v36, v36, v50, v51
    v_max3_f32 v36, v36, v52, v53
    s_waitcnt vmcnt(0)
    v_max3_f32 v36, v36, v54, v55
    ds_read_b128 v[144:147], v4 offset:24576
    v_max3_f32 v36, v36, v56, v57
    v_max3_f32 v36, v36, v58, v59
    v_max3_f32 v36, v36, v60, v61
    ds_read_b128 v[148:151], v5 offset:24576
    v_max3_f32 v36, v36, v62, v63
    v_mfma_f32_32x32x16_bf16 v[80:95], v[96:99], a[128:131], 4.0
    s_nop 0
    v_max3_f32 v38, v38, v64, v65
    v_mfma_f32_32x32x16_bf16 v[80:95], v[100:103], a[132:135], v[80:95]
    v_max3_f32 v38, v38, v66, v67
    v_max3_f32 v38, v38, v68, v69
    v_max3_f32 v38, v38, v70, v71
    ds_read_b128 v[152:155], v6 offset:24576
    v_max3_f32 v38, v38, v72, v73
    v_max3_f32 v38, v38, v74, v75
    v_max3_f32 v38, v38, v76, v77
    ds_read_b128 v[156:159], v7 offset:24576
    v_max3_f32 v38, v38, v78, v79
    v_mfma_f32_32x32x16_bf16 v[48:63], v[96:99], a[136:139], 4.0
    s_nop 1
    v_max3_f32 v39, v39, v80, v81
    v_mfma_f32_32x32x16_bf16 v[48:63], v[100:103], a[140:143], v[48:63]
    v_max3_f32 v39, v39, v82, v83
    v_max3_f32 v39, v39, v84, v85
    v_max3_f32 v39, v39, v86, v87
    v_max3_f32 v39, v39, v88, v89
    s_waitcnt lgkmcnt(3)
    v_max3_f32 v39, v39, v90, v91
    v_max3_f32 v39, v39, v92, v93
    v_mfma_f32_4x4x4_16b_bf16 v[24:27], v[144:145], v[144:145], 0
    v_max3_f32 v39, v39, v94, v95
    v_mfma_f32_32x32x16_bf16 v[64:79], v[96:99], a[144:147], 4.0
    s_nop 1
    v_max3_f32 v40, v40, v48, v49
    v_mfma_f32_32x32x16_bf16 v[64:79], v[100:103], a[148:151], v[64:79]
    v_max3_f32 v40, v40, v50, v51
    v_max3_f32 v40, v40, v52, v53
    v_max3_f32 v40, v40, v54, v55
    v_max3_f32 v40, v40, v56, v57
    v_mfma_f32_4x4x4_16b_bf16 v[24:27], v[146:147], v[146:147], v[24:27]
    s_waitcnt lgkmcnt(2)
    v_max3_f32 v40, v40, v58, v59
    v_max3_f32 v40, v40, v60, v61
    v_mfma_f32_4x4x4_16b_bf16 v[24:27], v[148:149], v[148:149], v[24:27]
    v_max3_f32 v40, v40, v62, v63
    v_mfma_f32_32x32x16_bf16 v[80:95], v[96:99], a[152:155], 4.0
    s_nop 0
    v_max3_f32 v41, v41, v64, v65
    v_mfma_f32_32x32x16_bf16 v[80:95], v[100:103], a[156:159], v[80:95]
    v_max3_f32 v41, v41, v66, v67
    v_max3_f32 v41, v41, v68, v69
    v_max3_f32 v41, v41, v70, v71
    ds_read_b64_tr_b16 v[160:161], v8 offset:24576
    v_max3_f32 v41, v41, v72, v73
    v_mfma_f32_4x4x4_16b_bf16 v[24:27], v[150:151], v[150:151], v[24:27]
    s_waitcnt lgkmcnt(2)
    v_max3_f32 v41, v41, v74, v75
    v_max3_f32 v41, v41, v76, v77
    ds_read_b64_tr_b16 v[162:163], v8 offset:24584
    v_mfma_f32_4x4x4_16b_bf16 v[24:27], v[152:153], v[152:153], v[24:27]
    v_max3_f32 v41, v41, v78, v79
    v_mfma_f32_32x32x16_bf16 v[48:63], v[96:99], a[160:163], 4.0
    v_max3_f32 v42, v42, v80, v81
    v_mfma_f32_32x32x16_bf16 v[48:63], v[100:103], a[164:167], v[48:63]
    v_max3_f32 v42, v42, v82, v83
    v_max3_f32 v42, v42, v84, v85
    v_max3_f32 v42, v42, v86, v87
    ds_read_b64_tr_b16 v[164:165], v9 offset:24576
    v_max3_f32 v42, v42, v88, v89
    v_mfma_f32_4x4x4_16b_bf16 v[24:27], v[154:155], v[154:155], v[24:27]
    s_waitcnt lgkmcnt(3)
    v_max3_f32 v42, v42, v90, v91
    v_max3_f32 v42, v42, v92, v93
    ds_read_b64_tr_b16 v[166:167], v9 offset:24584
    v_mfma_f32_4x4x4_16b_bf16 v[24:27], v[156:157], v[156:157], v[24:27]
    v_max3_f32 v42, v42, v94, v95
    v_mfma_f32_32x32x16_bf16 v[64:79], v[104:107], v[192:195], 4.0
    v_max3_f32 v43, v43, v48, v49
    v_mfma_f32_32x32x16_bf16 v[64:79], v[108:111], v[196:199], v[64:79]
    v_max3_f32 v43, v43, v50, v51
    v_max3_f32 v43, v43, v52, v53
    v_max3_f32 v43, v43, v54, v55
    ds_read_b64_tr_b16 v[168:169], v8 offset:26624
    v_max3_f32 v43, v43, v56, v57
    v_mfma_f32_4x4x4_16b_bf16 v[24:27], v[158:159], v[158:159], v[24:27]
    v_max3_f32 v43, v43, v58, v59
    v_max3_f32 v43, v43, v60, v61
    ds_read_b64_tr_b16 v[170:171], v8 offset:26632
    v_max3_f32 v43, v43, v62, v63
    s_nop 0
    v_cndmask_b32 v28, v24, v25, s[40:41]
    v_mfma_f32_32x32x16_bf16 v[80:95], v[104:107], a[120:123], 4.0
    v_max3_f32 v36, v36, v64, v65
    v_cndmask_b32 v28, v28, v26, s[42:43]
    v_mfma_f32_32x32x16_bf16 v[80:95], v[108:111], a[124:127], v[80:95]
    v_max3_f32 v36, v36, v66, v67
    v_max3_f32 v36, v36, v68, v69
    v_cndmask_b32 v28, v28, v27, s[44:45]
    v_max3_f32 v36, v36, v70, v71
    v_sqrt_f32 v28, v28
    ds_read_b64_tr_b16 v[172:173], v9 offset:26624
    v_max3_f32 v36, v36, v72, v73
    v_add_f32 v28, 0x358637bd, v28
    v_max3_f32 v36, v36, v74, v75
    v_max3_f32 v36, v36, v76, v77
    v_rcp_f32 v28, v28
    ds_read_b64_tr_b16 v[174:175], v9 offset:26632
    v_max3_f32 v36, v36, v78, v79
    v_cvt_pk_bf16_f32 v29, v28, v28
    v_cvt_pk_bf16_f32 v30, v28, v28
    v_mfma_f32_32x32x16_bf16 v[48:63], v[104:107], a[128:131], 4.0
    v_max3_f32 v38, v38, v80, v81
    v_permlane32_swap_b32 v29, v30
    v_mfma_f32_32x32x16_bf16 v[48:63], v[108:111], a[132:135], v[48:63]
    v_max3_f32 v38, v38, v82, v83
    v_max3_f32 v38, v38, v84, v85
    v_and_b32 v32, v29, v10
    v_and_b32 v33, v29, v11
    v_max3_f32 v38, v38, v86, v87
    v_and_b32 v34, v30, v10
    v_and_b32 v35, v30, v11
    v_max3_f32 v38, v38, v88, v89
    s_waitcnt lgkmcnt(4)
    v_max3_f32 v38, v38, v90, v91
    v_max3_f32 v38, v38, v92, v93
    v_mfma_f32_4x4x4_16b_bf16 v[176:179], v[160:161], v[32:33], 0
    v_max3_f32 v38, v38, v94, v95
    v_mfma_f32_32x32x16_bf16 v[64:79], v[104:107], a[136:139], 4.0
    v_max3_f32 v39, v39, v48, v49
    v_mfma_f32_32x32x16_bf16 v[64:79], v[108:111], a[140:143], v[64:79]
    v_max3_f32 v39, v39, v50, v51
    v_max3_f32 v39, v39, v52, v53
    v_cvt_pk_bf16_f32 v112, v176, v177
    v_cvt_pk_bf16_f32 v113, v178, v179
    v_max3_f32 v39, v39, v54, v55
    v_max3_f32 v39, v39, v56, v57
    v_mfma_f32_4x4x4_16b_bf16 v[180:183], v[162:163], v[32:33], 0
    v_max3_f32 v39, v39, v58, v59
    v_max3_f32 v39, v39, v60, v61
    v_mfma_f32_4x4x4_16b_bf16 v[184:187], v[164:165], v[32:33], 0
    v_max3_f32 v39, v39, v62, v63
    s_nop 0
    v_cvt_pk_bf16_f32 v114, v180, v181
    v_cvt_pk_bf16_f32 v115, v182, v183
    v_mfma_f32_32x32x16_bf16 v[80:95], v[104:107], a[144:147], 4.0
    v_max3_f32 v40, v40, v64, v65
    v_mfma_f32_32x32x16_bf16 v[80:95], v[108:111], a[148:151], v[80:95]
    v_max3_f32 v40, v40, v66, v67
    v_max3_f32 v40, v40, v68, v69
    v_cvt_pk_bf16_f32 v116, v184, v185
    v_cvt_pk_bf16_f32 v117, v186, v187
    v_max3_f32 v40, v40, v70, v71
    v_max3_f32 v40, v40, v72, v73
    v_mfma_f32_4x4x4_16b_bf16 v[188:191], v[166:167], v[32:33], 0
    s_waitcnt lgkmcnt(0)
    v_max3_f32 v40, v40, v74, v75
    v_max3_f32 v40, v40, v76, v77
    v_mfma_f32_4x4x4_16b_bf16 v[176:179], v[168:169], v[34:35], 0
    v_max3_f32 v40, v40, v78, v79
    v_cvt_pk_bf16_f32 v118, v188, v189
    v_cvt_pk_bf16_f32 v119, v190, v191
    v_mfma_f32_32x32x16_bf16 v[48:63], v[104:107], a[152:155], 4.0
    v_max3_f32 v41, v41, v80, v81
    v_mfma_f32_32x32x16_bf16 v[48:63], v[108:111], a[156:159], v[48:63]
    v_max3_f32 v41, v41, v82, v83
    v_max3_f32 v41, v41, v84, v85
    v_cvt_pk_bf16_f32 v120, v176, v177
    v_cvt_pk_bf16_f32 v121, v178, v179
    v_max3_f32 v41, v41, v86, v87
    v_max3_f32 v41, v41, v88, v89
    v_mfma_f32_4x4x4_16b_bf16 v[180:183], v[170:171], v[34:35], 0
    v_max3_f32 v41, v41, v90, v91
    v_max3_f32 v41, v41, v92, v93
    v_mfma_f32_4x4x4_16b_bf16 v[184:187], v[172:173], v[34:35], 0
    v_max3_f32 v41, v41, v94, v95
    s_nop 0
    v_cvt_pk_bf16_f32 v122, v180, v181
    v_cvt_pk_bf16_f32 v123, v182, v183
    v_mfma_f32_32x32x16_bf16 v[64:79], v[104:107], a[160:163], 4.0
    v_max3_f32 v42, v42, v48, v49
    v_mfma_f32_32x32x16_bf16 v[64:79], v[108:111], a[164:167], v[64:79]
    v_max3_f32 v42, v42, v50, v51
    v_max3_f32 v42, v42, v52, v53
    v_cvt_pk_bf16_f32 v124, v184, v185
    v_cvt_pk_bf16_f32 v125, v186, v187
    v_max3_f32 v42, v42, v54, v55
    v_max3_f32 v42, v42, v56, v57
    v_mfma_f32_4x4x4_16b_bf16 v[188:191], v[174:175], v[34:35], 0
    v_max3_f32 v42, v42, v58, v59
    v_max3_f32 v42, v42, v60, v61
    v_max3_f32 v42, v42, v62, v63
    s_nop 1
    v_cvt_pk_bf16_f32 v126, v188, v189
    v_cvt_pk_bf16_f32 v127, v190, v191
    v_mfma_f32_32x32x16_bf16 v[80:95], v[112:115], a[120:123], 4.0
    v_max3_f32 v43, v43, v64, v65
    v_mfma_f32_32x32x16_bf16 v[80:95], v[116:119], a[124:127], v[80:95]
    v_max3_f32 v43, v43, v66, v67
    v_max3_f32 v43, v43, v68, v69
    v_max3_f32 v43, v43, v70, v71
    v_max3_f32 v43, v43, v72, v73
    v_max3_f32 v43, v43, v74, v75
    v_max3_f32 v43, v43, v76, v77
    v_max3_f32 v43, v43, v78, v79
    v_mfma_f32_32x32x16_bf16 v[48:63], v[120:123], a[120:123], 4.0
    s_nop 3
    v_max3_f32 v38, v38, v80, v81
    v_mfma_f32_32x32x16_bf16 v[48:63], v[124:127], a[124:127], v[48:63]
    v_max3_f32 v38, v38, v82, v83
    v_max3_f32 v38, v38, v84, v85
    v_max3_f32 v38, v38, v86, v87
    v_max3_f32 v38, v38, v88, v89
    v_max3_f32 v38, v38, v90, v91
    v_max3_f32 v38, v38, v92, v93
    v_max3_f32 v38, v38, v94, v95
    v_mfma_f32_32x32x16_bf16 v[64:79], v[112:115], a[136:139], 4.0
    s_nop 3
    v_max3_f32 v38, v38, v48, v49
    v_mfma_f32_32x32x16_bf16 v[64:79], v[116:119], a[140:143], v[64:79]
    v_max3_f32 v38, v38, v50, v51
    v_max3_f32 v38, v38, v52, v53
    v_max3_f32 v38, v38, v54, v55
    v_max3_f32 v38, v38, v56, v57
    v_max3_f32 v38, v38, v58, v59
    v_max3_f32 v38, v38, v60, v61
    v_max3_f32 v38, v38, v62, v63
    v_mfma_f32_32x32x16_bf16 v[80:95], v[120:123], a[136:139], 4.0
    s_nop 3
    v_max3_f32 v40, v40, v64, v65
    v_mfma_f32_32x32x16_bf16 v[80:95], v[124:127], a[140:143], v[80:95]
    v_max3_f32 v40, v40, v66, v67
    v_max3_f32 v40, v40, v68, v69
    v_max3_f32 v40, v40, v70, v71
    v_max3_f32 v40, v40, v72, v73
    v_max3_f32 v40, v40, v74, v75
    v_max3_f32 v40, v40, v76, v77
    v_max3_f32 v40, v40, v78, v79
    v_mfma_f32_32x32x16_bf16 v[48:63], v[112:115], a[152:155], 4.0
    s_nop 3
    v_max3_f32 v40, v40, v80, v81
    v_mfma_f32_32x32x16_bf16 v[48:63], v[116:119], a[156:159], v[48:63]
    v_max3_f32 v40, v40, v82, v83
    v_max3_f32 v40, v40, v84, v85
    v_max3_f32 v40, v40, v86, v87
    v_max3_f32 v40, v40, v88, v89
    v_max3_f32 v40, v40, v90, v91
    v_max3_f32 v40, v40, v92, v93
    v_max3_f32 v40, v40, v94, v95
    v_mfma_f32_32x32x16_bf16 v[64:79], v[120:123], a[152:155], 4.0
    s_nop 3
    v_max3_f32 v42, v42, v48, v49
    v_mfma_f32_32x32x16_bf16 v[64:79], v[124:127], a[156:159], v[64:79]
    v_max3_f32 v42, v42, v50, v51
    v_max3_f32 v42, v42, v52, v53
    v_max3_f32 v42, v42, v54, v55
    v_max3_f32 v42, v42, v56, v57
    v_max3_f32 v42, v42, v58, v59
    v_max3_f32 v42, v42, v60, v61
    v_max3_f32 v42, v42, v62, v63
    v_mfma_f32_32x32x16_bf16 v[80:95], v[112:115], v[192:195], 4.0
    s_nop 3
    v_max3_f32 v42, v42, v64, v65
    v_mfma_f32_32x32x16_bf16 v[80:95], v[116:119], v[196:199], v[80:95]
    v_max3_f32 v42, v42, v66, v67
    v_max3_f32 v42, v42, v68, v69
    v_max3_f32 v42, v42, v70, v71
    v_max3_f32 v42, v42, v72, v73
    v_max3_f32 v42, v42, v74, v75
    v_max3_f32 v42, v42, v76, v77
    v_max3_f32 v42, v42, v78, v79
    v_mfma_f32_32x32x16_bf16 v[48:63], v[120:123], v[192:195], 4.0
    s_nop 3
    v_max3_f32 v36, v36, v80, v81
    v_mfma_f32_32x32x16_bf16 v[48:63], v[124:127], v[196:199], v[48:63]
    v_max3_f32 v36, v36, v82, v83
    v_max3_f32 v36, v36, v84, v85
    v_max3_f32 v36, v36, v86, v87
    v_max3_f32 v36, v36, v88, v89
    v_max3_f32 v36, v36, v90, v91
    v_max3_f32 v36, v36, v92, v93
    v_max3_f32 v36, v36, v94, v95
    v_mfma_f32_32x32x16_bf16 v[64:79], v[112:115], a[128:131], 4.0
    s_nop 3
    v_max3_f32 v36, v36, v48, v49
    v_mfma_f32_32x32x16_bf16 v[64:79], v[116:119], a[132:135], v[64:79]
    v_max3_f32 v36, v36, v50, v51
    v_max3_f32 v36, v36, v52, v53
    v_max3_f32 v36, v36, v54, v55
    v_max3_f32 v36, v36, v56, v57
    v_max3_f32 v36, v36, v58, v59
    v_max3_f32 v36, v36, v60, v61
    v_max3_f32 v36, v36, v62, v63
    v_mfma_f32_32x32x16_bf16 v[80:95], v[120:123], a[128:131], 4.0
    s_nop 3
    v_max3_f32 v39, v39, v64, v65
    v_mfma_f32_32x32x16_bf16 v[80:95], v[124:127], a[132:135], v[80:95]
    v_max3_f32 v39, v39, v66, v67
    v_max3_f32 v39, v39, v68, v69
    v_max3_f32 v39, v39, v70, v71
    v_max3_f32 v39, v39, v72, v73
    v_max3_f32 v39, v39, v74, v75
    v_max3_f32 v39, v39, v76, v77
    v_max3_f32 v39, v39, v78, v79
    v_mfma_f32_32x32x16_bf16 v[48:63], v[112:115], a[144:147], 4.0
    s_nop 3
    v_max3_f32 v39, v39, v80, v81
    v_mfma_f32_32x32x16_bf16 v[48:63], v[116:119], a[148:151], v[48:63]
    v_max3_f32 v39, v39, v82, v83
    v_max3_f32 v39, v39, v84, v85
    v_max3_f32 v39, v39, v86, v87
    v_max3_f32 v39, v39, v88, v89
    v_max3_f32 v39, v39, v90, v91
    v_max3_f32 v39, v39, v92, v93
    v_max3_f32 v39, v39, v94, v95
    v_mfma_f32_32x32x16_bf16 v[64:79], v[120:123], a[144:147], 4.0
    s_nop 3
    v_max3_f32 v41, v41, v48, v49
    v_mfma_f32_32x32x16_bf16 v[64:79], v[124:127], a[148:151], v[64:79]
    v_max3_f32 v41, v41, v50, v51
    v_max3_f32 v41, v41, v52, v53
    v_max3_f32 v41, v41, v54, v55
    v_max3_f32 v41, v41, v56, v57
    v_max3_f32 v41, v41, v58, v59
    v_max3_f32 v41, v41, v60, v61
    v_max3_f32 v41, v41, v62, v63
    v_mfma_f32_32x32x16_bf16 v[80:95], v[112:115], a[160:163], 4.0
    s_nop 3
    v_max3_f32 v41, v41, v64, v65
    v_mfma_f32_32x32x16_bf16 v[80:95], v[116:119], a[164:167], v[80:95]
    v_max3_f32 v41, v41, v66, v67
    v_max3_f32 v41, v41, v68, v69
    v_max3_f32 v41, v41, v70, v71
    v_max3_f32 v41, v41, v72, v73
    v_max3_f32 v41, v41, v74, v75
    v_max3_f32 v41, v41, v76, v77
    v_max3_f32 v41, v41, v78, v79
    v_mfma_f32_32x32x16_bf16 v[48:63], v[120:123], a[160:163], 4.0
    s_nop 3
    v_max3_f32 v43, v43, v80, v81
    v_mfma_f32_32x32x16_bf16 v[48:63], v[124:127], a[164:167], v[48:63]
    v_max3_f32 v43, v43, v82, v83
    v_max3_f32 v43, v43, v84, v85
    v_max3_f32 v43, v43, v86, v87
    v_max3_f32 v43, v43, v88, v89
    v_max3_f32 v43, v43, v90, v91
    v_max3_f32 v43, v43, v92, v93
    v_max3_f32 v43, v43, v94, v95
    v_mfma_f32_32x32x16_bf16 v[64:79], v[96:99], v[200:203], 4.0
    s_nop 3
    v_max3_f32 v43, v43, v48, v49
    v_mfma_f32_32x32x16_bf16 v[64:79], v[100:103], v[204:207], v[64:79]
    v_max3_f32 v43, v43, v50, v51
    v_max3_f32 v43, v43, v52, v53
    v_max3_f32 v43, v43, v54, v55
    v_max3_f32 v43, v43, v56, v57
    v_max3_f32 v43, v43, v58, v59
    v_max3_f32 v43, v43, v60, v61
    v_max3_f32 v43, v43, v62, v63
    v_mfma_f32_32x32x16_bf16 v[80:95], v[104:107], v[200:203], 4.0
    s_nop 3
    v_max3_f32 v37, v37, v64, v65
    v_mfma_f32_32x32x16_bf16 v[80:95], v[108:111], v[204:207], v[80:95]
    v_max3_f32 v37, v37, v66, v67
    v_max3_f32 v37, v37, v68, v69
    v_max3_f32 v37, v37, v70, v71
    v_max3_f32 v37, v37, v72, v73
    v_max3_f32 v37, v37, v74, v75
    v_max3_f32 v37, v37, v76, v77
    v_max3_f32 v37, v37, v78, v79
    v_mfma_f32_32x32x16_bf16 v[48:63], v[112:115], v[200:203], 4.0
    s_nop 3
    v_max3_f32 v37, v37, v80, v81
    v_mfma_f32_32x32x16_bf16 v[48:63], v[116:119], v[204:207], v[48:63]
    v_max3_f32 v37, v37, v82, v83
    v_max3_f32 v37, v37, v84, v85
    v_max3_f32 v37, v37, v86, v87
    v_max3_f32 v37, v37, v88, v89
    v_max3_f32 v37, v37, v90, v91
    v_max3_f32 v37, v37, v92, v93
    v_max3_f32 v37, v37, v94, v95
    v_mfma_f32_32x32x16_bf16 v[64:79], v[120:123], v[200:203], 4.0
    s_nop 3
    v_max3_f32 v37, v37, v48, v49
    v_mfma_f32_32x32x16_bf16 v[64:79], v[124:127], v[204:207], v[64:79]
    v_max3_f32 v37, v37, v50, v51
    v_max3_f32 v37, v37, v52, v53
    v_max3_f32 v37, v37, v54, v55
    v_max3_f32 v37, v37, v56, v57
    v_max3_f32 v37, v37, v58, v59
    v_max3_f32 v37, v37, v60, v61
    v_max3_f32 v37, v37, v62, v63
    s_nop 4
    v_max3_f32 v37, v37, v64, v65
    v_max3_f32 v37, v37, v66, v67
    v_max3_f32 v37, v37, v68, v69
    v_max3_f32 v37, v37, v70, v71
    v_max3_f32 v37, v37, v72, v73
    v_max3_f32 v37, v37, v74, v75
    v_max3_f32 v37, v37, v76, v77
    v_max3_f32 v37, v37, v78, v79
    s_waitcnt vmcnt(0) lgkmcnt(0)
    s_nop 15
    s_barrier
    v_lshrrev_b32 v49, 2, v2
    v_mov_b32 v48, v36
    s_nop 1
    v_permlane32_swap_b32 v36, v48
    v_max_f32 v36, v36, v48
    s_lshl_b32 s38, s32, 1
    s_add_u32 s38, s38, 0
    s_and_b32 s38, s38, 7
    s_lshl_b32 s38, s38, 8
    s_add_u32 s38, s38, 131072
    v_add_u32 v56, s38, v49
    s_lshl_b32 s39, s32, 11
    v_add_u32 v50, s39, v56
    ds_write_b32 v50, v36
    v_mov_b32 v48, v37
    s_nop 1
    v_permlane32_swap_b32 v37, v48
    v_max_f32 v37, v37, v48
    s_lshl_b32 s38, s32, 1
    s_add_u32 s38, s38, 1
    s_and_b32 s38, s38, 7
    s_lshl_b32 s38, s38, 8
    s_add_u32 s38, s38, 131072
    v_add_u32 v57, s38, v49
    s_lshl_b32 s39, s32, 11
    v_add_u32 v50, s39, v57
    ds_write_b32 v50, v37
    v_mov_b32 v48, v38
    s_nop 1
    v_permlane32_swap_b32 v38, v48
    v_max_f32 v38, v38, v48
    s_lshl_b32 s38, s32, 1
    s_add_u32 s38, s38, 2
    s_and_b32 s38, s38, 7
    s_lshl_b32 s38, s38, 8
    s_add_u32 s38, s38, 131072
    v_add_u32 v58, s38, v49
    s_lshl_b32 s39, s32, 11
    v_add_u32 v50, s39, v58
    ds_write_b32 v50, v38
    v_mov_b32 v48, v39
    s_nop 1
    v_permlane32_swap_b32 v39, v48
    v_max_f32 v39, v39, v48
    s_lshl_b32 s38, s32, 1
    s_add_u32 s38, s38, 3
    s_and_b32 s38, s38, 7
    s_lshl_b32 s38, s38, 8
    s_add_u32 s38, s38, 131072
    v_add_u32 v59, s38, v49
    s_lshl_b32 s39, s32, 11
    v_add_u32 v50, s39, v59
    ds_write_b32 v50, v39
    v_mov_b32 v48, v40
    s_nop 1
    v_permlane32_swap_b32 v40, v48
    v_max_f32 v40, v40, v48
    s_lshl_b32 s38, s32, 1
    s_add_u32 s38, s38, 4
    s_and_b32 s38, s38, 7
    s_lshl_b32 s38, s38, 8
    s_add_u32 s38, s38, 131072
    v_add_u32 v60, s38, v49
    s_lshl_b32 s39, s32, 11
    v_add_u32 v50, s39, v60
    ds_write_b32 v50, v40
    v_mov_b32 v48, v41
    s_nop 1
    v_permlane32_swap_b32 v41, v48
    v_max_f32 v41, v41, v48
    s_lshl_b32 s38, s32, 1
    s_add_u32 s38, s38, 5
    s_and_b32 s38, s38, 7
    s_lshl_b32 s38, s38, 8
    s_add_u32 s38, s38, 131072
    v_add_u32 v61, s38, v49
    s_lshl_b32 s39, s32, 11
    v_add_u32 v50, s39, v61
    ds_write_b32 v50, v41
    v_mov_b32 v48, v42
    s_nop 1
    v_permlane32_swap_b32 v42, v48
    v_max_f32 v42, v42, v48
    s_lshl_b32 s38, s32, 1
    s_add_u32 s38, s38, 6
    s_and_b32 s38, s38, 7
    s_lshl_b32 s38, s38, 8
    s_add_u32 s38, s38, 131072
    v_add_u32 v62, s38, v49
    s_lshl_b32 s39, s32, 11
    v_add_u32 v50, s39, v62
    ds_write_b32 v50, v42
    v_mov_b32 v48, v43
    s_nop 1
    v_permlane32_swap_b32 v43, v48
    v_max_f32 v43, v43, v48
    s_lshl_b32 s38, s32, 1
    s_add_u32 s38, s38, 7
    s_and_b32 s38, s38, 7
    s_lshl_b32 s38, s38, 8
    s_add_u32 s38, s38, 131072
    v_add_u32 v63, s38, v49
    s_lshl_b32 s39, s32, 11
    v_add_u32 v50, s39, v63
    ds_write_b32 v50, v43
    s_waitcnt lgkmcnt(0)
    s_barrier
    ds_read_b32 v64, v56
    ds_read_b32 v65, v56 offset:2048
    ds_read_b32 v66, v56 offset:4096
    ds_read_b32 v67, v56 offset:6144
    s_waitcnt lgkmcnt(0)
    v_max_f32 v36, v64, v65
    v_max3_f32 v36, v36, v66, v67
    ds_read_b32 v64, v57
    ds_read_b32 v65, v57 offset:2048
    ds_read_b32 v66, v57 offset:4096
    ds_read_b32 v67, v57 offset:6144
    s_waitcnt lgkmcnt(0)
    v_max_f32 v37, v64, v65
    v_max3_f32 v37, v37, v66, v67
    ds_read_b32 v64, v58
    ds_read_b32 v65, v58 offset:2048
    ds_read_b32 v66, v58 offset:4096
    ds_read_b32 v67, v58 offset:6144
    s_waitcnt lgkmcnt(0)
    v_max_f32 v38, v64, v65
    v_max3_f32 v38, v38, v66, v67
    ds_read_b32 v64, v59
    ds_read_b32 v65, v59 offset:2048
    ds_read_b32 v66, v59 offset:4096
    ds_read_b32 v67, v59 offset:6144
    s_waitcnt lgkmcnt(0)
    v_max_f32 v39, v64, v65
    v_max3_f32 v39, v39, v66, v67
    ds_read_b32 v64, v60
    ds_read_b32 v65, v60 offset:2048
    ds_read_b32 v66, v60 offset:4096
    ds_read_b32 v67, v60 offset:6144
    s_waitcnt lgkmcnt(0)
    v_max_f32 v40, v64, v65
    v_max3_f32 v40, v40, v66, v67
    ds_read_b32 v64, v61
    ds_read_b32 v65, v61 offset:2048
    ds_read_b32 v66, v61 offset:4096
    ds_read_b32 v67, v61 offset:6144
    s_waitcnt lgkmcnt(0)
    v_max_f32 v41, v64, v65
    v_max3_f32 v41, v41, v66, v67
    ds_read_b32 v64, v62
    ds_read_b32 v65, v62 offset:2048
    ds_read_b32 v66, v62 offset:4096
    ds_read_b32 v67, v62 offset:6144
    s_waitcnt lgkmcnt(0)
    v_max_f32 v42, v64, v65
    v_max3_f32 v42, v42, v66, v67
    ds_read_b32 v64, v63
    ds_read_b32 v65, v63 offset:2048
    ds_read_b32 v66, v63 offset:4096
    ds_read_b32 v67, v63 offset:6144
    s_waitcnt lgkmcnt(0)
    v_max_f32 v43, v64, v65
    v_max3_f32 v43, v43, v66, v67
    s_add_u32 m0, s36, 0
    s_add_u32 s48, s34, 0
    buffer_load_dwordx4 v1, s[20:23], s48 offen lds
    buffer_load_dwordx4 v1, s[20:23], s48 offen offset:1024 lds
    buffer_load_dwordx4 v1, s[20:23], s48 offen offset:2048 lds
    buffer_load_dwordx4 v1, s[20:23], s48 offen offset:3072 lds
    s_add_u32 m0, s36, 4096
    s_add_u32 s48, s34, 0
    buffer_load_dwordx4 v2, s[24:27], s48 offen lds
    buffer_load_dwordx4 v2, s[24:27], s48 offen offset:1024 lds
    buffer_load_dwordx4 v2, s[24:27], s48 offen offset:2048 lds
    buffer_load_dwordx4 v2, s[24:27], s48 offen offset:3072 lds
    s_add_u32 m0, s36, 8192
    s_add_u32 s48, s34, 4096
    buffer_load_dwordx4 v1, s[20:23], s48 offen lds
    buffer_load_dwordx4 v1, s[20:23], s48 offen offset:1024 lds
    buffer_load_dwordx4 v1, s[20:23], s48 offen offset:2048 lds
    buffer_load_dwordx4 v1, s[20:23], s48 offen offset:3072 lds
    s_waitcnt vmcnt(8)
    ds_read_b128 v[144:147], v4
    ds_read_b128 v[148:151], v5
    ds_read_b128 v[152:155], v6
    ds_read_b128 v[156:159], v7
    ds_read_b64_tr_b16 v[160:161], v8
    ds_read_b64_tr_b16 v[162:163], v8 offset:8
    ds_read_b64_tr_b16 v[164:165], v9
    ds_read_b64_tr_b16 v[166:167], v9 offset:8
    ds_read_b64_tr_b16 v[168:169], v8 offset:2048
    ds_read_b64_tr_b16 v[170:171], v8 offset:2056
    ds_read_b64_tr_b16 v[172:173], v9 offset:2048
    ds_read_b64_tr_b16 v[174:175], v9 offset:2056
    s_waitcnt lgkmcnt(11)
    s_waitcnt lgkmcnt(10)
    s_waitcnt lgkmcnt(9)
    s_waitcnt lgkmcnt(8)
    v_mfma_f32_4x4x4_16b_bf16 v[24:27], v[144:145], v[144:145], 0
    s_nop 1
    v_mfma_f32_4x4x4_16b_bf16 v[24:27], v[146:147], v[146:147], v[24:27]
    s_nop 1
    v_mfma_f32_4x4x4_16b_bf16 v[24:27], v[148:149], v[148:149], v[24:27]
    s_nop 1
    v_mfma_f32_4x4x4_16b_bf16 v[24:27], v[150:151], v[150:151], v[24:27]
    s_nop 1
    v_mfma_f32_4x4x4_16b_bf16 v[24:27], v[152:153], v[152:153], v[24:27]
    s_nop 1
    v_mfma_f32_4x4x4_16b_bf16 v[24:27], v[154:155], v[154:155], v[24:27]
    s_nop 1
    v_mfma_f32_4x4x4_16b_bf16 v[24:27], v[156:157], v[156:157], v[24:27]
    s_nop 1
    v_mfma_f32_4x4x4_16b_bf16 v[24:27], v[158:159], v[158:159], v[24:27]
    s_nop 4
    v_cndmask_b32 v28, v24, v25, s[40:41]
    v_cndmask_b32 v28, v28, v26, s[42:43]
    v_cndmask_b32 v28, v28, v27, s[44:45]
    v_sqrt_f32 v28, v28
    s_nop 0
    v_add_f32 v28, 0x358637bd, v28
    v_rcp_f32 v28, v28
    s_nop 0
    v_cvt_pk_bf16_f32 v29, v28, v28
    v_cvt_pk_bf16_f32 v30, v28, v28
    s_nop 1
    v_permlane32_swap_b32 v29, v30
    v_and_b32 v32, v29, v10
    v_and_b32 v33, v29, v11
    v_and_b32 v34, v30, v10
    v_and_b32 v35, v30, v11
    s_waitcnt lgkmcnt(4)
    s_waitcnt lgkmcnt(0)
    v_mfma_f32_4x4x4_16b_bf16 v[176:179], v[160:161], v[32:33], 0
    v_mfma_f32_4x4x4_16b_bf16 v[180:183], v[162:163], v[32:33], 0
    v_mfma_f32_4x4x4_16b_bf16 v[184:187], v[164:165], v[32:33], 0
    v_mfma_f32_4x4x4_16b_bf16 v[188:191], v[166:167], v[32:33], 0
    s_nop 1
    v_cvt_pk_bf16_f32 v96, v176, v177
    v_cvt_pk_bf16_f32 v97, v178, v179
    v_cvt_pk_bf16_f32 v98, v180, v181
    v_cvt_pk_bf16_f32 v99, v182, v183
    v_cvt_pk_bf16_f32 v100, v184, v185
    v_cvt_pk_bf16_f32 v101, v186, v187
    v_cvt_pk_bf16_f32 v102, v188, v189
    v_cvt_pk_bf16_f32 v103, v190, v191
    v_mfma_f32_4x4x4_16b_bf16 v[176:179], v[168:169], v[34:35], 0
    v_mfma_f32_4x4x4_16b_bf16 v[180:183], v[170:171], v[34:35], 0
    v_mfma_f32_4x4x4_16b_bf16 v[184:187], v[172:173], v[34:35], 0
    v_mfma_f32_4x4x4_16b_bf16 v[188:191], v[174:175], v[34:35], 0
    s_nop 1
    v_cvt_pk_bf16_f32 v104, v176, v177
    v_cvt_pk_bf16_f32 v105, v178, v179
    v_cvt_pk_bf16_f32 v106, v180, v181
    v_cvt_pk_bf16_f32 v107, v182, v183
    v_cvt_pk_bf16_f32 v108, v184, v185
    v_cvt_pk_bf16_f32 v109, v186, v187
    v_cvt_pk_bf16_f32 v110, v188, v189
    v_cvt_pk_bf16_f32 v111, v190, v191
    s_waitcnt vmcnt(6)
    ds_read_b64_tr_b16 v[128:129], v3
    ds_read_b64_tr_b16 v[130:131], v3 offset:256
    ds_read_b64_tr_b16 v[132:133], v3 offset:1024
    ds_read_b64_tr_b16 v[134:135], v3 offset:1280
    s_waitcnt lgkmcnt(0)
    v_mfma_f32_32x32x16_bf16 v[48:63], v[96:99], v[192:195], 4.0
    v_mfma_f32_32x32x16_bf16 v[48:63], v[100:103], v[196:199], v[48:63]
    v_mfma_f32_32x32x16_bf16 v[64:79], v[96:99], a[120:123], 4.0
    s_nop 10
    v_sub_f32 v48, v48, v36
    v_exp_f32 v48, v48
    v_sub_f32 v49, v49, v36
    v_exp_f32 v49, v49
    v_sub_f32 v50, v50, v36
    v_exp_f32 v50, v50
    v_mfma_f32_32x32x16_bf16 v[64:79], v[100:103], a[124:127], v[64:79]
    v_sub_f32 v51, v51, v36
    v_exp_f32 v51, v51
    v_sub_f32 v52, v52, v36
    v_exp_f32 v52, v52
    v_sub_f32 v53, v53, v36
    v_exp_f32 v53, v53
    s_waitcnt vmcnt(4)
    v_sub_f32 v54, v54, v36
    v_exp_f32 v54, v54
    v_sub_f32 v55, v55, v36
    v_exp_f32 v55, v55
    v_sub_f32 v56, v56, v36
    v_exp_f32 v56, v56
    ds_read_b64_tr_b16 v[136:137], v3 offset:2048
    v_sub_f32 v57, v57, v36
    v_exp_f32 v57, v57
    v_sub_f32 v58, v58, v36
    v_exp_f32 v58, v58
    v_smfmac_f32_32x32x32_bf16 v[208:223], v[128:131], v[48:55], v12
    v_sub_f32 v59, v59, v36
    v_exp_f32 v59, v59
    v_sub_f32 v60, v60, v36
    v_exp_f32 v60, v60
    v_sub_f32 v61, v61, v36
    v_exp_f32 v61, v61
    v_smfmac_f32_16x16x64_bf16 v[240:243], v[20:23], v[48:55], v12
    ds_read_b64_tr_b16 v[138:139], v3 offset:2304
    v_sub_f32 v62, v62, v36
    v_exp_f32 v62, v62
    v_sub_f32 v63, v63, v36
    v_exp_f32 v63, v63
    v_mfma_f32_32x32x16_bf16 v[80:95], v[96:99], a[136:139], 4.0
    v_sub_f32 v64, v64, v38
    v_exp_f32 v64, v64
    v_sub_f32 v65, v65, v38
    v_exp_f32 v65, v65
    v_sub_f32 v66, v66, v38
    v_exp_f32 v66, v66
    v_mfma_f32_32x32x16_bf16 v[80:95], v[100:103], a[140:143], v[80:95]
    v_sub_f32 v67, v67, v38
    v_exp_f32 v67, v67
    v_sub_f32 v68, v68, v38
    v_exp_f32 v68, v68
    v_sub_f32 v69, v69, v38
    v_exp_f32 v69, v69
    v_smfmac_f32_32x32x32_bf16 v[208:223], v[132:135], v[56:63], v12
    v_sub_f32 v70, v70, v38
    v_exp_f32 v70, v70
    v_sub_f32 v71, v71, v38
    v_exp_f32 v71, v71
    v_sub_f32 v72, v72, v38
    v_exp_f32 v72, v72
    v_smfmac_f32_16x16x64_bf16 v[240:243], v[20:23], v[56:63], v12
    ds_read_b64_tr_b16 v[140:141], v3 offset:3072
    v_sub_f32 v73, v73, v38
    v_exp_f32 v73, v73
    v_sub_f32 v74, v74, v38
    v_exp_f32 v74, v74
    v_smfmac_f32_32x32x32_bf16 a[0:15], v[128:131], v[64:71], v12
    v_sub_f32 v75, v75, v38
    v_exp_f32 v75, v75
    v_sub_f32 v76, v76, v38
    v_exp_f32 v76, v76
    v_sub_f32 v77, v77, v38
    v_exp_f32 v77, v77
    v_smfmac_f32_16x16x64_bf16 a[96:99], v[20:23], v[64:71], v12
    ds_read_b64_tr_b16 v[142:143], v3 offset:3328
    v_sub_f32 v78, v78, v38
    v_exp_f32 v78, v78
    v_sub_f32 v79, v79, v38
    v_exp_f32 v79, v79
    v_mfma_f32_32x32x16_bf16 v[48:63], v[96:99], a[152:155], 4.0
    v_sub_f32 v80, v80, v40
    v_exp_f32 v80, v80
    v_sub_f32 v81, v81, v40
    v_exp_f32 v81, v81
    v_sub_f32 v82, v82, v40
    v_exp_f32 v82, v82
    v_mfma_f32_32x32x16_bf16 v[48:63], v[100:103], a[156:159], v[48:63]
    v_sub_f32 v83, v83, v40
    v_exp_f32 v83, v83
    v_sub_f32 v84, v84, v40
    v_exp_f32 v84, v84
    v_sub_f32 v85, v85, v40
    v_exp_f32 v85, v85
    v_smfmac_f32_32x32x32_bf16 a[0:15], v[132:135], v[72:79], v12
    s_waitcnt vmcnt(0)
    v_sub_f32 v86, v86, v40
    v_exp_f32 v86, v86
    v_sub_f32 v87, v87, v40
    v_exp_f32 v87, v87
    v_sub_f32 v88, v88, v40
    v_exp_f32 v88, v88
    v_smfmac_f32_16x16x64_bf16 a[96:99], v[20:23], v[72:79], v12
    ds_read_b128 v[144:147], v4 offset:8192
    v_sub_f32 v89, v89, v40
    v_exp_f32 v89, v89
    v_sub_f32 v90, v90, v40
    v_exp_f32 v90, v90
    v_smfmac_f32_32x32x32_bf16 a[32:47], v[128:131], v[80:87], v12
    v_sub_f32 v91, v91, v40
    v_exp_f32 v91, v91
    v_sub_f32 v92, v92, v40
    v_exp_f32 v92, v92
    v_sub_f32 v93, v93, v40
    v_exp_f32 v93, v93
    v_smfmac_f32_16x16x64_bf16 a[104:107], v[20:23], v[80:87], v12
    ds_read_b128 v[148:151], v5 offset:8192
    v_sub_f32 v94, v94, v40
    v_exp_f32 v94, v94
    v_sub_f32 v95, v95, v40
    v_exp_f32 v95, v95
    v_mfma_f32_32x32x16_bf16 v[64:79], v[104:107], v[192:195], 4.0
    v_sub_f32 v48, v48, v42
    v_exp_f32 v48, v48
    v_sub_f32 v49, v49, v42
    v_exp_f32 v49, v49
    v_sub_f32 v50, v50, v42
    v_exp_f32 v50, v50
    v_mfma_f32_32x32x16_bf16 v[64:79], v[108:111], v[196:199], v[64:79]
    v_sub_f32 v51, v51, v42
    v_exp_f32 v51, v51
    v_sub_f32 v52, v52, v42
    v_exp_f32 v52, v52
    v_sub_f32 v53, v53, v42
    v_exp_f32 v53, v53
    v_smfmac_f32_32x32x32_bf16 a[32:47], v[132:135], v[88:95], v12
    v_sub_f32 v54, v54, v42
    v_exp_f32 v54, v54
    v_sub_f32 v55, v55, v42
    v_exp_f32 v55, v55
    v_sub_f32 v56, v56, v42
    v_exp_f32 v56, v56
    v_smfmac_f32_16x16x64_bf16 a[104:107], v[20:23], v[88:95], v12
    ds_read_b128 v[152:155], v6 offset:8192
    v_sub_f32 v57, v57, v42
    v_exp_f32 v57, v57
    v_sub_f32 v58, v58, v42
    v_exp_f32 v58, v58
    v_smfmac_f32_32x32x32_bf16 a[64:79], v[128:131], v[48:55], v12
    v_sub_f32 v59, v59, v42
    v_exp_f32 v59, v59
    v_sub_f32 v60, v60, v42
    v_exp_f32 v60, v60
    v_sub_f32 v61, v61, v42
    v_exp_f32 v61, v61
    v_smfmac_f32_16x16x64_bf16 a[112:115], v[20:23], v[48:55], v12
    ds_read_b128 v[156:159], v7 offset:8192
    v_sub_f32 v62, v62, v42
    v_exp_f32 v62, v62
    v_sub_f32 v63, v63, v42
    v_exp_f32 v63, v63
    v_mfma_f32_32x32x16_bf16 v[80:95], v[104:107], a[120:123], 4.0
    v_sub_f32 v64, v64, v36
    v_exp_f32 v64, v64
    v_sub_f32 v65, v65, v36
    v_exp_f32 v65, v65
    v_sub_f32 v66, v66, v36
    v_exp_f32 v66, v66
    v_mfma_f32_32x32x16_bf16 v[80:95], v[108:111], a[124:127], v[80:95]
    s_waitcnt lgkmcnt(4)
    v_sub_f32 v67, v67, v36
    v_exp_f32 v67, v67
    v_sub_f32 v68, v68, v36
    v_exp_f32 v68, v68
    v_sub_f32 v69, v69, v36
    v_exp_f32 v69, v69
    v_smfmac_f32_32x32x32_bf16 a[64:79], v[132:135], v[56:63], v12
    v_sub_f32 v70, v70, v36
    v_exp_f32 v70, v70
    v_sub_f32 v71, v71, v36
    v_exp_f32 v71, v71
    v_sub_f32 v72, v72, v36
    v_exp_f32 v72, v72
    v_smfmac_f32_16x16x64_bf16 a[112:115], v[20:23], v[56:63], v12
    ds_read_b64_tr_b16 v[160:161], v8 offset:8192
    v_sub_f32 v73, v73, v36
    v_exp_f32 v73, v73
    v_sub_f32 v74, v74, v36
    v_exp_f32 v74, v74
    v_smfmac_f32_32x32x32_bf16 v[208:223], v[136:139], v[64:71], v12
    s_waitcnt lgkmcnt(4)
    v_sub_f32 v75, v75, v36
    v_exp_f32 v75, v75
    v_sub_f32 v76, v76, v36
    v_exp_f32 v76, v76
    v_sub_f32 v77, v77, v36
    v_exp_f32 v77, v77
    v_smfmac_f32_16x16x64_bf16 v[240:243], v[20:23], v[64:71], v12
    ds_read_b64_tr_b16 v[162:163], v8 offset:8200
    v_sub_f32 v78, v78, v36
    v_exp_f32 v78, v78
    v_mfma_f32_4x4x4_16b_bf16 v[24:27], v[144:145], v[144:145], 0
    v_sub_f32 v79, v79, v36
    v_exp_f32 v79, v79
    v_mfma_f32_32x32x16_bf16 v[48:63], v[104:107], a[136:139], 4.0
    s_add_u32 m0, s36, 12288
    v_sub_f32 v80, v80, v38
    v_exp_f32 v80, v80
    v_sub_f32 v81, v81, v38
    v_exp_f32 v81, v81
    v_sub_f32 v82, v82, v38
    v_exp_f32 v82, v82
    v_mfma_f32_32x32x16_bf16 v[48:63], v[108:111], a[140:143], v[48:63]
    s_add_u32 s48, s34, 4096
    v_sub_f32 v83, v83, v38
    v_exp_f32 v83, v83
    v_sub_f32 v84, v84, v38
    v_exp_f32 v84, v84
    v_sub_f32 v85, v85, v38
    v_exp_f32 v85, v85
    v_smfmac_f32_32x32x32_bf16 v[208:223], v[140:143], v[72:79], v12
    buffer_load_dwordx4 v2, s[24:27], s48 offen lds
    buffer_load_dwordx4 v2, s[24:27], s48 offen offset:1024 lds
    v_sub_f32 v86, v86, v38
    v_exp_f32 v86, v86
    v_sub_f32 v87, v87, v38
    v_exp_f32 v87, v87
    v_sub_f32 v88, v88, v38
    v_exp_f32 v88, v88
    v_smfmac_f32_16x16x64_bf16 v[240:243], v[20:23], v[72:79], v12
    ds_read_b64_tr_b16 v[164:165], v9 offset:8192
    v_sub_f32 v89, v89, v38
    v_exp_f32 v89, v89
    v_mfma_f32_4x4x4_16b_bf16 v[24:27], v[146:147], v[146:147], v[24:27]
    v_sub_f32 v90, v90, v38
    v_exp_f32 v90, v90
    v_smfmac_f32_32x32x32_bf16 a[0:15], v[136:139], v[80:87], v12
    s_waitcnt lgkmcnt(5)
    buffer_load_dwordx4 v2, s[24:27], s48 offen offset:2048 lds
    buffer_load_dwordx4 v2, s[24:27], s48 offen offset:3072 lds
    v_sub_f32 v91, v91, v38
    v_exp_f32 v91, v91
    v_sub_f32 v92, v92, v38
    v_exp_f32 v92, v92
    v_sub_f32 v93, v93, v38
    v_exp_f32 v93, v93
    v_smfmac_f32_16x16x64_bf16 a[96:99], v[20:23], v[80:87], v12
    ds_read_b64_tr_b16 v[166:167], v9 offset:8200
    v_sub_f32 v94, v94, v38
    v_exp_f32 v94, v94
    v_mfma_f32_4x4x4_16b_bf16 v[24:27], v[148:149], v[148:149], v[24:27]
    v_sub_f32 v95, v95, v38
    v_exp_f32 v95, v95
    v_mfma_f32_32x32x16_bf16 v[64:79], v[104:107], a[152:155], 4.0
    s_add_u32 m0, s36, 16384
    v_sub_f32 v48, v48, v40
    v_exp_f32 v48, v48
    v_sub_f32 v49, v49, v40
    v_exp_f32 v49, v49
    v_sub_f32 v50, v50, v40
    v_exp_f32 v50, v50
    v_mfma_f32_32x32x16_bf16 v[64:79], v[108:111], a[156:159], v[64:79]
    s_add_u32 s48, s34, 8192
    v_sub_f32 v51, v51, v40
    v_exp_f32 v51, v51
    v_sub_f32 v52, v52, v40
    v_exp_f32 v52, v52
    v_sub_f32 v53, v53, v40
    v_exp_f32 v53, v53
    v_smfmac_f32_32x32x32_bf16 a[0:15], v[140:143], v[88:95], v12
    buffer_load_dwordx4 v1, s[20:23], s48 offen lds
    buffer_load_dwordx4 v1, s[20:23], s48 offen offset:1024 lds
    v_sub_f32 v54, v54, v40
    v_exp_f32 v54, v54
    v_sub_f32 v55, v55, v40
    v_exp_f32 v55, v55
    v_sub_f32 v56, v56, v40
    v_exp_f32 v56, v56
    v_smfmac_f32_16x16x64_bf16 a[96:99], v[20:23], v[88:95], v12
    ds_read_b64_tr_b16 v[168:169], v8 offset:10240
    v_sub_f32 v57, v57, v40
    v_exp_f32 v57, v57
    v_mfma_f32_4x4x4_16b_bf16 v[24:27], v[150:151], v[150:151], v[24:27]
    v_sub_f32 v58, v58, v40
    v_exp_f32 v58, v58
    v_smfmac_f32_32x32x32_bf16 a[32:47], v[136:139], v[48:55], v12
    s_waitcnt lgkmcnt(6)
    buffer_load_dwordx4 v1, s[20:23], s48 offen offset:2048 lds
    buffer_load_dwordx4 v1, s[20:23], s48 offen offset:3072 lds
    v_sub_f32 v59, v59, v40
    v_exp_f32 v59, v59
    v_sub_f32 v60, v60, v40
    v_exp_f32 v60, v60
    v_sub_f32 v61, v61, v40
    v_exp_f32 v61, v61
    v_smfmac_f32_16x16x64_bf16 a[104:107], v[20:23], v[48:55], v12
    ds_read_b64_tr_b16 v[170:171], v8 offset:10248
    v_sub_f32 v62, v62, v40
    v_exp_f32 v62, v62
    v_mfma_f32_4x4x4_16b_bf16 v[24:27], v[152:153], v[152:153], v[24:27]
    v_sub_f32 v63, v63, v40
    v_exp_f32 v63, v63
    v_mfma_f32_32x32x16_bf16 v[80:95], v[96:99], v[200:203], 4.0
    v_sub_f32 v64, v64, v42
    v_exp_f32 v64, v64
    v_sub_f32 v65, v65, v42
    v_exp_f32 v65, v65
    v_sub_f32 v66, v66, v42
    v_exp_f32 v66, v66
    v_mfma_f32_32x32x16_bf16 v[80:95], v[100:103], v[204:207], v[80:95]
    v_sub_f32 v67, v67, v42
    v_exp_f32 v67, v67
    v_sub_f32 v68, v68, v42
    v_exp_f32 v68, v68
    v_sub_f32 v69, v69, v42
    v_exp_f32 v69, v69
    v_smfmac_f32_32x32x32_bf16 a[32:47], v[140:143], v[56:63], v12
    v_sub_f32 v70, v70, v42
    v_exp_f32 v70, v70
    v_sub_f32 v71, v71, v42
    v_exp_f32 v71, v71
    v_sub_f32 v72, v72, v42
    v_exp_f32 v72, v72
    v_smfmac_f32_16x16x64_bf16 a[104:107], v[20:23], v[56:63], v12
    ds_read_b64_tr_b16 v[172:173], v9 offset:10240
    v_sub_f32 v73, v73, v42
    v_exp_f32 v73, v73
    v_mfma_f32_4x4x4_16b_bf16 v[24:27], v[154:155], v[154:155], v[24:27]
    v_sub_f32 v74, v74, v42
    v_exp_f32 v74, v74
    v_smfmac_f32_32x32x32_bf16 a[64:79], v[136:139], v[64:71], v12
    s_waitcnt lgkmcnt(7)
    v_sub_f32 v75, v75, v42
    v_exp_f32 v75, v75
    v_sub_f32 v76, v76, v42
    v_exp_f32 v76, v76
    v_sub_f32 v77, v77, v42
    v_exp_f32 v77, v77
    v_smfmac_f32_16x16x64_bf16 a[112:115], v[20:23], v[64:71], v12
    ds_read_b64_tr_b16 v[174:175], v9 offset:10248
    v_sub_f32 v78, v78, v42
    v_exp_f32 v78, v78
    v_mfma_f32_4x4x4_16b_bf16 v[24:27], v[156:157], v[156:157], v[24:27]
    v_sub_f32 v79, v79, v42
    v_exp_f32 v79, v79
    v_mfma_f32_32x32x16_bf16 v[48:63], v[104:107], v[200:203], 4.0
    v_sub_f32 v80, v80, v37
    v_exp_f32 v80, v80
    v_sub_f32 v81, v81, v37
    v_exp_f32 v81, v81
    v_sub_f32 v82, v82, v37
    v_exp_f32 v82, v82
    v_mfma_f32_32x32x16_bf16 v[48:63], v[108:111], v[204:207], v[48:63]
    v_sub_f32 v83, v83, v37
    v_exp_f32 v83, v83
    v_sub_f32 v84, v84, v37
    v_exp_f32 v84, v84
    v_sub_f32 v85, v85, v37
    v_exp_f32 v85, v85
    v_smfmac_f32_32x32x32_bf16 a[64:79], v[140:143], v[72:79], v12
    v_sub_f32 v86, v86, v37
    v_exp_f32 v86, v86
    v_sub_f32 v87, v87, v37
    v_exp_f32 v87, v87
    v_sub_f32 v88, v88, v37
    v_exp_f32 v88, v88
    v_smfmac_f32_16x16x64_bf16 a[112:115], v[20:23], v[72:79], v12
    v_sub_f32 v89, v89, v37
    v_exp_f32 v89, v89
    v_mfma_f32_4x4x4_16b_bf16 v[24:27], v[158:159], v[158:159], v[24:27]
    v_sub_f32 v90, v90, v37
    v_exp_f32 v90, v90
    v_smfmac_f32_32x32x32_bf16 v[224:239], v[128:131], v[80:87], v12
    v_sub_f32 v91, v91, v37
    v_exp_f32 v91, v91
    v_sub_f32 v92, v92, v37
    v_exp_f32 v92, v92
    v_sub_f32 v93, v93, v37
    v_exp_f32 v93, v93
    v_smfmac_f32_16x16x64_bf16 v[244:247], v[20:23], v[80:87], v12
    v_sub_f32 v94, v94, v37
    v_exp_f32 v94, v94
    v_sub_f32 v95, v95, v37
    v_exp_f32 v95, v95
    v_cndmask_b32 v28, v24, v25, s[40:41]
    v_mfma_f32_32x32x16_bf16 v[64:79], v[96:99], a[128:131], 4.0
    v_sub_f32 v48, v48, v37
    v_exp_f32 v48, v48
    v_sub_f32 v49, v49, v37
    v_exp_f32 v49, v49
    v_sub_f32 v50, v50, v37
    v_exp_f32 v50, v50
    v_cndmask_b32 v28, v28, v26, s[42:43]
    v_mfma_f32_32x32x16_bf16 v[64:79], v[100:103], a[132:135], v[64:79]
    v_sub_f32 v51, v51, v37
    v_exp_f32 v51, v51
    v_sub_f32 v52, v52, v37
    v_exp_f32 v52, v52
    v_sub_f32 v53, v53, v37
    v_exp_f32 v53, v53
    v_cndmask_b32 v28, v28, v27, s[44:45]
    v_smfmac_f32_32x32x32_bf16 v[224:239], v[132:135], v[88:95], v12
    v_sub_f32 v54, v54, v37
    v_exp_f32 v54, v54
    v_sub_f32 v55, v55, v37
    v_exp_f32 v55, v55
    v_sub_f32 v56, v56, v37
    v_exp_f32 v56, v56
    v_sqrt_f32 v28, v28
    v_smfmac_f32_16x16x64_bf16 v[244:247], v[20:23], v[88:95], v12
    v_sub_f32 v57, v57, v37
    v_exp_f32 v57, v57
    v_sub_f32 v58, v58, v37
    v_exp_f32 v58, v58
    v_add_f32 v28, 0x358637bd, v28
    v_smfmac_f32_32x32x32_bf16 v[224:239], v[136:139], v[48:55], v12
    v_sub_f32 v59, v59, v37
    v_exp_f32 v59, v59
    v_sub_f32 v60, v60, v37
    v_exp_f32 v60, v60
    v_sub_f32 v61, v61, v37
    v_exp_f32 v61, v61
    v_rcp_f32 v28, v28
    v_smfmac_f32_16x16x64_bf16 v[244:247], v[20:23], v[48:55], v12
    v_sub_f32 v62, v62, v37
    v_exp_f32 v62, v62
    v_sub_f32 v63, v63, v37
    v_exp_f32 v63, v63
    v_cvt_pk_bf16_f32 v29, v28, v28
    v_cvt_pk_bf16_f32 v30, v28, v28
    v_mfma_f32_32x32x16_bf16 v[80:95], v[96:99], a[144:147], 4.0
    v_sub_f32 v64, v64, v39
    v_exp_f32 v64, v64
    v_sub_f32 v65, v65, v39
    v_exp_f32 v65, v65
    v_sub_f32 v66, v66, v39
    v_exp_f32 v66, v66
    v_permlane32_swap_b32 v29, v30
    v_mfma_f32_32x32x16_bf16 v[80:95], v[100:103], a[148:151], v[80:95]
    v_sub_f32 v67, v67, v39
    v_exp_f32 v67, v67
    v_sub_f32 v68, v68, v39
    v_exp_f32 v68, v68
    v_sub_f32 v69, v69, v39
    v_exp_f32 v69, v69
    v_and_b32 v32, v29, v10
    v_and_b32 v33, v29, v11
    v_smfmac_f32_32x32x32_bf16 v[224:239], v[140:143], v[56:63], v12
    v_sub_f32 v70, v70, v39
    v_exp_f32 v70, v70
    v_sub_f32 v71, v71, v39
    v_exp_f32 v71, v71
    v_sub_f32 v72, v72, v39
    v_exp_f32 v72, v72
    v_and_b32 v34, v30, v10
    v_and_b32 v35, v30, v11
    v_smfmac_f32_16x16x64_bf16 v[244:247], v[20:23], v[56:63], v12
    v_sub_f32 v73, v73, v39
    v_exp_f32 v73, v73
    v_sub_f32 v74, v74, v39
    v_exp_f32 v74, v74
    v_smfmac_f32_32x32x32_bf16 a[16:31], v[128:131], v[64:71], v12
    s_waitcnt lgkmcnt(4)
    v_sub_f32 v75, v75, v39
    v_exp_f32 v75, v75
    v_sub_f32 v76, v76, v39
    v_exp_f32 v76, v76
    v_sub_f32 v77, v77, v39
    v_exp_f32 v77, v77
    v_smfmac_f32_16x16x64_bf16 a[100:103], v[20:23], v[64:71], v12
    v_sub_f32 v78, v78, v39
    v_exp_f32 v78, v78
    v_mfma_f32_4x4x4_16b_bf16 v[176:179], v[160:161], v[32:33], 0
    v_sub_f32 v79, v79, v39
    v_exp_f32 v79, v79
    v_mfma_f32_32x32x16_bf16 v[48:63], v[96:99], a[160:163], 4.0
    s_add_u32 m0, s36, 20480
    v_sub_f32 v80, v80, v41
    v_exp_f32 v80, v80
    v_sub_f32 v81, v81, v41
    v_exp_f32 v81, v81
    v_sub_f32 v82, v82, v41
    v_exp_f32 v82, v82
    v_mfma_f32_32x32x16_bf16 v[48:63], v[100:103], a[164:167], v[48:63]
    s_add_u32 s48, s34, 8192
    v_sub_f32 v83, v83, v41
    v_exp_f32 v83, v83
    v_sub_f32 v84, v84, v41
    v_exp_f32 v84, v84
    v_sub_f32 v85, v85, v41
    v_exp_f32 v85, v85
    v_cvt_pk_bf16_f32 v112, v176, v177
    v_cvt_pk_bf16_f32 v113, v178, v179
    v_smfmac_f32_32x32x32_bf16 a[16:31], v[132:135], v[72:79], v12
    v_sub_f32 v86, v86, v41
    v_exp_f32 v86, v86
    v_sub_f32 v87, v87, v41
    v_exp_f32 v87, v87
    v_sub_f32 v88, v88, v41
    v_exp_f32 v88, v88
    v_smfmac_f32_16x16x64_bf16 a[100:103], v[20:23], v[72:79], v12
    buffer_load_dwordx4 v2, s[24:27], s48 offen lds
    v_sub_f32 v89, v89, v41
    v_exp_f32 v89, v89
    v_mfma_f32_4x4x4_16b_bf16 v[180:183], v[162:163], v[32:33], 0
    v_sub_f32 v90, v90, v41
    v_exp_f32 v90, v90
    v_smfmac_f32_32x32x32_bf16 a[48:63], v[128:131], v[80:87], v12
    v_sub_f32 v91, v91, v41
    v_exp_f32 v91, v91
    v_sub_f32 v92, v92, v41
    v_exp_f32 v92, v92
    v_sub_f32 v93, v93, v41
    v_exp_f32 v93, v93
    v_smfmac_f32_16x16x64_bf16 a[108:111], v[20:23], v[80:87], v12
    buffer_load_dwordx4 v2, s[24:27], s48 offen offset:1024 lds
    v_sub_f32 v94, v94, v41
    v_exp_f32 v94, v94
    v_mfma_f32_4x4x4_16b_bf16 v[184:187], v[164:165], v[32:33], 0
    v_sub_f32 v95, v95, v41
    v_exp_f32 v95, v95
    v_cvt_pk_bf16_f32 v114, v180, v181
    v_cvt_pk_bf16_f32 v115, v182, v183
    v_mfma_f32_32x32x16_bf16 v[64:79], v[104:107], a[128:131], 4.0
    v_sub_f32 v48, v48, v43
    v_exp_f32 v48, v48
    v_sub_f32 v49, v49, v43
    v_exp_f32 v49, v49
    v_sub_f32 v50, v50, v43
    v_exp_f32 v50, v50
    v_mfma_f32_32x32x16_bf16 v[64:79], v[108:111], a[132:135], v[64:79]
    v_sub_f32 v51, v51, v43
    v_exp_f32 v51, v51
    v_sub_f32 v52, v52, v43
    v_exp_f32 v52, v52
    v_sub_f32 v53, v53, v43
    v_exp_f32 v53, v53
    v_cvt_pk_bf16_f32 v116, v184, v185
    v_cvt_pk_bf16_f32 v117, v186, v187
    v_smfmac_f32_32x32x32_bf16 a[48:63], v[132:135], v[88:95], v12
    v_sub_f32 v54, v54, v43
    v_exp_f32 v54, v54
    v_sub_f32 v55, v55, v43
    v_exp_f32 v55, v55
    v_sub_f32 v56, v56, v43
    v_exp_f32 v56, v56
    v_smfmac_f32_16x16x64_bf16 a[108:111], v[20:23], v[88:95], v12
    buffer_load_dwordx4 v2, s[24:27], s48 offen offset:2048 lds
    v_sub_f32 v57, v57, v43
    v_exp_f32 v57, v57
    v_mfma_f32_4x4x4_16b_bf16 v[188:191], v[166:167], v[32:33], 0
    v_sub_f32 v58, v58, v43
    v_exp_f32 v58, v58
    v_smfmac_f32_32x32x32_bf16 a[80:95], v[128:131], v[48:55], v12
    s_waitcnt lgkmcnt(0)
    v_sub_f32 v59, v59, v43
    v_exp_f32 v59, v59
    v_sub_f32 v60, v60, v43
    v_exp_f32 v60, v60
    v_sub_f32 v61, v61, v43
    v_exp_f32 v61, v61
    v_smfmac_f32_16x16x64_bf16 a[116:119], v[20:23], v[48:55], v12
    buffer_load_dwordx4 v2, s[24:27], s48 offen offset:3072 lds
    v_sub_f32 v62, v62, v43
    v_exp_f32 v62, v62
    v_mfma_f32_4x4x4_16b_bf16 v[176:179], v[168:169], v[34:35], 0
    v_sub_f32 v63, v63, v43
    v_exp_f32 v63, v63
    v_cvt_pk_bf16_f32 v118, v188, v189
    v_cvt_pk_bf16_f32 v119, v190, v191
    v_mfma_f32_32x32x16_bf16 v[80:95], v[104:107], a[144:147], 4.0
    v_sub_f32 v64, v64, v39
    v_exp_f32 v64, v64
    v_sub_f32 v65, v65, v39
    v_exp_f32 v65, v65
    v_sub_f32 v66, v66, v39
    v_exp_f32 v66, v66
    v_mfma_f32_32x32x16_bf16 v[80:95], v[108:111], a[148:151], v[80:95]
    v_sub_f32 v67, v67, v39
    v_exp_f32 v67, v67
    v_sub_f32 v68, v68, v39
    v_exp_f32 v68, v68
    v_sub_f32 v69, v69, v39
    v_exp_f32 v69, v69
    v_cvt_pk_bf16_f32 v120, v176, v177
    v_cvt_pk_bf16_f32 v121, v178, v179
    v_smfmac_f32_32x32x32_bf16 a[80:95], v[132:135], v[56:63], v12
    s_waitcnt vmcnt(10)
    v_sub_f32 v70, v70, v39
    v_exp_f32 v70, v70
    v_sub_f32 v71, v71, v39
    v_exp_f32 v71, v71
    v_sub_f32 v72, v72, v39
    v_exp_f32 v72, v72
    v_smfmac_f32_16x16x64_bf16 a[116:119], v[20:23], v[56:63], v12
    ds_read_b64_tr_b16 v[128:129], v3 offset:8192
    v_sub_f32 v73, v73, v39
    v_exp_f32 v73, v73
    v_mfma_f32_4x4x4_16b_bf16 v[180:183], v[170:171], v[34:35], 0
    v_sub_f32 v74, v74, v39
    v_exp_f32 v74, v74
    v_smfmac_f32_32x32x32_bf16 a[16:31], v[136:139], v[64:71], v12
    v_sub_f32 v75, v75, v39
    v_exp_f32 v75, v75
    v_sub_f32 v76, v76, v39
    v_exp_f32 v76, v76
    v_sub_f32 v77, v77, v39
    v_exp_f32 v77, v77
    v_smfmac_f32_16x16x64_bf16 a[100:103], v[20:23], v[64:71], v12
    ds_read_b64_tr_b16 v[130:131], v3 offset:8448
    v_sub_f32 v78, v78, v39
    v_exp_f32 v78, v78
    v_mfma_f32_4x4x4_16b_bf16 v[184:187], v[172:173], v[34:35], 0
    v_sub_f32 v79, v79, v39
    v_exp_f32 v79, v79
    v_cvt_pk_bf16_f32 v122, v180, v181
    v_cvt_pk_bf16_f32 v123, v182, v183
    v_mfma_f32_32x32x16_bf16 v[48:63], v[104:107], a[160:163], 4.0
    v_sub_f32 v80, v80, v41
    v_exp_f32 v80, v80
    v_sub_f32 v81, v81, v41
    v_exp_f32 v81, v81
    v_sub_f32 v82, v82, v41
    v_exp_f32 v82, v82
    v_mfma_f32_32x32x16_bf16 v[48:63], v[108:111], a[164:167], v[48:63]
    v_sub_f32 v83, v83, v41
    v_exp_f32 v83, v83
    v_sub_f32 v84, v84, v41
    v_exp_f32 v84, v84
    v_sub_f32 v85, v85, v41
    v_exp_f32 v85, v85
    v_cvt_pk_bf16_f32 v124, v184, v185
    v_cvt_pk_bf16_f32 v125, v186, v187
    v_smfmac_f32_32x32x32_bf16 a[16:31], v[140:143], v[72:79], v12
    v_sub_f32 v86, v86, v41
    v_exp_f32 v86, v86
    v_sub_f32 v87, v87, v41
    v_exp_f32 v87, v87
    v_sub_f32 v88, v88, v41
    v_exp_f32 v88, v88
    v_smfmac_f32_16x16x64_bf16 a[100:103], v[20:23], v[72:79], v12
    ds_read_b64_tr_b16 v[132:133], v3 offset:9216
    v_sub_f32 v89, v89, v41
    v_exp_f32 v89, v89
    v_mfma_f32_4x4x4_16b_bf16 v[188:191], v[174:175], v[34:35], 0
    v_sub_f32 v90, v90, v41
    v_exp_f32 v90, v90
    v_smfmac_f32_32x32x32_bf16 a[48:63], v[136:139], v[80:87], v12
    v_sub_f32 v91, v91, v41
    v_exp_f32 v91, v91
    v_sub_f32 v92, v92, v41
    v_exp_f32 v92, v92
    v_sub_f32 v93, v93, v41
    v_exp_f32 v93, v93
    v_smfmac_f32_16x16x64_bf16 a[108:111], v[20:23], v[80:87], v12
    ds_read_b64_tr_b16 v[134:135], v3 offset:9472
    v_sub_f32 v94, v94, v41
    v_exp_f32 v94, v94
    v_sub_f32 v95, v95, v41
    v_exp_f32 v95, v95
    v_cvt_pk_bf16_f32 v126, v188, v189
    v_cvt_pk_bf16_f32 v127, v190, v191
    v_mfma_f32_32x32x16_bf16 v[64:79], v[112:115], v[192:195], 4.0
    s_add_u32 m0, s36, 24576
    v_sub_f32 v48, v48, v43
    v_exp_f32 v48, v48
    v_sub_f32 v49, v49, v43
    v_exp_f32 v49, v49
    v_sub_f32 v50, v50, v43
    v_exp_f32 v50, v50
    v_mfma_f32_32x32x16_bf16 v[64:79], v[116:119], v[196:199], v[64:79]
    s_add_u32 s48, s34, 12288
    v_sub_f32 v51, v51, v43
    v_exp_f32 v51, v51
    v_sub_f32 v52, v52, v43
    v_exp_f32 v52, v52
    v_sub_f32 v53, v53, v43
    v_exp_f32 v53, v53
    v_smfmac_f32_32x32x32_bf16 a[48:63], v[140:143], v[88:95], v12
    buffer_load_dwordx4 v1, s[20:23], s48 offen lds
    buffer_load_dwordx4 v1, s[20:23], s48 offen offset:1024 lds
    v_sub_f32 v54, v54, v43
    v_exp_f32 v54, v54
    v_sub_f32 v55, v55, v43
    v_exp_f32 v55, v55
    v_sub_f32 v56, v56, v43
    v_exp_f32 v56, v56
    v_smfmac_f32_16x16x64_bf16 a[108:111], v[20:23], v[88:95], v12
    v_sub_f32 v57, v57, v43
    v_exp_f32 v57, v57
    v_sub_f32 v58, v58, v43
    v_exp_f32 v58, v58
    v_smfmac_f32_32x32x32_bf16 a[80:95], v[136:139], v[48:55], v12
    s_waitcnt lgkmcnt(0)
    buffer_load_dwordx4 v1, s[20:23], s48 offen offset:2048 lds
    buffer_load_dwordx4 v1, s[20:23], s48 offen offset:3072 lds
    v_sub_f32 v59, v59, v43
    v_exp_f32 v59, v59
    v_sub_f32 v60, v60, v43
    v_exp_f32 v60, v60
    v_sub_f32 v61, v61, v43
    v_exp_f32 v61, v61
    v_smfmac_f32_16x16x64_bf16 a[116:119], v[20:23], v[48:55], v12
    v_sub_f32 v62, v62, v43
    v_exp_f32 v62, v62
    v_sub_f32 v63, v63, v43
    v_exp_f32 v63, v63
    v_mfma_f32_32x32x16_bf16 v[80:95], v[112:115], v[200:203], 4.0
    v_sub_f32 v64, v64, v36
    v_exp_f32 v64, v64
    v_sub_f32 v65, v65, v36
    v_exp_f32 v65, v65
    v_sub_f32 v66, v66, v36
    v_exp_f32 v66, v66
    v_mfma_f32_32x32x16_bf16 v[80:95], v[116:119], v[204:207], v[80:95]
    v_sub_f32 v67, v67, v36
    v_exp_f32 v67, v67
    v_sub_f32 v68, v68, v36
    v_exp_f32 v68, v68
    v_sub_f32 v69, v69, v36
    v_exp_f32 v69, v69
    v_smfmac_f32_32x32x32_bf16 a[80:95], v[140:143], v[56:63], v12
    s_waitcnt vmcnt(8)
    v_sub_f32 v70, v70, v36
    v_exp_f32 v70, v70
    v_sub_f32 v71, v71, v36
    v_exp_f32 v71, v71
    v_sub_f32 v72, v72, v36
    v_exp_f32 v72, v72
    v_smfmac_f32_16x16x64_bf16 a[116:119], v[20:23], v[56:63], v12
    ds_read_b128 v[144:147], v4 offset:16384
    v_sub_f32 v73, v73, v36
    v_exp_f32 v73, v73
    v_sub_f32 v74, v74, v36
    v_exp_f32 v74, v74
    v_smfmac_f32_32x32x32_bf16 v[208:223], v[128:131], v[64:71], v12
    v_sub_f32 v75, v75, v36
    v_exp_f32 v75, v75
    v_sub_f32 v76, v76, v36
    v_exp_f32 v76, v76
    v_sub_f32 v77, v77, v36
    v_exp_f32 v77, v77
    v_smfmac_f32_16x16x64_bf16 v[240:243], v[20:23], v[64:71], v12
    ds_read_b128 v[148:151], v5 offset:16384
    v_sub_f32 v78, v78, v36
    v_exp_f32 v78, v78
    v_sub_f32 v79, v79, v36
    v_exp_f32 v79, v79
    v_mfma_f32_32x32x16_bf16 v[48:63], v[112:115], a[120:123], 4.0
    v_sub_f32 v80, v80, v37
    v_exp_f32 v80, v80
    v_sub_f32 v81, v81, v37
    v_exp_f32 v81, v81
    v_sub_f32 v82, v82, v37
    v_exp_f32 v82, v82
    v_mfma_f32_32x32x16_bf16 v[48:63], v[116:119], a[124:127], v[48:63]
    v_sub_f32 v83, v83, v37
    v_exp_f32 v83, v83
    v_sub_f32 v84, v84, v37
    v_exp_f32 v84, v84
    v_sub_f32 v85, v85, v37
    v_exp_f32 v85, v85
    v_smfmac_f32_32x32x32_bf16 v[208:223], v[132:135], v[72:79], v12
    v_sub_f32 v86, v86, v37
    v_exp_f32 v86, v86
    v_sub_f32 v87, v87, v37
    v_exp_f32 v87, v87
    v_sub_f32 v88, v88, v37
    v_exp_f32 v88, v88
    v_smfmac_f32_16x16x64_bf16 v[240:243], v[20:23], v[72:79], v12
    ds_read_b128 v[152:155], v6 offset:16384
    v_sub_f32 v89, v89, v37
    v_exp_f32 v89, v89
    v_sub_f32 v90, v90, v37
    v_exp_f32 v90, v90
    v_smfmac_f32_32x32x32_bf16 v[224:239], v[128:131], v[80:87], v12
    v_sub_f32 v91, v91, v37
    v_exp_f32 v91, v91
    v_sub_f32 v92, v92, v37
    v_exp_f32 v92, v92
    v_sub_f32 v93, v93, v37
    v_exp_f32 v93, v93
    v_smfmac_f32_16x16x64_bf16 v[244:247], v[20:23], v[80:87], v12
    ds_read_b128 v[156:159], v7 offset:16384
    v_sub_f32 v94, v94, v37
    v_exp_f32 v94, v94
    v_sub_f32 v95, v95, v37
    v_exp_f32 v95, v95
    v_mfma_f32_32x32x16_bf16 v[64:79], v[112:115], a[128:131], 4.0
    v_sub_f32 v48, v48, v38
    v_exp_f32 v48, v48
    v_sub_f32 v49, v49, v38
    v_exp_f32 v49, v49
    v_sub_f32 v50, v50, v38
    v_exp_f32 v50, v50
    v_mfma_f32_32x32x16_bf16 v[64:79], v[116:119], a[132:135], v[64:79]
    v_sub_f32 v51, v51, v38
    v_exp_f32 v51, v51
    v_sub_f32 v52, v52, v38
    v_exp_f32 v52, v52
    v_sub_f32 v53, v53, v38
    v_exp_f32 v53, v53
    v_smfmac_f32_32x32x32_bf16 v[224:239], v[132:135], v[88:95], v12
    v_sub_f32 v54, v54, v38
    v_exp_f32 v54, v54
    v_sub_f32 v55, v55, v38
    v_exp_f32 v55, v55
    v_sub_f32 v56, v56, v38
    v_exp_f32 v56, v56
    v_smfmac_f32_16x16x64_bf16 v[244:247], v[20:23], v[88:95], v12
    ds_read_b64_tr_b16 v[136:137], v3 offset:10240
    v_sub_f32 v57, v57, v38
    v_exp_f32 v57, v57
    v_sub_f32 v58, v58, v38
    v_exp_f32 v58, v58
    v_smfmac_f32_32x32x32_bf16 a[0:15], v[128:131], v[48:55], v12
    s_waitcnt lgkmcnt(4)
    v_sub_f32 v59, v59, v38
    v_exp_f32 v59, v59
    v_sub_f32 v60, v60, v38
    v_exp_f32 v60, v60
    v_sub_f32 v61, v61, v38
    v_exp_f32 v61, v61
    v_smfmac_f32_16x16x64_bf16 a[96:99], v[20:23], v[48:55], v12
    ds_read_b64_tr_b16 v[138:139], v3 offset:10496
    v_sub_f32 v62, v62, v38
    v_exp_f32 v62, v62
    v_mfma_f32_4x4x4_16b_bf16 v[24:27], v[144:145], v[144:145], 0
    v_sub_f32 v63, v63, v38
    v_exp_f32 v63, v63
    v_mfma_f32_32x32x16_bf16 v[80:95], v[112:115], a[136:139], 4.0
    v_sub_f32 v64, v64, v39
    v_exp_f32 v64, v64
    v_sub_f32 v65, v65, v39
    v_exp_f32 v65, v65
    v_sub_f32 v66, v66, v39
    v_exp_f32 v66, v66
    v_mfma_f32_32x32x16_bf16 v[80:95], v[116:119], a[140:143], v[80:95]
    v_sub_f32 v67, v67, v39
    v_exp_f32 v67, v67
    v_sub_f32 v68, v68, v39
    v_exp_f32 v68, v68
    v_sub_f32 v69, v69, v39
    v_exp_f32 v69, v69
    v_smfmac_f32_32x32x32_bf16 a[0:15], v[132:135], v[56:63], v12
    v_sub_f32 v70, v70, v39
    v_exp_f32 v70, v70
    v_sub_f32 v71, v71, v39
    v_exp_f32 v71, v71
    v_sub_f32 v72, v72, v39
    v_exp_f32 v72, v72
    v_smfmac_f32_16x16x64_bf16 a[96:99], v[20:23], v[56:63], v12
    ds_read_b64_tr_b16 v[140:141], v3 offset:11264
    v_sub_f32 v73, v73, v39
    v_exp_f32 v73, v73
    v_mfma_f32_4x4x4_16b_bf16 v[24:27], v[146:147], v[146:147], v[24:27]
    v_sub_f32 v74, v74, v39
    v_exp_f32 v74, v74
    v_smfmac_f32_32x32x32_bf16 a[16:31], v[128:131], v[64:71], v12
    s_waitcnt lgkmcnt(5)
    v_sub_f32 v75, v75, v39
    v_exp_f32 v75, v75
    v_sub_f32 v76, v76, v39
    v_exp_f32 v76, v76
    v_sub_f32 v77, v77, v39
    v_exp_f32 v77, v77
    v_smfmac_f32_16x16x64_bf16 a[100:103], v[20:23], v[64:71], v12
    ds_read_b64_tr_b16 v[142:143], v3 offset:11520
    v_sub_f32 v78, v78, v39
    v_exp_f32 v78, v78
    v_mfma_f32_4x4x4_16b_bf16 v[24:27], v[148:149], v[148:149], v[24:27]
    v_sub_f32 v79, v79, v39
    v_exp_f32 v79, v79
    v_mfma_f32_32x32x16_bf16 v[48:63], v[112:115], a[144:147], 4.0
    v_sub_f32 v80, v80, v40
    v_exp_f32 v80, v80
    v_sub_f32 v81, v81, v40
    v_exp_f32 v81, v81
    v_sub_f32 v82, v82, v40
    v_exp_f32 v82, v82
    v_mfma_f32_32x32x16_bf16 v[48:63], v[116:119], a[148:151], v[48:63]
    v_sub_f32 v83, v83, v40
    v_exp_f32 v83, v83
    v_sub_f32 v84, v84, v40
    v_exp_f32 v84, v84
    v_sub_f32 v85, v85, v40
    v_exp_f32 v85, v85
    v_smfmac_f32_32x32x32_bf16 a[16:31], v[132:135], v[72:79], v12
    v_sub_f32 v86, v86, v40
    v_exp_f32 v86, v86
    v_sub_f32 v87, v87, v40
    v_exp_f32 v87, v87
    v_sub_f32 v88, v88, v40
    v_exp_f32 v88, v88
    v_smfmac_f32_16x16x64_bf16 a[100:103], v[20:23], v[72:79], v12
    ds_read_b64_tr_b16 v[160:161], v8 offset:16384
    v_sub_f32 v89, v89, v40
    v_exp_f32 v89, v89
    v_mfma_f32_4x4x4_16b_bf16 v[24:27], v[150:151], v[150:151], v[24:27]
    v_sub_f32 v90, v90, v40
    v_exp_f32 v90, v90
    v_smfmac_f32_32x32x32_bf16 a[32:47], v[128:131], v[80:87], v12
    s_waitcnt lgkmcnt(6)
    v_sub_f32 v91, v91, v40
    v_exp_f32 v91, v91
    v_sub_f32 v92, v92, v40
    v_exp_f32 v92, v92
    v_sub_f32 v93, v93, v40
    v_exp_f32 v93, v93
    v_smfmac_f32_16x16x64_bf16 a[104:107], v[20:23], v[80:87], v12
    ds_read_b64_tr_b16 v[162:163], v8 offset:16392
    v_sub_f32 v94, v94, v40
    v_exp_f32 v94, v94
    v_mfma_f32_4x4x4_16b_bf16 v[24:27], v[152:153], v[152:153], v[24:27]
    v_sub_f32 v95, v95, v40
    v_exp_f32 v95, v95
    v_mfma_f32_32x32x16_bf16 v[64:79], v[112:115], a[152:155], 4.0
    v_sub_f32 v48, v48, v41
    v_exp_f32 v48, v48
    v_sub_f32 v49, v49, v41
    v_exp_f32 v49, v49
    v_sub_f32 v50, v50, v41
    v_exp_f32 v50, v50
    v_mfma_f32_32x32x16_bf16 v[64:79], v[116:119], a[156:159], v[64:79]
    v_sub_f32 v51, v51, v41
    v_exp_f32 v51, v51
    v_sub_f32 v52, v52, v41
    v_exp_f32 v52, v52
    v_sub_f32 v53, v53, v41
    v_exp_f32 v53, v53
    v_smfmac_f32_32x32x32_bf16 a[32:47], v[132:135], v[88:95], v12
    v_sub_f32 v54, v54, v41
    v_exp_f32 v54, v54
    v_sub_f32 v55, v55, v41
    v_exp_f32 v55, v55
    v_sub_f32 v56, v56, v41
    v_exp_f32 v56, v56
    v_smfmac_f32_16x16x64_bf16 a[104:107], v[20:23], v[88:95], v12
    ds_read_b64_tr_b16 v[164:165], v9 offset:16384
    v_sub_f32 v57, v57, v41
    v_exp_f32 v57, v57
    v_mfma_f32_4x4x4_16b_bf16 v[24:27], v[154:155], v[154:155], v[24:27]
    v_sub_f32 v58, v58, v41
    v_exp_f32 v58, v58
    v_smfmac_f32_32x32x32_bf16 a[48:63], v[128:131], v[48:55], v12
    s_waitcnt lgkmcnt(7)
    v_sub_f32 v59, v59, v41
    v_exp_f32 v59, v59
    v_sub_f32 v60, v60, v41
    v_exp_f32 v60, v60
    v_sub_f32 v61, v61, v41
    v_exp_f32 v61, v61
    v_smfmac_f32_16x16x64_bf16 a[108:111], v[20:23], v[48:55], v12
    ds_read_b64_tr_b16 v[166:167], v9 offset:16392
    v_sub_f32 v62, v62, v41
    v_exp_f32 v62, v62
    v_mfma_f32_4x4x4_16b_bf16 v[24:27], v[156:157], v[156:157], v[24:27]
    v_sub_f32 v63, v63, v41
    v_exp_f32 v63, v63
    v_mfma_f32_32x32x16_bf16 v[80:95], v[112:115], a[160:163], 4.0
    v_sub_f32 v64, v64, v42
    v_exp_f32 v64, v64
    v_sub_f32 v65, v65, v42
    v_exp_f32 v65, v65
    v_sub_f32 v66, v66, v42
    v_exp_f32 v66, v66
    v_mfma_f32_32x32x16_bf16 v[80:95], v[116:119], a[164:167], v[80:95]
    v_sub_f32 v67, v67, v42
    v_exp_f32 v67, v67
    v_sub_f32 v68, v68, v42
    v_exp_f32 v68, v68
    v_sub_f32 v69, v69, v42
    v_exp_f32 v69, v69
    v_smfmac_f32_32x32x32_bf16 a[48:63], v[132:135], v[56:63], v12
    v_sub_f32 v70, v70, v42
    v_exp_f32 v70, v70
    v_sub_f32 v71, v71, v42
    v_exp_f32 v71, v71
    v_sub_f32 v72, v72, v42
    v_exp_f32 v72, v72
    v_smfmac_f32_16x16x64_bf16 a[108:111], v[20:23], v[56:63], v12
    ds_read_b64_tr_b16 v[168:169], v8 offset:18432
    v_sub_f32 v73, v73, v42
    v_exp_f32 v73, v73
    v_mfma_f32_4x4x4_16b_bf16 v[24:27], v[158:159], v[158:159], v[24:27]
    v_sub_f32 v74, v74, v42
    v_exp_f32 v74, v74
    v_smfmac_f32_32x32x32_bf16 a[64:79], v[128:131], v[64:71], v12
    v_sub_f32 v75, v75, v42
    v_exp_f32 v75, v75
    v_sub_f32 v76, v76, v42
    v_exp_f32 v76, v76
    v_sub_f32 v77, v77, v42
    v_exp_f32 v77, v77
    v_smfmac_f32_16x16x64_bf16 a[112:115], v[20:23], v[64:71], v12
    ds_read_b64_tr_b16 v[170:171], v8 offset:18440
    v_sub_f32 v78, v78, v42
    v_exp_f32 v78, v78
    v_sub_f32 v79, v79, v42
    v_exp_f32 v79, v79
    v_cndmask_b32 v28, v24, v25, s[40:41]
    v_mfma_f32_32x32x16_bf16 v[48:63], v[120:123], v[192:195], 4.0
    v_sub_f32 v80, v80, v43
    v_exp_f32 v80, v80
    v_sub_f32 v81, v81, v43
    v_exp_f32 v81, v81
    v_sub_f32 v82, v82, v43
    v_exp_f32 v82, v82
    v_cndmask_b32 v28, v28, v26, s[42:43]
    v_mfma_f32_32x32x16_bf16 v[48:63], v[124:127], v[196:199], v[48:63]
    s_waitcnt lgkmcnt(6)
    v_sub_f32 v83, v83, v43
    v_exp_f32 v83, v83
    v_sub_f32 v84, v84, v43
    v_exp_f32 v84, v84
    v_sub_f32 v85, v85, v43
    v_exp_f32 v85, v85
    v_cndmask_b32 v28, v28, v27, s[44:45]
    v_smfmac_f32_32x32x32_bf16 a[64:79], v[132:135], v[72:79], v12
    v_sub_f32 v86, v86, v43
    v_exp_f32 v86, v86
    v_sub_f32 v87, v87, v43
    v_exp_f32 v87, v87
    v_sub_f32 v88, v88, v43
    v_exp_f32 v88, v88
    v_sqrt_f32 v28, v28
    v_smfmac_f32_16x16x64_bf16 a[112:115], v[20:23], v[72:79], v12
    ds_read_b64_tr_b16 v[172:173], v9 offset:18432
    v_sub_f32 v89, v89, v43
    v_exp_f32 v89, v89
    v_sub_f32 v90, v90, v43
    v_exp_f32 v90, v90
    v_add_f32 v28, 0x358637bd, v28
    v_smfmac_f32_32x32x32_bf16 a[80:95], v[128:131], v[80:87], v12
    v_sub_f32 v91, v91, v43
    v_exp_f32 v91, v91
    v_sub_f32 v92, v92, v43
    v_exp_f32 v92, v92
    v_sub_f32 v93, v93, v43
    v_exp_f32 v93, v93
    v_rcp_f32 v28, v28
    v_smfmac_f32_16x16x64_bf16 a[116:119], v[20:23], v[80:87], v12
    ds_read_b64_tr_b16 v[174:175], v9 offset:18440
    v_sub_f32 v94, v94, v43
    v_exp_f32 v94, v94
    v_sub_f32 v95, v95, v43
    v_exp_f32 v95, v95
    v_cvt_pk_bf16_f32 v29, v28, v28
    v_cvt_pk_bf16_f32 v30, v28, v28
    v_mfma_f32_32x32x16_bf16 v[64:79], v[120:123], v[200:203], 4.0
    s_add_u32 m0, s36, 28672
    v_sub_f32 v48, v48, v36
    v_exp_f32 v48, v48
    v_sub_f32 v49, v49, v36
    v_exp_f32 v49, v49
    v_sub_f32 v50, v50, v36
    v_exp_f32 v50, v50
    v_permlane32_swap_b32 v29, v30
    v_mfma_f32_32x32x16_bf16 v[64:79], v[124:127], v[204:207], v[64:79]
    s_add_u32 s48, s34, 12288
    v_sub_f32 v51, v51, v36
    v_exp_f32 v51, v51
    v_sub_f32 v52, v52, v36
    v_exp_f32 v52, v52
    v_sub_f32 v53, v53, v36
    v_exp_f32 v53, v53
    v_and_b32 v32, v29, v10
    v_and_b32 v33, v29, v11
    v_smfmac_f32_32x32x32_bf16 a[80:95], v[132:135], v[88:95], v12
    buffer_load_dwordx4 v2, s[24:27], s48 offen lds
    buffer_load_dwordx4 v2, s[24:27], s48 offen offset:1024 lds
    v_sub_f32 v54, v54, v36
    v_exp_f32 v54, v54
    v_sub_f32 v55, v55, v36
    v_exp_f32 v55, v55
    v_sub_f32 v56, v56, v36
    v_exp_f32 v56, v56
    v_and_b32 v34, v30, v10
    v_and_b32 v35, v30, v11
    v_smfmac_f32_16x16x64_bf16 a[116:119], v[20:23], v[88:95], v12
    v_sub_f32 v57, v57, v36
    v_exp_f32 v57, v57
    v_sub_f32 v58, v58, v36
    v_exp_f32 v58, v58
    v_smfmac_f32_32x32x32_bf16 v[208:223], v[136:139], v[48:55], v12
    s_waitcnt lgkmcnt(4)
    buffer_load_dwordx4 v2, s[24:27], s48 offen offset:2048 lds
    buffer_load_dwordx4 v2, s[24:27], s48 offen offset:3072 lds
    v_sub_f32 v59, v59, v36
    v_exp_f32 v59, v59
    v_sub_f32 v60, v60, v36
    v_exp_f32 v60, v60
    v_sub_f32 v61, v61, v36
    v_exp_f32 v61, v61
    v_smfmac_f32_16x16x64_bf16 v[240:243], v[20:23], v[48:55], v12
    v_sub_f32 v62, v62, v36
    v_exp_f32 v62, v62
    v_mfma_f32_4x4x4_16b_bf16 v[176:179], v[160:161], v[32:33], 0
    v_sub_f32 v63, v63, v36
    v_exp_f32 v63, v63
    v_mfma_f32_32x32x16_bf16 v[80:95], v[120:123], a[120:123], 4.0
    v_sub_f32 v64, v64, v37
    v_exp_f32 v64, v64
    v_sub_f32 v65, v65, v37
    v_exp_f32 v65, v65
    v_sub_f32 v66, v66, v37
    v_exp_f32 v66, v66
    v_mfma_f32_32x32x16_bf16 v[80:95], v[124:127], a[124:127], v[80:95]
    v_sub_f32 v67, v67, v37
    v_exp_f32 v67, v67
    v_sub_f32 v68, v68, v37
    v_exp_f32 v68, v68
    v_sub_f32 v69, v69, v37
    v_exp_f32 v69, v69
    v_cvt_pk_bf16_f32 v96, v176, v177
    v_cvt_pk_bf16_f32 v97, v178, v179
    v_smfmac_f32_32x32x32_bf16 v[208:223], v[140:143], v[56:63], v12
    s_waitcnt vmcnt(10)
    v_sub_f32 v70, v70, v37
    v_exp_f32 v70, v70
    v_sub_f32 v71, v71, v37
    v_exp_f32 v71, v71
    v_sub_f32 v72, v72, v37
    v_exp_f32 v72, v72
    v_smfmac_f32_16x16x64_bf16 v[240:243], v[20:23], v[56:63], v12
    ds_read_b64_tr_b16 v[128:129], v3 offset:16384
    v_sub_f32 v73, v73, v37
    v_exp_f32 v73, v73
    v_mfma_f32_4x4x4_16b_bf16 v[180:183], v[162:163], v[32:33], 0
    v_sub_f32 v74, v74, v37
    v_exp_f32 v74, v74
    v_smfmac_f32_32x32x32_bf16 v[224:239], v[136:139], v[64:71], v12
    v_sub_f32 v75, v75, v37
    v_exp_f32 v75, v75
    v_sub_f32 v76, v76, v37
    v_exp_f32 v76, v76
    v_sub_f32 v77, v77, v37
    v_exp_f32 v77, v77
    v_smfmac_f32_16x16x64_bf16 v[244:247], v[20:23], v[64:71], v12
    ds_read_b64_tr_b16 v[130:131], v3 offset:16640
    v_sub_f32 v78, v78, v37
    v_exp_f32 v78, v78
    v_mfma_f32_4x4x4_16b_bf16 v[184:187], v[164:165], v[32:33], 0
    v_sub_f32 v79, v79, v37
    v_exp_f32 v79, v79
    v_cvt_pk_bf16_f32 v98, v180, v181
    v_cvt_pk_bf16_f32 v99, v182, v183
    v_mfma_f32_32x32x16_bf16 v[48:63], v[120:123], a[128:131], 4.0
    v_sub_f32 v80, v80, v38
    v_exp_f32 v80, v80
    v_sub_f32 v81, v81, v38
    v_exp_f32 v81, v81
    v_sub_f32 v82, v82, v38
    v_exp_f32 v82, v82
    v_mfma_f32_32x32x16_bf16 v[48:63], v[124:127], a[132:135], v[48:63]
    v_sub_f32 v83, v83, v38
    v_exp_f32 v83, v83
    v_sub_f32 v84, v84, v38
    v_exp_f32 v84, v84
    v_sub_f32 v85, v85, v38
    v_exp_f32 v85, v85
    v_cvt_pk_bf16_f32 v100, v184, v185
    v_cvt_pk_bf16_f32 v101, v186, v187
    v_smfmac_f32_32x32x32_bf16 v[224:239], v[140:143], v[72:79], v12
    v_sub_f32 v86, v86, v38
    v_exp_f32 v86, v86
    v_sub_f32 v87, v87, v38
    v_exp_f32 v87, v87
    v_sub_f32 v88, v88, v38
    v_exp_f32 v88, v88
    v_smfmac_f32_16x16x64_bf16 v[244:247], v[20:23], v[72:79], v12
    ds_read_b64_tr_b16 v[132:133], v3 offset:17408
    v_sub_f32 v89, v89, v38
    v_exp_f32 v89, v89
    v_mfma_f32_4x4x4_16b_bf16 v[188:191], v[166:167], v[32:33], 0
    v_sub_f32 v90, v90, v38
    v_exp_f32 v90, v90
    v_smfmac_f32_32x32x32_bf16 a[0:15], v[136:139], v[80:87], v12
    s_waitcnt lgkmcnt(3)
    v_sub_f32 v91, v91, v38
    v_exp_f32 v91, v91
    v_sub_f32 v92, v92, v38
    v_exp_f32 v92, v92
    v_sub_f32 v93, v93, v38
    v_exp_f32 v93, v93
    v_smfmac_f32_16x16x64_bf16 a[96:99], v[20:23], v[80:87], v12
    ds_read_b64_tr_b16 v[134:135], v3 offset:17664
    v_sub_f32 v94, v94, v38
    v_exp_f32 v94, v94
    v_mfma_f32_4x4x4_16b_bf16 v[176:179], v[168:169], v[34:35], 0
    v_sub_f32 v95, v95, v38
    v_exp_f32 v95, v95
    v_cvt_pk_bf16_f32 v102, v188, v189
    v_cvt_pk_bf16_f32 v103, v190, v191
    v_mfma_f32_32x32x16_bf16 v[64:79], v[120:123], a[136:139], 4.0
    s_add_u32 m0, s36, 0
    v_sub_f32 v48, v48, v39
    v_exp_f32 v48, v48
    v_sub_f32 v49, v49, v39
    v_exp_f32 v49, v49
    v_sub_f32 v50, v50, v39
    v_exp_f32 v50, v50
    v_mfma_f32_32x32x16_bf16 v[64:79], v[124:127], a[140:143], v[64:79]
    s_add_u32 s48, s34, 16384
    v_sub_f32 v51, v51, v39
    v_exp_f32 v51, v51
    v_sub_f32 v52, v52, v39
    v_exp_f32 v52, v52
    v_sub_f32 v53, v53, v39
    v_exp_f32 v53, v53
    v_cvt_pk_bf16_f32 v104, v176, v177
    v_cvt_pk_bf16_f32 v105, v178, v179
    v_smfmac_f32_32x32x32_bf16 a[0:15], v[140:143], v[88:95], v12
    v_sub_f32 v54, v54, v39
    v_exp_f32 v54, v54
    v_sub_f32 v55, v55, v39
    v_exp_f32 v55, v55
    v_sub_f32 v56, v56, v39
    v_exp_f32 v56, v56
    v_smfmac_f32_16x16x64_bf16 a[96:99], v[20:23], v[88:95], v12
    buffer_load_dwordx4 v1, s[20:23], s48 offen lds
    v_sub_f32 v57, v57, v39
    v_exp_f32 v57, v57
    v_mfma_f32_4x4x4_16b_bf16 v[180:183], v[170:171], v[34:35], 0
    v_sub_f32 v58, v58, v39
    v_exp_f32 v58, v58
    v_smfmac_f32_32x32x32_bf16 a[16:31], v[136:139], v[48:55], v12
    v_sub_f32 v59, v59, v39
    v_exp_f32 v59, v59
    v_sub_f32 v60, v60, v39
    v_exp_f32 v60, v60
    v_sub_f32 v61, v61, v39
    v_exp_f32 v61, v61
    v_smfmac_f32_16x16x64_bf16 a[100:103], v[20:23], v[48:55], v12
    buffer_load_dwordx4 v1, s[20:23], s48 offen offset:1024 lds
    v_sub_f32 v62, v62, v39
    v_exp_f32 v62, v62
    v_mfma_f32_4x4x4_16b_bf16 v[184:187], v[172:173], v[34:35], 0
    v_sub_f32 v63, v63, v39
    v_exp_f32 v63, v63
    v_cvt_pk_bf16_f32 v106, v180, v181
    v_cvt_pk_bf16_f32 v107, v182, v183
    v_mfma_f32_32x32x16_bf16 v[80:95], v[120:123], a[144:147], 4.0
    v_sub_f32 v64, v64, v40
    v_exp_f32 v64, v64
    v_sub_f32 v65, v65, v40
    v_exp_f32 v65, v65
    v_sub_f32 v66, v66, v40
    v_exp_f32 v66, v66
    v_mfma_f32_32x32x16_bf16 v[80:95], v[124:127], a[148:151], v[80:95]
    v_sub_f32 v67, v67, v40
    v_exp_f32 v67, v67
    v_sub_f32 v68, v68, v40
    v_exp_f32 v68, v68
    v_sub_f32 v69, v69, v40
    v_exp_f32 v69, v69
    v_cvt_pk_bf16_f32 v108, v184, v185
    v_cvt_pk_bf16_f32 v109, v186, v187
    v_smfmac_f32_32x32x32_bf16 a[16:31], v[140:143], v[56:63], v12
    v_sub_f32 v70, v70, v40
    v_exp_f32 v70, v70
    v_sub_f32 v71, v71, v40
    v_exp_f32 v71, v71
    v_sub_f32 v72, v72, v40
    v_exp_f32 v72, v72
    v_smfmac_f32_16x16x64_bf16 a[100:103], v[20:23], v[56:63], v12
    buffer_load_dwordx4 v1, s[20:23], s48 offen offset:2048 lds
    v_sub_f32 v73, v73, v40
    v_exp_f32 v73, v73
    v_mfma_f32_4x4x4_16b_bf16 v[188:191], v[174:175], v[34:35], 0
    v_sub_f32 v74, v74, v40
    v_exp_f32 v74, v74
    v_smfmac_f32_32x32x32_bf16 a[32:47], v[136:139], v[64:71], v12
    v_sub_f32 v75, v75, v40
    v_exp_f32 v75, v75
    v_sub_f32 v76, v76, v40
    v_exp_f32 v76, v76
    v_sub_f32 v77, v77, v40
    v_exp_f32 v77, v77
    v_smfmac_f32_16x16x64_bf16 a[104:107], v[20:23], v[64:71], v12
    buffer_load_dwordx4 v1, s[20:23], s48 offen offset:3072 lds
    v_sub_f32 v78, v78, v40
    v_exp_f32 v78, v78
    v_sub_f32 v79, v79, v40
    v_exp_f32 v79, v79
    v_cvt_pk_bf16_f32 v110, v188, v189
    v_cvt_pk_bf16_f32 v111, v190, v191
    v_mfma_f32_32x32x16_bf16 v[48:63], v[120:123], a[152:155], 4.0
    s_add_u32 m0, s36, 4096
    v_sub_f32 v80, v80, v41
    v_exp_f32 v80, v80
    v_sub_f32 v81, v81, v41
    v_exp_f32 v81, v81
    v_sub_f32 v82, v82, v41
    v_exp_f32 v82, v82
    v_mfma_f32_32x32x16_bf16 v[48:63], v[124:127], a[156:159], v[48:63]
    s_add_u32 s48, s34, 16384
    v_sub_f32 v83, v83, v41
    v_exp_f32 v83, v83
    v_sub_f32 v84, v84, v41
    v_exp_f32 v84, v84
    v_sub_f32 v85, v85, v41
    v_exp_f32 v85, v85
    v_smfmac_f32_32x32x32_bf16 a[32:47], v[140:143], v[72:79], v12
    v_sub_f32 v86, v86, v41
    v_exp_f32 v86, v86
    v_sub_f32 v87, v87, v41
    v_exp_f32 v87, v87
    v_sub_f32 v88, v88, v41
    v_exp_f32 v88, v88
    v_smfmac_f32_16x16x64_bf16 a[104:107], v[20:23], v[72:79], v12
    buffer_load_dwordx4 v2, s[24:27], s48 offen lds
    v_sub_f32 v89, v89, v41
    v_exp_f32 v89, v89
    v_sub_f32 v90, v90, v41
    v_exp_f32 v90, v90
    v_smfmac_f32_32x32x32_bf16 a[48:63], v[136:139], v[80:87], v12
    v_sub_f32 v91, v91, v41
    v_exp_f32 v91, v91
    v_sub_f32 v92, v92, v41
    v_exp_f32 v92, v92
    v_sub_f32 v93, v93, v41
    v_exp_f32 v93, v93
    v_smfmac_f32_16x16x64_bf16 a[108:111], v[20:23], v[80:87], v12
    buffer_load_dwordx4 v2, s[24:27], s48 offen offset:1024 lds
    v_sub_f32 v94, v94, v41
    v_exp_f32 v94, v94
    v_sub_f32 v95, v95, v41
    v_exp_f32 v95, v95
    v_mfma_f32_32x32x16_bf16 v[64:79], v[120:123], a[160:163], 4.0
    v_sub_f32 v48, v48, v42
    v_exp_f32 v48, v48
    v_sub_f32 v49, v49, v42
    v_exp_f32 v49, v49
    v_sub_f32 v50, v50, v42
    v_exp_f32 v50, v50
    v_mfma_f32_32x32x16_bf16 v[64:79], v[124:127], a[164:167], v[64:79]
    v_sub_f32 v51, v51, v42
    v_exp_f32 v51, v51
    v_sub_f32 v52, v52, v42
    v_exp_f32 v52, v52
    v_sub_f32 v53, v53, v42
    v_exp_f32 v53, v53
    v_smfmac_f32_32x32x32_bf16 a[48:63], v[140:143], v[88:95], v12
    v_sub_f32 v54, v54, v42
    v_exp_f32 v54, v54
    v_sub_f32 v55, v55, v42
    v_exp_f32 v55, v55
    v_sub_f32 v56, v56, v42
    v_exp_f32 v56, v56
    v_smfmac_f32_16x16x64_bf16 a[108:111], v[20:23], v[88:95], v12
    buffer_load_dwordx4 v2, s[24:27], s48 offen offset:2048 lds
    v_sub_f32 v57, v57, v42
    v_exp_f32 v57, v57
    v_sub_f32 v58, v58, v42
    v_exp_f32 v58, v58
    v_smfmac_f32_32x32x32_bf16 a[64:79], v[136:139], v[48:55], v12
    v_sub_f32 v59, v59, v42
    v_exp_f32 v59, v59
    v_sub_f32 v60, v60, v42
    v_exp_f32 v60, v60
    v_sub_f32 v61, v61, v42
    v_exp_f32 v61, v61
    v_smfmac_f32_16x16x64_bf16 a[112:115], v[20:23], v[48:55], v12
    buffer_load_dwordx4 v2, s[24:27], s48 offen offset:3072 lds
    v_sub_f32 v62, v62, v42
    v_exp_f32 v62, v62
    v_sub_f32 v63, v63, v42
    v_exp_f32 v63, v63
    v_mfma_f32_32x32x16_bf16 v[80:95], v[96:99], v[192:195], 4.0
    v_sub_f32 v64, v64, v43
    v_exp_f32 v64, v64
    v_sub_f32 v65, v65, v43
    v_exp_f32 v65, v65
    v_sub_f32 v66, v66, v43
    v_exp_f32 v66, v66
    v_mfma_f32_32x32x16_bf16 v[80:95], v[100:103], v[196:199], v[80:95]
    v_sub_f32 v67, v67, v43
    v_exp_f32 v67, v67
    v_sub_f32 v68, v68, v43
    v_exp_f32 v68, v68
    v_sub_f32 v69, v69, v43
    v_exp_f32 v69, v69
    v_smfmac_f32_32x32x32_bf16 a[64:79], v[140:143], v[56:63], v12
    v_sub_f32 v70, v70, v43
    v_exp_f32 v70, v70
    v_sub_f32 v71, v71, v43
    v_exp_f32 v71, v71
    v_sub_f32 v72, v72, v43
    v_exp_f32 v72, v72
    v_smfmac_f32_16x16x64_bf16 a[112:115], v[20:23], v[56:63], v12
    v_sub_f32 v73, v73, v43
    v_exp_f32 v73, v73
    v_sub_f32 v74, v74, v43
    v_exp_f32 v74, v74
    v_smfmac_f32_32x32x32_bf16 a[80:95], v[136:139], v[64:71], v12
    s_waitcnt lgkmcnt(0)
    v_sub_f32 v75, v75, v43
    v_exp_f32 v75, v75
    v_sub_f32 v76, v76, v43
    v_exp_f32 v76, v76
    v_sub_f32 v77, v77, v43
    v_exp_f32 v77, v77
    v_smfmac_f32_16x16x64_bf16 a[116:119], v[20:23], v[64:71], v12
    v_sub_f32 v78, v78, v43
    v_exp_f32 v78, v78
    v_sub_f32 v79, v79, v43
    v_exp_f32 v79, v79
    v_mfma_f32_32x32x16_bf16 v[48:63], v[96:99], v[200:203], 4.0
    v_sub_f32 v80, v80, v36
    v_exp_f32 v80, v80
    v_sub_f32 v81, v81, v36
    v_exp_f32 v81, v81
    v_sub_f32 v82, v82, v36
    v_exp_f32 v82, v82
    v_mfma_f32_32x32x16_bf16 v[48:63], v[100:103], v[204:207], v[48:63]
    v_sub_f32 v83, v83, v36
    v_exp_f32 v83, v83
    v_sub_f32 v84, v84, v36
    v_exp_f32 v84, v84
    v_sub_f32 v85, v85, v36
    v_exp_f32 v85, v85
    v_smfmac_f32_32x32x32_bf16 a[80:95], v[140:143], v[72:79], v12
    s_waitcnt vmcnt(12)
    v_sub_f32 v86, v86, v36
    v_exp_f32 v86, v86
    v_sub_f32 v87, v87, v36
    v_exp_f32 v87, v87
    v_sub_f32 v88, v88, v36
    v_exp_f32 v88, v88
    v_smfmac_f32_16x16x64_bf16 a[116:119], v[20:23], v[72:79], v12
    ds_read_b128 v[144:147], v4 offset:24576
    v_sub_f32 v89, v89, v36
    v_exp_f32 v89, v89
    v_sub_f32 v90, v90, v36
    v_exp_f32 v90, v90
    v_smfmac_f32_32x32x32_bf16 v[208:223], v[128:131], v[80:87], v12
    v_sub_f32 v91, v91, v36
    v_exp_f32 v91, v91
    v_sub_f32 v92, v92, v36
    v_exp_f32 v92, v92
    v_sub_f32 v93, v93, v36
    v_exp_f32 v93, v93
    v_smfmac_f32_16x16x64_bf16 v[240:243], v[20:23], v[80:87], v12
    ds_read_b128 v[148:151], v5 offset:24576
    v_sub_f32 v94, v94, v36
    v_exp_f32 v94, v94
    v_sub_f32 v95, v95, v36
    v_exp_f32 v95, v95
    v_mfma_f32_32x32x16_bf16 v[64:79], v[96:99], a[120:123], 4.0
    v_sub_f32 v48, v48, v37
    v_exp_f32 v48, v48
    v_sub_f32 v49, v49, v37
    v_exp_f32 v49, v49
    v_sub_f32 v50, v50, v37
    v_exp_f32 v50, v50
    v_mfma_f32_32x32x16_bf16 v[64:79], v[100:103], a[124:127], v[64:79]
    v_sub_f32 v51, v51, v37
    v_exp_f32 v51, v51
    v_sub_f32 v52, v52, v37
    v_exp_f32 v52, v52
    v_sub_f32 v53, v53, v37
    v_exp_f32 v53, v53
    v_smfmac_f32_32x32x32_bf16 v[208:223], v[132:135], v[88:95], v12
    v_sub_f32 v54, v54, v37
    v_exp_f32 v54, v54
    v_sub_f32 v55, v55, v37
    v_exp_f32 v55, v55
    v_sub_f32 v56, v56, v37
    v_exp_f32 v56, v56
    v_smfmac_f32_16x16x64_bf16 v[240:243], v[20:23], v[88:95], v12
    ds_read_b128 v[152:155], v6 offset:24576
    v_sub_f32 v57, v57, v37
    v_exp_f32 v57, v57
    v_sub_f32 v58, v58, v37
    v_exp_f32 v58, v58
    v_smfmac_f32_32x32x32_bf16 v[224:239], v[128:131], v[48:55], v12
    v_sub_f32 v59, v59, v37
    v_exp_f32 v59, v59
    v_sub_f32 v60, v60, v37
    v_exp_f32 v60, v60
    v_sub_f32 v61, v61, v37
    v_exp_f32 v61, v61
    v_smfmac_f32_16x16x64_bf16 v[244:247], v[20:23], v[48:55], v12
    ds_read_b128 v[156:159], v7 offset:24576
    v_sub_f32 v62, v62, v37
    v_exp_f32 v62, v62
    v_sub_f32 v63, v63, v37
    v_exp_f32 v63, v63
    v_mfma_f32_32x32x16_bf16 v[80:95], v[96:99], a[128:131], 4.0
    v_sub_f32 v64, v64, v38
    v_exp_f32 v64, v64
    v_sub_f32 v65, v65, v38
    v_exp_f32 v65, v65
    v_sub_f32 v66, v66, v38
    v_exp_f32 v66, v66
    v_mfma_f32_32x32x16_bf16 v[80:95], v[100:103], a[132:135], v[80:95]
    v_sub_f32 v67, v67, v38
    v_exp_f32 v67, v67
    v_sub_f32 v68, v68, v38
    v_exp_f32 v68, v68
    v_sub_f32 v69, v69, v38
    v_exp_f32 v69, v69
    v_smfmac_f32_32x32x32_bf16 v[224:239], v[132:135], v[56:63], v12
    v_sub_f32 v70, v70, v38
    v_exp_f32 v70, v70
    v_sub_f32 v71, v71, v38
    v_exp_f32 v71, v71
    v_sub_f32 v72, v72, v38
    v_exp_f32 v72, v72
    v_smfmac_f32_16x16x64_bf16 v[244:247], v[20:23], v[56:63], v12
    ds_read_b64_tr_b16 v[136:137], v3 offset:18432
    v_sub_f32 v73, v73, v38
    v_exp_f32 v73, v73
    v_sub_f32 v74, v74, v38
    v_exp_f32 v74, v74
    v_smfmac_f32_32x32x32_bf16 a[0:15], v[128:131], v[64:71], v12
    s_waitcnt lgkmcnt(4)
    v_sub_f32 v75, v75, v38
    v_exp_f32 v75, v75
    v_sub_f32 v76, v76, v38
    v_exp_f32 v76, v76
    v_sub_f32 v77, v77, v38
    v_exp_f32 v77, v77
    v_smfmac_f32_16x16x64_bf16 a[96:99], v[20:23], v[64:71], v12
    ds_read_b64_tr_b16 v[138:139], v3 offset:18688
    v_sub_f32 v78, v78, v38
    v_exp_f32 v78, v78
    v_mfma_f32_4x4x4_16b_bf16 v[24:27], v[144:145], v[144:145], 0
    v_sub_f32 v79, v79, v38
    v_exp_f32 v79, v79
    v_mfma_f32_32x32x16_bf16 v[48:63], v[96:99], a[136:139], 4.0
    v_sub_f32 v80, v80, v39
    v_exp_f32 v80, v80
    v_sub_f32 v81, v81, v39
    v_exp_f32 v81, v81
    v_sub_f32 v82, v82, v39
    v_exp_f32 v82, v82
    v_mfma_f32_32x32x16_bf16 v[48:63], v[100:103], a[140:143], v[48:63]
    v_sub_f32 v83, v83, v39
    v_exp_f32 v83, v83
    v_sub_f32 v84, v84, v39
    v_exp_f32 v84, v84
    v_sub_f32 v85, v85, v39
    v_exp_f32 v85, v85
    v_smfmac_f32_32x32x32_bf16 a[0:15], v[132:135], v[72:79], v12
    v_sub_f32 v86, v86, v39
    v_exp_f32 v86, v86
    v_sub_f32 v87, v87, v39
    v_exp_f32 v87, v87
    v_sub_f32 v88, v88, v39
    v_exp_f32 v88, v88
    v_smfmac_f32_16x16x64_bf16 a[96:99], v[20:23], v[72:79], v12
    ds_read_b64_tr_b16 v[140:141], v3 offset:19456
    v_sub_f32 v89, v89, v39
    v_exp_f32 v89, v89
    v_mfma_f32_4x4x4_16b_bf16 v[24:27], v[146:147], v[146:147], v[24:27]
    v_sub_f32 v90, v90, v39
    v_exp_f32 v90, v90
    v_smfmac_f32_32x32x32_bf16 a[16:31], v[128:131], v[80:87], v12
    s_waitcnt lgkmcnt(5)
    v_sub_f32 v91, v91, v39
    v_exp_f32 v91, v91
    v_sub_f32 v92, v92, v39
    v_exp_f32 v92, v92
    v_sub_f32 v93, v93, v39
    v_exp_f32 v93, v93
    v_smfmac_f32_16x16x64_bf16 a[100:103], v[20:23], v[80:87], v12
    ds_read_b64_tr_b16 v[142:143], v3 offset:19712
    v_sub_f32 v94, v94, v39
    v_exp_f32 v94, v94
    v_mfma_f32_4x4x4_16b_bf16 v[24:27], v[148:149], v[148:149], v[24:27]
    v_sub_f32 v95, v95, v39
    v_exp_f32 v95, v95
    v_mfma_f32_32x32x16_bf16 v[64:79], v[96:99], a[144:147], 4.0
    v_sub_f32 v48, v48, v40
    v_exp_f32 v48, v48
    v_sub_f32 v49, v49, v40
    v_exp_f32 v49, v49
    v_sub_f32 v50, v50, v40
    v_exp_f32 v50, v50
    v_mfma_f32_32x32x16_bf16 v[64:79], v[100:103], a[148:151], v[64:79]
    v_sub_f32 v51, v51, v40
    v_exp_f32 v51, v51
    v_sub_f32 v52, v52, v40
    v_exp_f32 v52, v52
    v_sub_f32 v53, v53, v40
    v_exp_f32 v53, v53
    v_smfmac_f32_32x32x32_bf16 a[16:31], v[132:135], v[88:95], v12
    v_sub_f32 v54, v54, v40
    v_exp_f32 v54, v54
    v_sub_f32 v55, v55, v40
    v_exp_f32 v55, v55
    v_sub_f32 v56, v56, v40
    v_exp_f32 v56, v56
    v_smfmac_f32_16x16x64_bf16 a[100:103], v[20:23], v[88:95], v12
    ds_read_b64_tr_b16 v[160:161], v8 offset:24576
    v_sub_f32 v57, v57, v40
    v_exp_f32 v57, v57
    v_mfma_f32_4x4x4_16b_bf16 v[24:27], v[150:151], v[150:151], v[24:27]
    v_sub_f32 v58, v58, v40
    v_exp_f32 v58, v58
    v_smfmac_f32_32x32x32_bf16 a[32:47], v[128:131], v[48:55], v12
    s_waitcnt lgkmcnt(6)
    v_sub_f32 v59, v59, v40
    v_exp_f32 v59, v59
    v_sub_f32 v60, v60, v40
    v_exp_f32 v60, v60
    v_sub_f32 v61, v61, v40
    v_exp_f32 v61, v61
    v_smfmac_f32_16x16x64_bf16 a[104:107], v[20:23], v[48:55], v12
    ds_read_b64_tr_b16 v[162:163], v8 offset:24584
    v_sub_f32 v62, v62, v40
    v_exp_f32 v62, v62
    v_mfma_f32_4x4x4_16b_bf16 v[24:27], v[152:153], v[152:153], v[24:27]
    v_sub_f32 v63, v63, v40
    v_exp_f32 v63, v63
    v_mfma_f32_32x32x16_bf16 v[80:95], v[96:99], a[152:155], 4.0
    v_sub_f32 v64, v64, v41
    v_exp_f32 v64, v64
    v_sub_f32 v65, v65, v41
    v_exp_f32 v65, v65
    v_sub_f32 v66, v66, v41
    v_exp_f32 v66, v66
    v_mfma_f32_32x32x16_bf16 v[80:95], v[100:103], a[156:159], v[80:95]
    v_sub_f32 v67, v67, v41
    v_exp_f32 v67, v67
    v_sub_f32 v68, v68, v41
    v_exp_f32 v68, v68
    v_sub_f32 v69, v69, v41
    v_exp_f32 v69, v69
    v_smfmac_f32_32x32x32_bf16 a[32:47], v[132:135], v[56:63], v12
    v_sub_f32 v70, v70, v41
    v_exp_f32 v70, v70
    v_sub_f32 v71, v71, v41
    v_exp_f32 v71, v71
    v_sub_f32 v72, v72, v41
    v_exp_f32 v72, v72
    v_smfmac_f32_16x16x64_bf16 a[104:107], v[20:23], v[56:63], v12
    ds_read_b64_tr_b16 v[164:165], v9 offset:24576
    v_sub_f32 v73, v73, v41
    v_exp_f32 v73, v73
    v_mfma_f32_4x4x4_16b_bf16 v[24:27], v[154:155], v[154:155], v[24:27]
    v_sub_f32 v74, v74, v41
    v_exp_f32 v74, v74
    v_smfmac_f32_32x32x32_bf16 a[48:63], v[128:131], v[64:71], v12
    s_waitcnt lgkmcnt(7)
    v_sub_f32 v75, v75, v41
    v_exp_f32 v75, v75
    v_sub_f32 v76, v76, v41
    v_exp_f32 v76, v76
    v_sub_f32 v77, v77, v41
    v_exp_f32 v77, v77
    v_smfmac_f32_16x16x64_bf16 a[108:111], v[20:23], v[64:71], v12
    ds_read_b64_tr_b16 v[166:167], v9 offset:24584
    v_sub_f32 v78, v78, v41
    v_exp_f32 v78, v78
    v_mfma_f32_4x4x4_16b_bf16 v[24:27], v[156:157], v[156:157], v[24:27]
    v_sub_f32 v79, v79, v41
    v_exp_f32 v79, v79
    v_mfma_f32_32x32x16_bf16 v[48:63], v[96:99], a[160:163], 4.0
    v_sub_f32 v80, v80, v42
    v_exp_f32 v80, v80
    v_sub_f32 v81, v81, v42
    v_exp_f32 v81, v81
    v_sub_f32 v82, v82, v42
    v_exp_f32 v82, v82
    v_mfma_f32_32x32x16_bf16 v[48:63], v[100:103], a[164:167], v[48:63]
    v_sub_f32 v83, v83, v42
    v_exp_f32 v83, v83
    v_sub_f32 v84, v84, v42
    v_exp_f32 v84, v84
    v_sub_f32 v85, v85, v42
    v_exp_f32 v85, v85
    v_smfmac_f32_32x32x32_bf16 a[48:63], v[132:135], v[72:79], v12
    v_sub_f32 v86, v86, v42
    v_exp_f32 v86, v86
    v_sub_f32 v87, v87, v42
    v_exp_f32 v87, v87
    v_sub_f32 v88, v88, v42
    v_exp_f32 v88, v88
    v_smfmac_f32_16x16x64_bf16 a[108:111], v[20:23], v[72:79], v12
    ds_read_b64_tr_b16 v[168:169], v8 offset:26624
    v_sub_f32 v89, v89, v42
    v_exp_f32 v89, v89
    v_mfma_f32_4x4x4_16b_bf16 v[24:27], v[158:159], v[158:159], v[24:27]
    v_sub_f32 v90, v90, v42
    v_exp_f32 v90, v90
    v_smfmac_f32_32x32x32_bf16 a[64:79], v[128:131], v[80:87], v12
    v_sub_f32 v91, v91, v42
    v_exp_f32 v91, v91
    v_sub_f32 v92, v92, v42
    v_exp_f32 v92, v92
    v_sub_f32 v93, v93, v42
    v_exp_f32 v93, v93
    v_smfmac_f32_16x16x64_bf16 a[112:115], v[20:23], v[80:87], v12
    ds_read_b64_tr_b16 v[170:171], v8 offset:26632
    v_sub_f32 v94, v94, v42
    v_exp_f32 v94, v94
    v_sub_f32 v95, v95, v42
    v_exp_f32 v95, v95
    v_cndmask_b32 v28, v24, v25, s[40:41]
    v_mfma_f32_32x32x16_bf16 v[64:79], v[104:107], v[192:195], 4.0
    v_sub_f32 v48, v48, v43
    v_exp_f32 v48, v48
    v_sub_f32 v49, v49, v43
    v_exp_f32 v49, v49
    v_sub_f32 v50, v50, v43
    v_exp_f32 v50, v50
    v_cndmask_b32 v28, v28, v26, s[42:43]
    v_mfma_f32_32x32x16_bf16 v[64:79], v[108:111], v[196:199], v[64:79]
    s_waitcnt lgkmcnt(6)
    v_sub_f32 v51, v51, v43
    v_exp_f32 v51, v51
    v_sub_f32 v52, v52, v43
    v_exp_f32 v52, v52
    v_sub_f32 v53, v53, v43
    v_exp_f32 v53, v53
    v_cndmask_b32 v28, v28, v27, s[44:45]
    v_smfmac_f32_32x32x32_bf16 a[64:79], v[132:135], v[88:95], v12
    v_sub_f32 v54, v54, v43
    v_exp_f32 v54, v54
    v_sub_f32 v55, v55, v43
    v_exp_f32 v55, v55
    v_sub_f32 v56, v56, v43
    v_exp_f32 v56, v56
    v_sqrt_f32 v28, v28
    v_smfmac_f32_16x16x64_bf16 a[112:115], v[20:23], v[88:95], v12
    ds_read_b64_tr_b16 v[172:173], v9 offset:26624
    v_sub_f32 v57, v57, v43
    v_exp_f32 v57, v57
    v_sub_f32 v58, v58, v43
    v_exp_f32 v58, v58
    v_add_f32 v28, 0x358637bd, v28
    v_smfmac_f32_32x32x32_bf16 a[80:95], v[128:131], v[48:55], v12
    v_sub_f32 v59, v59, v43
    v_exp_f32 v59, v59
    v_sub_f32 v60, v60, v43
    v_exp_f32 v60, v60
    v_sub_f32 v61, v61, v43
    v_exp_f32 v61, v61
    v_rcp_f32 v28, v28
    v_smfmac_f32_16x16x64_bf16 a[116:119], v[20:23], v[48:55], v12
    ds_read_b64_tr_b16 v[174:175], v9 offset:26632
    v_sub_f32 v62, v62, v43
    v_exp_f32 v62, v62
    v_sub_f32 v63, v63, v43
    v_exp_f32 v63, v63
    v_cvt_pk_bf16_f32 v29, v28, v28
    v_cvt_pk_bf16_f32 v30, v28, v28
    v_mfma_f32_32x32x16_bf16 v[80:95], v[104:107], v[200:203], 4.0
    v_sub_f32 v64, v64, v36
    v_exp_f32 v64, v64
    v_sub_f32 v65, v65, v36
    v_exp_f32 v65, v65
    v_sub_f32 v66, v66, v36
    v_exp_f32 v66, v66
    v_permlane32_swap_b32 v29, v30
    v_mfma_f32_32x32x16_bf16 v[80:95], v[108:111], v[204:207], v[80:95]
    v_sub_f32 v67, v67, v36
    v_exp_f32 v67, v67
    v_sub_f32 v68, v68, v36
    v_exp_f32 v68, v68
    v_sub_f32 v69, v69, v36
    v_exp_f32 v69, v69
    v_and_b32 v32, v29, v10
    v_and_b32 v33, v29, v11
    v_smfmac_f32_32x32x32_bf16 a[80:95], v[132:135], v[56:63], v12
    v_sub_f32 v70, v70, v36
    v_exp_f32 v70, v70
    v_sub_f32 v71, v71, v36
    v_exp_f32 v71, v71
    v_sub_f32 v72, v72, v36
    v_exp_f32 v72, v72
    v_and_b32 v34, v30, v10
    v_and_b32 v35, v30, v11
    v_smfmac_f32_16x16x64_bf16 a[116:119], v[20:23], v[56:63], v12
    v_sub_f32 v73, v73, v36
    v_exp_f32 v73, v73
    v_sub_f32 v74, v74, v36
    v_exp_f32 v74, v74
    v_smfmac_f32_32x32x32_bf16 v[208:223], v[136:139], v[64:71], v12
    s_waitcnt lgkmcnt(4)
    v_sub_f32 v75, v75, v36
    v_exp_f32 v75, v75
    v_sub_f32 v76, v76, v36
    v_exp_f32 v76, v76
    v_sub_f32 v77, v77, v36
    v_exp_f32 v77, v77
    v_smfmac_f32_16x16x64_bf16 v[240:243], v[20:23], v[64:71], v12
    v_sub_f32 v78, v78, v36
    v_exp_f32 v78, v78
    v_mfma_f32_4x4x4_16b_bf16 v[176:179], v[160:161], v[32:33], 0
    v_sub_f32 v79, v79, v36
    v_exp_f32 v79, v79
    v_mfma_f32_32x32x16_bf16 v[48:63], v[104:107], a[120:123], 4.0
    v_sub_f32 v80, v80, v37
    v_exp_f32 v80, v80
    v_sub_f32 v81, v81, v37
    v_exp_f32 v81, v81
    v_sub_f32 v82, v82, v37
    v_exp_f32 v82, v82
    v_mfma_f32_32x32x16_bf16 v[48:63], v[108:111], a[124:127], v[48:63]
    v_sub_f32 v83, v83, v37
    v_exp_f32 v83, v83
    v_sub_f32 v84, v84, v37
    v_exp_f32 v84, v84
    v_sub_f32 v85, v85, v37
    v_exp_f32 v85, v85
    v_cvt_pk_bf16_f32 v112, v176, v177
    v_cvt_pk_bf16_f32 v113, v178, v179
    v_smfmac_f32_32x32x32_bf16 v[208:223], v[140:143], v[72:79], v12
    s_waitcnt vmcnt(10)
    v_sub_f32 v86, v86, v37
    v_exp_f32 v86, v86
    v_sub_f32 v87, v87, v37
    v_exp_f32 v87, v87
    v_sub_f32 v88, v88, v37
    v_exp_f32 v88, v88
    v_smfmac_f32_16x16x64_bf16 v[240:243], v[20:23], v[72:79], v12
    ds_read_b64_tr_b16 v[128:129], v3 offset:24576
    v_sub_f32 v89, v89, v37
    v_exp_f32 v89, v89
    v_mfma_f32_4x4x4_16b_bf16 v[180:183], v[162:163], v[32:33], 0
    v_sub_f32 v90, v90, v37
    v_exp_f32 v90, v90
    v_smfmac_f32_32x32x32_bf16 v[224:239], v[136:139], v[80:87], v12
    v_sub_f32 v91, v91, v37
    v_exp_f32 v91, v91
    v_sub_f32 v92, v92, v37
    v_exp_f32 v92, v92
    v_sub_f32 v93, v93, v37
    v_exp_f32 v93, v93
    v_smfmac_f32_16x16x64_bf16 v[244:247], v[20:23], v[80:87], v12
    ds_read_b64_tr_b16 v[130:131], v3 offset:24832
    v_sub_f32 v94, v94, v37
    v_exp_f32 v94, v94
    v_mfma_f32_4x4x4_16b_bf16 v[184:187], v[164:165], v[32:33], 0
    v_sub_f32 v95, v95, v37
    v_exp_f32 v95, v95
    v_cvt_pk_bf16_f32 v114, v180, v181
    v_cvt_pk_bf16_f32 v115, v182, v183
    v_mfma_f32_32x32x16_bf16 v[64:79], v[104:107], a[128:131], 4.0
    v_sub_f32 v48, v48, v38
    v_exp_f32 v48, v48
    v_sub_f32 v49, v49, v38
    v_exp_f32 v49, v49
    v_sub_f32 v50, v50, v38
    v_exp_f32 v50, v50
    v_mfma_f32_32x32x16_bf16 v[64:79], v[108:111], a[132:135], v[64:79]
    v_sub_f32 v51, v51, v38
    v_exp_f32 v51, v51
    v_sub_f32 v52, v52, v38
    v_exp_f32 v52, v52
    v_sub_f32 v53, v53, v38
    v_exp_f32 v53, v53
    v_cvt_pk_bf16_f32 v116, v184, v185
    v_cvt_pk_bf16_f32 v117, v186, v187
    v_smfmac_f32_32x32x32_bf16 v[224:239], v[140:143], v[88:95], v12
    v_sub_f32 v54, v54, v38
    v_exp_f32 v54, v54
    v_sub_f32 v55, v55, v38
    v_exp_f32 v55, v55
    v_sub_f32 v56, v56, v38
    v_exp_f32 v56, v56
    v_smfmac_f32_16x16x64_bf16 v[244:247], v[20:23], v[88:95], v12
    ds_read_b64_tr_b16 v[132:133], v3 offset:25600
    v_sub_f32 v57, v57, v38
    v_exp_f32 v57, v57
    v_mfma_f32_4x4x4_16b_bf16 v[188:191], v[166:167], v[32:33], 0
    v_sub_f32 v58, v58, v38
    v_exp_f32 v58, v58
    v_smfmac_f32_32x32x32_bf16 a[0:15], v[136:139], v[48:55], v12
    s_waitcnt lgkmcnt(3)
    v_sub_f32 v59, v59, v38
    v_exp_f32 v59, v59
    v_sub_f32 v60, v60, v38
    v_exp_f32 v60, v60
    v_sub_f32 v61, v61, v38
    v_exp_f32 v61, v61
    v_smfmac_f32_16x16x64_bf16 a[96:99], v[20:23], v[48:55], v12
    ds_read_b64_tr_b16 v[134:135], v3 offset:25856
    v_sub_f32 v62, v62, v38
    v_exp_f32 v62, v62
    v_mfma_f32_4x4x4_16b_bf16 v[176:179], v[168:169], v[34:35], 0
    v_sub_f32 v63, v63, v38
    v_exp_f32 v63, v63
    v_cvt_pk_bf16_f32 v118, v188, v189
    v_cvt_pk_bf16_f32 v119, v190, v191
    v_mfma_f32_32x32x16_bf16 v[80:95], v[104:107], a[136:139], 4.0
    s_add_u32 m0, s36, 8192
    v_sub_f32 v64, v64, v39
    v_exp_f32 v64, v64
    v_sub_f32 v65, v65, v39
    v_exp_f32 v65, v65
    v_sub_f32 v66, v66, v39
    v_exp_f32 v66, v66
    v_mfma_f32_32x32x16_bf16 v[80:95], v[108:111], a[140:143], v[80:95]
    s_add_u32 s48, s34, 20480
    v_sub_f32 v67, v67, v39
    v_exp_f32 v67, v67
    v_sub_f32 v68, v68, v39
    v_exp_f32 v68, v68
    v_sub_f32 v69, v69, v39
    v_exp_f32 v69, v69
    v_cvt_pk_bf16_f32 v120, v176, v177
    v_cvt_pk_bf16_f32 v121, v178, v179
    v_smfmac_f32_32x32x32_bf16 a[0:15], v[140:143], v[56:63], v12
    v_sub_f32 v70, v70, v39
    v_exp_f32 v70, v70
    v_sub_f32 v71, v71, v39
    v_exp_f32 v71, v71
    v_sub_f32 v72, v72, v39
    v_exp_f32 v72, v72
    v_smfmac_f32_16x16x64_bf16 a[96:99], v[20:23], v[56:63], v12
    buffer_load_dwordx4 v1, s[20:23], s48 offen lds
    v_sub_f32 v73, v73, v39
    v_exp_f32 v73, v73
    v_mfma_f32_4x4x4_16b_bf16 v[180:183], v[170:171], v[34:35], 0
    v_sub_f32 v74, v74, v39
    v_exp_f32 v74, v74
    v_smfmac_f32_32x32x32_bf16 a[16:31], v[136:139], v[64:71], v12
    v_sub_f32 v75, v75, v39
    v_exp_f32 v75, v75
    v_sub_f32 v76, v76, v39
    v_exp_f32 v76, v76
    v_sub_f32 v77, v77, v39
    v_exp_f32 v77, v77
    v_smfmac_f32_16x16x64_bf16 a[100:103], v[20:23], v[64:71], v12
    buffer_load_dwordx4 v1, s[20:23], s48 offen offset:1024 lds
    v_sub_f32 v78, v78, v39
    v_exp_f32 v78, v78
    v_mfma_f32_4x4x4_16b_bf16 v[184:187], v[172:173], v[34:35], 0
    v_sub_f32 v79, v79, v39
    v_exp_f32 v79, v79
    v_cvt_pk_bf16_f32 v122, v180, v181
    v_cvt_pk_bf16_f32 v123, v182, v183
    v_mfma_f32_32x32x16_bf16 v[48:63], v[104:107], a[144:147], 4.0
    v_sub_f32 v80, v80, v40
    v_exp_f32 v80, v80
    v_sub_f32 v81, v81, v40
    v_exp_f32 v81, v81
    v_sub_f32 v82, v82, v40
    v_exp_f32 v82, v82
    v_mfma_f32_32x32x16_bf16 v[48:63], v[108:111], a[148:151], v[48:63]
    v_sub_f32 v83, v83, v40
    v_exp_f32 v83, v83
    v_sub_f32 v84, v84, v40
    v_exp_f32 v84, v84
    v_sub_f32 v85, v85, v40
    v_exp_f32 v85, v85
    v_cvt_pk_bf16_f32 v124, v184, v185
    v_cvt_pk_bf16_f32 v125, v186, v187
    v_smfmac_f32_32x32x32_bf16 a[16:31], v[140:143], v[72:79], v12
    v_sub_f32 v86, v86, v40
    v_exp_f32 v86, v86
    v_sub_f32 v87, v87, v40
    v_exp_f32 v87, v87
    v_sub_f32 v88, v88, v40
    v_exp_f32 v88, v88
    v_smfmac_f32_16x16x64_bf16 a[100:103], v[20:23], v[72:79], v12
    buffer_load_dwordx4 v1, s[20:23], s48 offen offset:2048 lds
    v_sub_f32 v89, v89, v40
    v_exp_f32 v89, v89
    v_mfma_f32_4x4x4_16b_bf16 v[188:191], v[174:175], v[34:35], 0
    v_sub_f32 v90, v90, v40
    v_exp_f32 v90, v90
    v_smfmac_f32_32x32x32_bf16 a[32:47], v[136:139], v[80:87], v12
    v_sub_f32 v91, v91, v40
    v_exp_f32 v91, v91
    v_sub_f32 v92, v92, v40
    v_exp_f32 v92, v92
    v_sub_f32 v93, v93, v40
    v_exp_f32 v93, v93
    v_smfmac_f32_16x16x64_bf16 a[104:107], v[20:23], v[80:87], v12
    buffer_load_dwordx4 v1, s[20:23], s48 offen offset:3072 lds
    v_sub_f32 v94, v94, v40
    v_exp_f32 v94, v94
    v_sub_f32 v95, v95, v40
    v_exp_f32 v95, v95
    v_cvt_pk_bf16_f32 v126, v188, v189
    v_cvt_pk_bf16_f32 v127, v190, v191
    v_mfma_f32_32x32x16_bf16 v[64:79], v[104:107], a[152:155], 4.0
    s_add_u32 m0, s36, 12288
    v_sub_f32 v48, v48, v41
    v_exp_f32 v48, v48
    v_sub_f32 v49, v49, v41
    v_exp_f32 v49, v49
    v_sub_f32 v50, v50, v41
    v_exp_f32 v50, v50
    v_mfma_f32_32x32x16_bf16 v[64:79], v[108:111], a[156:159], v[64:79]
    s_add_u32 s48, s34, 20480
    v_sub_f32 v51, v51, v41
    v_exp_f32 v51, v51
    v_sub_f32 v52, v52, v41
    v_exp_f32 v52, v52
    v_sub_f32 v53, v53, v41
    v_exp_f32 v53, v53
    v_smfmac_f32_32x32x32_bf16 a[32:47], v[140:143], v[88:95], v12
    v_sub_f32 v54, v54, v41
    v_exp_f32 v54, v54
    v_sub_f32 v55, v55, v41
    v_exp_f32 v55, v55
    v_sub_f32 v56, v56, v41
    v_exp_f32 v56, v56
    v_smfmac_f32_16x16x64_bf16 a[104:107], v[20:23], v[88:95], v12
    buffer_load_dwordx4 v2, s[24:27], s48 offen lds
    v_sub_f32 v57, v57, v41
    v_exp_f32 v57, v57
    v_sub_f32 v58, v58, v41
    v_exp_f32 v58, v58
    v_smfmac_f32_32x32x32_bf16 a[48:63], v[136:139], v[48:55], v12
    v_sub_f32 v59, v59, v41
    v_exp_f32 v59, v59
    v_sub_f32 v60, v60, v41
    v_exp_f32 v60, v60
    v_sub_f32 v61, v61, v41
    v_exp_f32 v61, v61
    v_smfmac_f32_16x16x64_bf16 a[108:111], v[20:23], v[48:55], v12
    buffer_load_dwordx4 v2, s[24:27], s48 offen offset:1024 lds
    v_sub_f32 v62, v62, v41
    v_exp_f32 v62, v62
    v_sub_f32 v63, v63, v41
    v_exp_f32 v63, v63
    v_mfma_f32_32x32x16_bf16 v[80:95], v[104:107], a[160:163], 4.0
    v_sub_f32 v64, v64, v42
    v_exp_f32 v64, v64
    v_sub_f32 v65, v65, v42
    v_exp_f32 v65, v65
    v_sub_f32 v66, v66, v42
    v_exp_f32 v66, v66
    v_mfma_f32_32x32x16_bf16 v[80:95], v[108:111], a[164:167], v[80:95]
    v_sub_f32 v67, v67, v42
    v_exp_f32 v67, v67
    v_sub_f32 v68, v68, v42
    v_exp_f32 v68, v68
    v_sub_f32 v69, v69, v42
    v_exp_f32 v69, v69
    v_smfmac_f32_32x32x32_bf16 a[48:63], v[140:143], v[56:63], v12
    v_sub_f32 v70, v70, v42
    v_exp_f32 v70, v70
    v_sub_f32 v71, v71, v42
    v_exp_f32 v71, v71
    v_sub_f32 v72, v72, v42
    v_exp_f32 v72, v72
    v_smfmac_f32_16x16x64_bf16 a[108:111], v[20:23], v[56:63], v12
    buffer_load_dwordx4 v2, s[24:27], s48 offen offset:2048 lds
    v_sub_f32 v73, v73, v42
    v_exp_f32 v73, v73
    v_sub_f32 v74, v74, v42
    v_exp_f32 v74, v74
    v_smfmac_f32_32x32x32_bf16 a[64:79], v[136:139], v[64:71], v12
    v_sub_f32 v75, v75, v42
    v_exp_f32 v75, v75
    v_sub_f32 v76, v76, v42
    v_exp_f32 v76, v76
    v_sub_f32 v77, v77, v42
    v_exp_f32 v77, v77
    v_smfmac_f32_16x16x64_bf16 a[112:115], v[20:23], v[64:71], v12
    buffer_load_dwordx4 v2, s[24:27], s48 offen offset:3072 lds
    v_sub_f32 v78, v78, v42
    v_exp_f32 v78, v78
    v_sub_f32 v79, v79, v42
    v_exp_f32 v79, v79
    v_mfma_f32_32x32x16_bf16 v[48:63], v[112:115], v[192:195], 4.0
    v_sub_f32 v80, v80, v43
    v_exp_f32 v80, v80
    v_sub_f32 v81, v81, v43
    v_exp_f32 v81, v81
    v_sub_f32 v82, v82, v43
    v_exp_f32 v82, v82
    v_mfma_f32_32x32x16_bf16 v[48:63], v[116:119], v[196:199], v[48:63]
    v_sub_f32 v83, v83, v43
    v_exp_f32 v83, v83
    v_sub_f32 v84, v84, v43
    v_exp_f32 v84, v84
    v_sub_f32 v85, v85, v43
    v_exp_f32 v85, v85
    v_smfmac_f32_32x32x32_bf16 a[64:79], v[140:143], v[72:79], v12
    v_sub_f32 v86, v86, v43
    v_exp_f32 v86, v86
    v_sub_f32 v87, v87, v43
    v_exp_f32 v87, v87
    v_sub_f32 v88, v88, v43
    v_exp_f32 v88, v88
    v_smfmac_f32_16x16x64_bf16 a[112:115], v[20:23], v[72:79], v12
    v_sub_f32 v89, v89, v43
    v_exp_f32 v89, v89
    v_sub_f32 v90, v90, v43
    v_exp_f32 v90, v90
    v_smfmac_f32_32x32x32_bf16 a[80:95], v[136:139], v[80:87], v12
    s_waitcnt lgkmcnt(0)
    v_sub_f32 v91, v91, v43
    v_exp_f32 v91, v91
    v_sub_f32 v92, v92, v43
    v_exp_f32 v92, v92
    v_sub_f32 v93, v93, v43
    v_exp_f32 v93, v93
    v_smfmac_f32_16x16x64_bf16 a[116:119], v[20:23], v[80:87], v12
    v_sub_f32 v94, v94, v43
    v_exp_f32 v94, v94
    v_sub_f32 v95, v95, v43
    v_exp_f32 v95, v95
    v_mfma_f32_32x32x16_bf16 v[64:79], v[112:115], v[200:203], 4.0
    v_sub_f32 v48, v48, v36
    v_exp_f32 v48, v48
    v_sub_f32 v49, v49, v36
    v_exp_f32 v49, v49
    v_sub_f32 v50, v50, v36
    v_exp_f32 v50, v50
    v_mfma_f32_32x32x16_bf16 v[64:79], v[116:119], v[204:207], v[64:79]
    v_sub_f32 v51, v51, v36
    v_exp_f32 v51, v51
    v_sub_f32 v52, v52, v36
    v_exp_f32 v52, v52
    v_sub_f32 v53, v53, v36
    v_exp_f32 v53, v53
    v_smfmac_f32_32x32x32_bf16 a[80:95], v[140:143], v[88:95], v12
    s_waitcnt vmcnt(12)
    v_sub_f32 v54, v54, v36
    v_exp_f32 v54, v54
    v_sub_f32 v55, v55, v36
    v_exp_f32 v55, v55
    v_sub_f32 v56, v56, v36
    v_exp_f32 v56, v56
    v_smfmac_f32_16x16x64_bf16 a[116:119], v[20:23], v[88:95], v12
    ds_read_b128 v[144:147], v4
    v_sub_f32 v57, v57, v36
    v_exp_f32 v57, v57
    v_sub_f32 v58, v58, v36
    v_exp_f32 v58, v58
    v_smfmac_f32_32x32x32_bf16 v[208:223], v[128:131], v[48:55], v12
    v_sub_f32 v59, v59, v36
    v_exp_f32 v59, v59
    v_sub_f32 v60, v60, v36
    v_exp_f32 v60, v60
    v_sub_f32 v61, v61, v36
    v_exp_f32 v61, v61
    v_smfmac_f32_16x16x64_bf16 v[240:243], v[20:23], v[48:55], v12
    ds_read_b128 v[148:151], v5
    v_sub_f32 v62, v62, v36
    v_exp_f32 v62, v62
    v_sub_f32 v63, v63, v36
    v_exp_f32 v63, v63
    v_mfma_f32_32x32x16_bf16 v[80:95], v[112:115], a[120:123], 4.0
    v_sub_f32 v64, v64, v37
    v_exp_f32 v64, v64
    v_sub_f32 v65, v65, v37
    v_exp_f32 v65, v65
    v_sub_f32 v66, v66, v37
    v_exp_f32 v66, v66
    v_mfma_f32_32x32x16_bf16 v[80:95], v[116:119], a[124:127], v[80:95]
    v_sub_f32 v67, v67, v37
    v_exp_f32 v67, v67
    v_sub_f32 v68, v68, v37
    v_exp_f32 v68, v68
    v_sub_f32 v69, v69, v37
    v_exp_f32 v69, v69
    v_smfmac_f32_32x32x32_bf16 v[208:223], v[132:135], v[56:63], v12
    v_sub_f32 v70, v70, v37
    v_exp_f32 v70, v70
    v_sub_f32 v71, v71, v37
    v_exp_f32 v71, v71
    v_sub_f32 v72, v72, v37
    v_exp_f32 v72, v72
    v_smfmac_f32_16x16x64_bf16 v[240:243], v[20:23], v[56:63], v12
    ds_read_b128 v[152:155], v6
    v_sub_f32 v73, v73, v37
    v_exp_f32 v73, v73
    v_sub_f32 v74, v74, v37
    v_exp_f32 v74, v74
    v_smfmac_f32_32x32x32_bf16 v[224:239], v[128:131], v[64:71], v12
    v_sub_f32 v75, v75, v37
    v_exp_f32 v75, v75
    v_sub_f32 v76, v76, v37
    v_exp_f32 v76, v76
    v_sub_f32 v77, v77, v37
    v_exp_f32 v77, v77
    v_smfmac_f32_16x16x64_bf16 v[244:247], v[20:23], v[64:71], v12
    ds_read_b128 v[156:159], v7
    v_sub_f32 v78, v78, v37
    v_exp_f32 v78, v78
    v_sub_f32 v79, v79, v37
    v_exp_f32 v79, v79
    v_mfma_f32_32x32x16_bf16 v[48:63], v[112:115], a[128:131], 4.0
    v_sub_f32 v80, v80, v38
    v_exp_f32 v80, v80
    v_sub_f32 v81, v81, v38
    v_exp_f32 v81, v81
    v_sub_f32 v82, v82, v38
    v_exp_f32 v82, v82
    v_mfma_f32_32x32x16_bf16 v[48:63], v[116:119], a[132:135], v[48:63]
    v_sub_f32 v83, v83, v38
    v_exp_f32 v83, v83
    v_sub_f32 v84, v84, v38
    v_exp_f32 v84, v84
    v_sub_f32 v85, v85, v38
    v_exp_f32 v85, v85
    v_smfmac_f32_32x32x32_bf16 v[224:239], v[132:135], v[72:79], v12
    v_sub_f32 v86, v86, v38
    v_exp_f32 v86, v86
    v_sub_f32 v87, v87, v38
    v_exp_f32 v87, v87
    v_sub_f32 v88, v88, v38
    v_exp_f32 v88, v88
    v_smfmac_f32_16x16x64_bf16 v[244:247], v[20:23], v[72:79], v12
    ds_read_b64_tr_b16 v[136:137], v3 offset:26624
    v_sub_f32 v89, v89, v38
    v_exp_f32 v89, v89
    v_sub_f32 v90, v90, v38
    v_exp_f32 v90, v90
    v_smfmac_f32_32x32x32_bf16 a[0:15], v[128:131], v[80:87], v12
    s_waitcnt lgkmcnt(4)
    v_sub_f32 v91, v91, v38
    v_exp_f32 v91, v91
    v_sub_f32 v92, v92, v38
    v_exp_f32 v92, v92
    v_sub_f32 v93, v93, v38
    v_exp_f32 v93, v93
    v_smfmac_f32_16x16x64_bf16 a[96:99], v[20:23], v[80:87], v12
    ds_read_b64_tr_b16 v[138:139], v3 offset:26880
    v_sub_f32 v94, v94, v38
    v_exp_f32 v94, v94
    v_mfma_f32_4x4x4_16b_bf16 v[24:27], v[144:145], v[144:145], 0
    v_sub_f32 v95, v95, v38
    v_exp_f32 v95, v95
    v_mfma_f32_32x32x16_bf16 v[64:79], v[112:115], a[136:139], 4.0
    v_sub_f32 v48, v48, v39
    v_exp_f32 v48, v48
    v_sub_f32 v49, v49, v39
    v_exp_f32 v49, v49
    v_sub_f32 v50, v50, v39
    v_exp_f32 v50, v50
    v_mfma_f32_32x32x16_bf16 v[64:79], v[116:119], a[140:143], v[64:79]
    v_sub_f32 v51, v51, v39
    v_exp_f32 v51, v51
    v_sub_f32 v52, v52, v39
    v_exp_f32 v52, v52
    v_sub_f32 v53, v53, v39
    v_exp_f32 v53, v53
    v_smfmac_f32_32x32x32_bf16 a[0:15], v[132:135], v[88:95], v12
    v_sub_f32 v54, v54, v39
    v_exp_f32 v54, v54
    v_sub_f32 v55, v55, v39
    v_exp_f32 v55, v55
    v_sub_f32 v56, v56, v39
    v_exp_f32 v56, v56
    v_smfmac_f32_16x16x64_bf16 a[96:99], v[20:23], v[88:95], v12
    ds_read_b64_tr_b16 v[140:141], v3 offset:27648
    v_sub_f32 v57, v57, v39
    v_exp_f32 v57, v57
    v_mfma_f32_4x4x4_16b_bf16 v[24:27], v[146:147], v[146:147], v[24:27]
    v_sub_f32 v58, v58, v39
    v_exp_f32 v58, v58
    v_smfmac_f32_32x32x32_bf16 a[16:31], v[128:131], v[48:55], v12
    s_waitcnt lgkmcnt(5)
    v_sub_f32 v59, v59, v39
    v_exp_f32 v59, v59
    v_sub_f32 v60, v60, v39
    v_exp_f32 v60, v60
    v_sub_f32 v61, v61, v39
    v_exp_f32 v61, v61
    v_smfmac_f32_16x16x64_bf16 a[100:103], v[20:23], v[48:55], v12
    ds_read_b64_tr_b16 v[142:143], v3 offset:27904
    v_sub_f32 v62, v62, v39
    v_exp_f32 v62, v62
    v_mfma_f32_4x4x4_16b_bf16 v[24:27], v[148:149], v[148:149], v[24:27]
    v_sub_f32 v63, v63, v39
    v_exp_f32 v63, v63
    v_mfma_f32_32x32x16_bf16 v[80:95], v[112:115], a[144:147], 4.0
    v_sub_f32 v64, v64, v40
    v_exp_f32 v64, v64
    v_sub_f32 v65, v65, v40
    v_exp_f32 v65, v65
    v_sub_f32 v66, v66, v40
    v_exp_f32 v66, v66
    v_mfma_f32_32x32x16_bf16 v[80:95], v[116:119], a[148:151], v[80:95]
    v_sub_f32 v67, v67, v40
    v_exp_f32 v67, v67
    v_sub_f32 v68, v68, v40
    v_exp_f32 v68, v68
    v_sub_f32 v69, v69, v40
    v_exp_f32 v69, v69
    v_smfmac_f32_32x32x32_bf16 a[16:31], v[132:135], v[56:63], v12
    v_sub_f32 v70, v70, v40
    v_exp_f32 v70, v70
    v_sub_f32 v71, v71, v40
    v_exp_f32 v71, v71
    v_sub_f32 v72, v72, v40
    v_exp_f32 v72, v72
    v_smfmac_f32_16x16x64_bf16 a[100:103], v[20:23], v[56:63], v12
    ds_read_b64_tr_b16 v[160:161], v8
    v_sub_f32 v73, v73, v40
    v_exp_f32 v73, v73
    v_mfma_f32_4x4x4_16b_bf16 v[24:27], v[150:151], v[150:151], v[24:27]
    v_sub_f32 v74, v74, v40
    v_exp_f32 v74, v74
    v_smfmac_f32_32x32x32_bf16 a[32:47], v[128:131], v[64:71], v12
    s_waitcnt lgkmcnt(6)
    v_sub_f32 v75, v75, v40
    v_exp_f32 v75, v75
    v_sub_f32 v76, v76, v40
    v_exp_f32 v76, v76
    v_sub_f32 v77, v77, v40
    v_exp_f32 v77, v77
    v_smfmac_f32_16x16x64_bf16 a[104:107], v[20:23], v[64:71], v12
    ds_read_b64_tr_b16 v[162:163], v8 offset:8
    v_sub_f32 v78, v78, v40
    v_exp_f32 v78, v78
    v_mfma_f32_4x4x4_16b_bf16 v[24:27], v[152:153], v[152:153], v[24:27]
    v_sub_f32 v79, v79, v40
    v_exp_f32 v79, v79
    v_mfma_f32_32x32x16_bf16 v[48:63], v[112:115], a[152:155], 4.0
    v_sub_f32 v80, v80, v41
    v_exp_f32 v80, v80
    v_sub_f32 v81, v81, v41
    v_exp_f32 v81, v81
    v_sub_f32 v82, v82, v41
    v_exp_f32 v82, v82
    v_mfma_f32_32x32x16_bf16 v[48:63], v[116:119], a[156:159], v[48:63]
    v_sub_f32 v83, v83, v41
    v_exp_f32 v83, v83
    v_sub_f32 v84, v84, v41
    v_exp_f32 v84, v84
    v_sub_f32 v85, v85, v41
    v_exp_f32 v85, v85
    v_smfmac_f32_32x32x32_bf16 a[32:47], v[132:135], v[72:79], v12
    v_sub_f32 v86, v86, v41
    v_exp_f32 v86, v86
    v_sub_f32 v87, v87, v41
    v_exp_f32 v87, v87
    v_sub_f32 v88, v88, v41
    v_exp_f32 v88, v88
    v_smfmac_f32_16x16x64_bf16 a[104:107], v[20:23], v[72:79], v12
    ds_read_b64_tr_b16 v[164:165], v9
    v_sub_f32 v89, v89, v41
    v_exp_f32 v89, v89
    v_mfma_f32_4x4x4_16b_bf16 v[24:27], v[154:155], v[154:155], v[24:27]
    v_sub_f32 v90, v90, v41
    v_exp_f32 v90, v90
    v_smfmac_f32_32x32x32_bf16 a[48:63], v[128:131], v[80:87], v12
    s_waitcnt lgkmcnt(7)
    v_sub_f32 v91, v91, v41
    v_exp_f32 v91, v91
    v_sub_f32 v92, v92, v41
    v_exp_f32 v92, v92
    v_sub_f32 v93, v93, v41
    v_exp_f32 v93, v93
    v_smfmac_f32_16x16x64_bf16 a[108:111], v[20:23], v[80:87], v12
    ds_read_b64_tr_b16 v[166:167], v9 offset:8
    v_sub_f32 v94, v94, v41
    v_exp_f32 v94, v94
    v_mfma_f32_4x4x4_16b_bf16 v[24:27], v[156:157], v[156:157], v[24:27]
    v_sub_f32 v95, v95, v41
    v_exp_f32 v95, v95
    v_mfma_f32_32x32x16_bf16 v[64:79], v[112:115], a[160:163], 4.0
    v_sub_f32 v48, v48, v42
    v_exp_f32 v48, v48
    v_sub_f32 v49, v49, v42
    v_exp_f32 v49, v49
    v_sub_f32 v50, v50, v42
    v_exp_f32 v50, v50
    v_mfma_f32_32x32x16_bf16 v[64:79], v[116:119], a[164:167], v[64:79]
    v_sub_f32 v51, v51, v42
    v_exp_f32 v51, v51
    v_sub_f32 v52, v52, v42
    v_exp_f32 v52, v52
    v_sub_f32 v53, v53, v42
    v_exp_f32 v53, v53
    v_smfmac_f32_32x32x32_bf16 a[48:63], v[132:135], v[88:95], v12
    v_sub_f32 v54, v54, v42
    v_exp_f32 v54, v54
    v_sub_f32 v55, v55, v42
    v_exp_f32 v55, v55
    v_sub_f32 v56, v56, v42
    v_exp_f32 v56, v56
    v_smfmac_f32_16x16x64_bf16 a[108:111], v[20:23], v[88:95], v12
    ds_read_b64_tr_b16 v[168:169], v8 offset:2048
    v_sub_f32 v57, v57, v42
    v_exp_f32 v57, v57
    v_mfma_f32_4x4x4_16b_bf16 v[24:27], v[158:159], v[158:159], v[24:27]
    v_sub_f32 v58, v58, v42
    v_exp_f32 v58, v58
    v_smfmac_f32_32x32x32_bf16 a[64:79], v[128:131], v[48:55], v12
    v_sub_f32 v59, v59, v42
    v_exp_f32 v59, v59
    v_sub_f32 v60, v60, v42
    v_exp_f32 v60, v60
    v_sub_f32 v61, v61, v42
    v_exp_f32 v61, v61
    v_smfmac_f32_16x16x64_bf16 a[112:115], v[20:23], v[48:55], v12
    ds_read_b64_tr_b16 v[170:171], v8 offset:2056
    v_sub_f32 v62, v62, v42
    v_exp_f32 v62, v62
    v_sub_f32 v63, v63, v42
    v_exp_f32 v63, v63
    v_cndmask_b32 v28, v24, v25, s[40:41]
    v_mfma_f32_32x32x16_bf16 v[80:95], v[120:123], v[192:195], 4.0
    v_sub_f32 v64, v64, v43
    v_exp_f32 v64, v64
    v_sub_f32 v65, v65, v43
    v_exp_f32 v65, v65
    v_sub_f32 v66, v66, v43
    v_exp_f32 v66, v66
    v_cndmask_b32 v28, v28, v26, s[42:43]
    v_mfma_f32_32x32x16_bf16 v[80:95], v[124:127], v[196:199], v[80:95]
    s_waitcnt lgkmcnt(6)
    v_sub_f32 v67, v67, v43
    v_exp_f32 v67, v67
    v_sub_f32 v68, v68, v43
    v_exp_f32 v68, v68
    v_sub_f32 v69, v69, v43
    v_exp_f32 v69, v69
    v_cndmask_b32 v28, v28, v27, s[44:45]
    v_smfmac_f32_32x32x32_bf16 a[64:79], v[132:135], v[56:63], v12
    v_sub_f32 v70, v70, v43
    v_exp_f32 v70, v70
    v_sub_f32 v71, v71, v43
    v_exp_f32 v71, v71
    v_sub_f32 v72, v72, v43
    v_exp_f32 v72, v72
    v_sqrt_f32 v28, v28
    v_smfmac_f32_16x16x64_bf16 a[112:115], v[20:23], v[56:63], v12
    ds_read_b64_tr_b16 v[172:173], v9 offset:2048
    v_sub_f32 v73, v73, v43
    v_exp_f32 v73, v73
    v_sub_f32 v74, v74, v43
    v_exp_f32 v74, v74
    v_add_f32 v28, 0x358637bd, v28
    v_smfmac_f32_32x32x32_bf16 a[80:95], v[128:131], v[64:71], v12
    v_sub_f32 v75, v75, v43
    v_exp_f32 v75, v75
    v_sub_f32 v76, v76, v43
    v_exp_f32 v76, v76
    v_sub_f32 v77, v77, v43
    v_exp_f32 v77, v77
    v_rcp_f32 v28, v28
    v_smfmac_f32_16x16x64_bf16 a[116:119], v[20:23], v[64:71], v12
    ds_read_b64_tr_b16 v[174:175], v9 offset:2056
    v_sub_f32 v78, v78, v43
    v_exp_f32 v78, v78
    v_sub_f32 v79, v79, v43
    v_exp_f32 v79, v79
    v_cvt_pk_bf16_f32 v29, v28, v28
    v_cvt_pk_bf16_f32 v30, v28, v28
    v_mfma_f32_32x32x16_bf16 v[48:63], v[120:123], v[200:203], 4.0
    v_sub_f32 v80, v80, v36
    v_exp_f32 v80, v80
    v_sub_f32 v81, v81, v36
    v_exp_f32 v81, v81
    v_sub_f32 v82, v82, v36
    v_exp_f32 v82, v82
    v_permlane32_swap_b32 v29, v30
    v_mfma_f32_32x32x16_bf16 v[48:63], v[124:127], v[204:207], v[48:63]
    v_sub_f32 v83, v83, v36
    v_exp_f32 v83, v83
    v_sub_f32 v84, v84, v36
    v_exp_f32 v84, v84
    v_sub_f32 v85, v85, v36
    v_exp_f32 v85, v85
    v_and_b32 v32, v29, v10
    v_and_b32 v33, v29, v11
    v_smfmac_f32_32x32x32_bf16 a[80:95], v[132:135], v[72:79], v12
    v_sub_f32 v86, v86, v36
    v_exp_f32 v86, v86
    v_sub_f32 v87, v87, v36
    v_exp_f32 v87, v87
    v_sub_f32 v88, v88, v36
    v_exp_f32 v88, v88
    v_and_b32 v34, v30, v10
    v_and_b32 v35, v30, v11
    v_smfmac_f32_16x16x64_bf16 a[116:119], v[20:23], v[72:79], v12
    v_sub_f32 v89, v89, v36
    v_exp_f32 v89, v89
    v_sub_f32 v90, v90, v36
    v_exp_f32 v90, v90
    v_smfmac_f32_32x32x32_bf16 v[208:223], v[136:139], v[80:87], v12
    s_waitcnt lgkmcnt(4)
    v_sub_f32 v91, v91, v36
    v_exp_f32 v91, v91
    v_sub_f32 v92, v92, v36
    v_exp_f32 v92, v92
    v_sub_f32 v93, v93, v36
    v_exp_f32 v93, v93
    v_smfmac_f32_16x16x64_bf16 v[240:243], v[20:23], v[80:87], v12
    v_sub_f32 v94, v94, v36
    v_exp_f32 v94, v94
    v_mfma_f32_4x4x4_16b_bf16 v[176:179], v[160:161], v[32:33], 0
    v_sub_f32 v95, v95, v36
    v_exp_f32 v95, v95
    v_mfma_f32_32x32x16_bf16 v[64:79], v[120:123], a[120:123], 4.0
    v_sub_f32 v48, v48, v37
    v_exp_f32 v48, v48
    v_sub_f32 v49, v49, v37
    v_exp_f32 v49, v49
    v_sub_f32 v50, v50, v37
    v_exp_f32 v50, v50
    v_mfma_f32_32x32x16_bf16 v[64:79], v[124:127], a[124:127], v[64:79]
    v_sub_f32 v51, v51, v37
    v_exp_f32 v51, v51
    v_sub_f32 v52, v52, v37
    v_exp_f32 v52, v52
    v_sub_f32 v53, v53, v37
    v_exp_f32 v53, v53
    v_cvt_pk_bf16_f32 v96, v176, v177
    v_cvt_pk_bf16_f32 v97, v178, v179
    v_smfmac_f32_32x32x32_bf16 v[208:223], v[140:143], v[88:95], v12
    s_waitcnt vmcnt(10)
    v_sub_f32 v54, v54, v37
    v_exp_f32 v54, v54
    v_sub_f32 v55, v55, v37
    v_exp_f32 v55, v55
    v_sub_f32 v56, v56, v37
    v_exp_f32 v56, v56
    v_smfmac_f32_16x16x64_bf16 v[240:243], v[20:23], v[88:95], v12
    ds_read_b64_tr_b16 v[128:129], v3
    v_sub_f32 v57, v57, v37
    v_exp_f32 v57, v57
    v_mfma_f32_4x4x4_16b_bf16 v[180:183], v[162:163], v[32:33], 0
    v_sub_f32 v58, v58, v37
    v_exp_f32 v58, v58
    v_smfmac_f32_32x32x32_bf16 v[224:239], v[136:139], v[48:55], v12
    v_sub_f32 v59, v59, v37
    v_exp_f32 v59, v59
    v_sub_f32 v60, v60, v37
    v_exp_f32 v60, v60
    v_sub_f32 v61, v61, v37
    v_exp_f32 v61, v61
    v_smfmac_f32_16x16x64_bf16 v[244:247], v[20:23], v[48:55], v12
    ds_read_b64_tr_b16 v[130:131], v3 offset:256
    v_sub_f32 v62, v62, v37
    v_exp_f32 v62, v62
    v_mfma_f32_4x4x4_16b_bf16 v[184:187], v[164:165], v[32:33], 0
    v_sub_f32 v63, v63, v37
    v_exp_f32 v63, v63
    v_cvt_pk_bf16_f32 v98, v180, v181
    v_cvt_pk_bf16_f32 v99, v182, v183
    v_mfma_f32_32x32x16_bf16 v[80:95], v[120:123], a[128:131], 4.0
    v_sub_f32 v64, v64, v38
    v_exp_f32 v64, v64
    v_sub_f32 v65, v65, v38
    v_exp_f32 v65, v65
    v_sub_f32 v66, v66, v38
    v_exp_f32 v66, v66
    v_mfma_f32_32x32x16_bf16 v[80:95], v[124:127], a[132:135], v[80:95]
    v_sub_f32 v67, v67, v38
    v_exp_f32 v67, v67
    v_sub_f32 v68, v68, v38
    v_exp_f32 v68, v68
    v_sub_f32 v69, v69, v38
    v_exp_f32 v69, v69
    v_cvt_pk_bf16_f32 v100, v184, v185
    v_cvt_pk_bf16_f32 v101, v186, v187
    v_smfmac_f32_32x32x32_bf16 v[224:239], v[140:143], v[56:63], v12
    v_sub_f32 v70, v70, v38
    v_exp_f32 v70, v70
    v_sub_f32 v71, v71, v38
    v_exp_f32 v71, v71
    v_sub_f32 v72, v72, v38
    v_exp_f32 v72, v72
    v_smfmac_f32_16x16x64_bf16 v[244:247], v[20:23], v[56:63], v12
    ds_read_b64_tr_b16 v[132:133], v3 offset:1024
    v_sub_f32 v73, v73, v38
    v_exp_f32 v73, v73
    v_mfma_f32_4x4x4_16b_bf16 v[188:191], v[166:167], v[32:33], 0
    v_sub_f32 v74, v74, v38
    v_exp_f32 v74, v74
    v_smfmac_f32_32x32x32_bf16 a[0:15], v[136:139], v[64:71], v12
    s_waitcnt lgkmcnt(3)
    v_sub_f32 v75, v75, v38
    v_exp_f32 v75, v75
    v_sub_f32 v76, v76, v38
    v_exp_f32 v76, v76
    v_sub_f32 v77, v77, v38
    v_exp_f32 v77, v77
    v_smfmac_f32_16x16x64_bf16 a[96:99], v[20:23], v[64:71], v12
    ds_read_b64_tr_b16 v[134:135], v3 offset:1280
    v_sub_f32 v78, v78, v38
    v_exp_f32 v78, v78
    v_mfma_f32_4x4x4_16b_bf16 v[176:179], v[168:169], v[34:35], 0
    v_sub_f32 v79, v79, v38
    v_exp_f32 v79, v79
    v_cvt_pk_bf16_f32 v102, v188, v189
    v_cvt_pk_bf16_f32 v103, v190, v191
    v_mfma_f32_32x32x16_bf16 v[48:63], v[120:123], a[136:139], 4.0
    s_add_u32 m0, s36, 16384
    v_sub_f32 v80, v80, v39
    v_exp_f32 v80, v80
    v_sub_f32 v81, v81, v39
    v_exp_f32 v81, v81
    v_sub_f32 v82, v82, v39
    v_exp_f32 v82, v82
    v_mfma_f32_32x32x16_bf16 v[48:63], v[124:127], a[140:143], v[48:63]
    s_add_u32 s48, s34, 24576
    v_sub_f32 v83, v83, v39
    v_exp_f32 v83, v83
    v_sub_f32 v84, v84, v39
    v_exp_f32 v84, v84
    v_sub_f32 v85, v85, v39
    v_exp_f32 v85, v85
    v_cvt_pk_bf16_f32 v104, v176, v177
    v_cvt_pk_bf16_f32 v105, v178, v179
    v_smfmac_f32_32x32x32_bf16 a[0:15], v[140:143], v[72:79], v12
    v_sub_f32 v86, v86, v39
    v_exp_f32 v86, v86
    v_sub_f32 v87, v87, v39
    v_exp_f32 v87, v87
    v_sub_f32 v88, v88, v39
    v_exp_f32 v88, v88
    v_smfmac_f32_16x16x64_bf16 a[96:99], v[20:23], v[72:79], v12
    buffer_load_dwordx4 v1, s[20:23], s48 offen lds
    v_sub_f32 v89, v89, v39
    v_exp_f32 v89, v89
    v_mfma_f32_4x4x4_16b_bf16 v[180:183], v[170:171], v[34:35], 0
    v_sub_f32 v90, v90, v39
    v_exp_f32 v90, v90
    v_smfmac_f32_32x32x32_bf16 a[16:31], v[136:139], v[80:87], v12
    v_sub_f32 v91, v91, v39
    v_exp_f32 v91, v91
    v_sub_f32 v92, v92, v39
    v_exp_f32 v92, v92
    v_sub_f32 v93, v93, v39
    v_exp_f32 v93, v93
    v_smfmac_f32_16x16x64_bf16 a[100:103], v[20:23], v[80:87], v12
    buffer_load_dwordx4 v1, s[20:23], s48 offen offset:1024 lds
    v_sub_f32 v94, v94, v39
    v_exp_f32 v94, v94
    v_mfma_f32_4x4x4_16b_bf16 v[184:187], v[172:173], v[34:35], 0
    v_sub_f32 v95, v95, v39
    v_exp_f32 v95, v95
    v_cvt_pk_bf16_f32 v106, v180, v181
    v_cvt_pk_bf16_f32 v107, v182, v183
    v_mfma_f32_32x32x16_bf16 v[64:79], v[120:123], a[144:147], 4.0
    v_sub_f32 v48, v48, v40
    v_exp_f32 v48, v48
    v_sub_f32 v49, v49, v40
    v_exp_f32 v49, v49
    v_sub_f32 v50, v50, v40
    v_exp_f32 v50, v50
    v_mfma_f32_32x32x16_bf16 v[64:79], v[124:127], a[148:151], v[64:79]
    v_sub_f32 v51, v51, v40
    v_exp_f32 v51, v51
    v_sub_f32 v52, v52, v40
    v_exp_f32 v52, v52
    v_sub_f32 v53, v53, v40
    v_exp_f32 v53, v53
    v_cvt_pk_bf16_f32 v108, v184, v185
    v_cvt_pk_bf16_f32 v109, v186, v187
    v_smfmac_f32_32x32x32_bf16 a[16:31], v[140:143], v[88:95], v12
    v_sub_f32 v54, v54, v40
    v_exp_f32 v54, v54
    v_sub_f32 v55, v55, v40
    v_exp_f32 v55, v55
    v_sub_f32 v56, v56, v40
    v_exp_f32 v56, v56
    v_smfmac_f32_16x16x64_bf16 a[100:103], v[20:23], v[88:95], v12
    buffer_load_dwordx4 v1, s[20:23], s48 offen offset:2048 lds
    v_sub_f32 v57, v57, v40
    v_exp_f32 v57, v57
    v_mfma_f32_4x4x4_16b_bf16 v[188:191], v[174:175], v[34:35], 0
    v_sub_f32 v58, v58, v40
    v_exp_f32 v58, v58
    v_smfmac_f32_32x32x32_bf16 a[32:47], v[136:139], v[48:55], v12
    v_sub_f32 v59, v59, v40
    v_exp_f32 v59, v59
    v_sub_f32 v60, v60, v40
    v_exp_f32 v60, v60
    v_sub_f32 v61, v61, v40
    v_exp_f32 v61, v61
    v_smfmac_f32_16x16x64_bf16 a[104:107], v[20:23], v[48:55], v12
    buffer_load_dwordx4 v1, s[20:23], s48 offen offset:3072 lds
    v_sub_f32 v62, v62, v40
    v_exp_f32 v62, v62
    v_sub_f32 v63, v63, v40
    v_exp_f32 v63, v63
    v_cvt_pk_bf16_f32 v110, v188, v189
    v_cvt_pk_bf16_f32 v111, v190, v191
    v_mfma_f32_32x32x16_bf16 v[80:95], v[120:123], a[152:155], 4.0
    s_add_u32 m0, s36, 20480
    v_sub_f32 v64, v64, v41
    v_exp_f32 v64, v64
    v_sub_f32 v65, v65, v41
    v_exp_f32 v65, v65
    v_sub_f32 v66, v66, v41
    v_exp_f32 v66, v66
    v_mfma_f32_32x32x16_bf16 v[80:95], v[124:127], a[156:159], v[80:95]
    s_add_u32 s48, s34, 24576
    v_sub_f32 v67, v67, v41
    v_exp_f32 v67, v67
    v_sub_f32 v68, v68, v41
    v_exp_f32 v68, v68
    v_sub_f32 v69, v69, v41
    v_exp_f32 v69, v69
    v_smfmac_f32_32x32x32_bf16 a[32:47], v[140:143], v[56:63], v12
    v_sub_f32 v70, v70, v41
    v_exp_f32 v70, v70
    v_sub_f32 v71, v71, v41
    v_exp_f32 v71, v71
    v_sub_f32 v72, v72, v41
    v_exp_f32 v72, v72
    v_smfmac_f32_16x16x64_bf16 a[104:107], v[20:23], v[56:63], v12
    buffer_load_dwordx4 v2, s[24:27], s48 offen lds
    v_sub_f32 v73, v73, v41
    v_exp_f32 v73, v73
    v_sub_f32 v74, v74, v41
    v_exp_f32 v74, v74
    v_smfmac_f32_32x32x32_bf16 a[48:63], v[136:139], v[64:71], v12
    v_sub_f32 v75, v75, v41
    v_exp_f32 v75, v75
    v_sub_f32 v76, v76, v41
    v_exp_f32 v76, v76
    v_sub_f32 v77, v77, v41
    v_exp_f32 v77, v77
    v_smfmac_f32_16x16x64_bf16 a[108:111], v[20:23], v[64:71], v12
    buffer_load_dwordx4 v2, s[24:27], s48 offen offset:1024 lds
    v_sub_f32 v78, v78, v41
    v_exp_f32 v78, v78
    v_sub_f32 v79, v79, v41
    v_exp_f32 v79, v79
    v_mfma_f32_32x32x16_bf16 v[48:63], v[120:123], a[160:163], 4.0
    v_sub_f32 v80, v80, v42
    v_exp_f32 v80, v80
    v_sub_f32 v81, v81, v42
    v_exp_f32 v81, v81
    v_sub_f32 v82, v82, v42
    v_exp_f32 v82, v82
    v_mfma_f32_32x32x16_bf16 v[48:63], v[124:127], a[164:167], v[48:63]
    v_sub_f32 v83, v83, v42
    v_exp_f32 v83, v83
    v_sub_f32 v84, v84, v42
    v_exp_f32 v84, v84
    v_sub_f32 v85, v85, v42
    v_exp_f32 v85, v85
    v_smfmac_f32_32x32x32_bf16 a[48:63], v[140:143], v[72:79], v12
    v_sub_f32 v86, v86, v42
    v_exp_f32 v86, v86
    v_sub_f32 v87, v87, v42
    v_exp_f32 v87, v87
    v_sub_f32 v88, v88, v42
    v_exp_f32 v88, v88
    v_smfmac_f32_16x16x64_bf16 a[108:111], v[20:23], v[72:79], v12
    buffer_load_dwordx4 v2, s[24:27], s48 offen offset:2048 lds
    v_sub_f32 v89, v89, v42
    v_exp_f32 v89, v89
    v_sub_f32 v90, v90, v42
    v_exp_f32 v90, v90
    v_smfmac_f32_32x32x32_bf16 a[64:79], v[136:139], v[80:87], v12
    v_sub_f32 v91, v91, v42
    v_exp_f32 v91, v91
    v_sub_f32 v92, v92, v42
    v_exp_f32 v92, v92
    v_sub_f32 v93, v93, v42
    v_exp_f32 v93, v93
    v_smfmac_f32_16x16x64_bf16 a[112:115], v[20:23], v[80:87], v12
    buffer_load_dwordx4 v2, s[24:27], s48 offen offset:3072 lds
    v_sub_f32 v94, v94, v42
    v_exp_f32 v94, v94
    v_sub_f32 v95, v95, v42
    v_exp_f32 v95, v95
    v_mfma_f32_32x32x16_bf16 v[64:79], v[96:99], v[192:195], 4.0
    v_sub_f32 v48, v48, v43
    v_exp_f32 v48, v48
    v_sub_f32 v49, v49, v43
    v_exp_f32 v49, v49
    v_sub_f32 v50, v50, v43
    v_exp_f32 v50, v50
    v_mfma_f32_32x32x16_bf16 v[64:79], v[100:103], v[196:199], v[64:79]
    v_sub_f32 v51, v51, v43
    v_exp_f32 v51, v51
    v_sub_f32 v52, v52, v43
    v_exp_f32 v52, v52
    v_sub_f32 v53, v53, v43
    v_exp_f32 v53, v53
    v_smfmac_f32_32x32x32_bf16 a[64:79], v[140:143], v[88:95], v12
    v_sub_f32 v54, v54, v43
    v_exp_f32 v54, v54
    v_sub_f32 v55, v55, v43
    v_exp_f32 v55, v55
    v_sub_f32 v56, v56, v43
    v_exp_f32 v56, v56
    v_smfmac_f32_16x16x64_bf16 a[112:115], v[20:23], v[88:95], v12
    v_sub_f32 v57, v57, v43
    v_exp_f32 v57, v57
    v_sub_f32 v58, v58, v43
    v_exp_f32 v58, v58
    v_smfmac_f32_32x32x32_bf16 a[80:95], v[136:139], v[48:55], v12
    s_waitcnt lgkmcnt(0)
    v_sub_f32 v59, v59, v43
    v_exp_f32 v59, v59
    v_sub_f32 v60, v60, v43
    v_exp_f32 v60, v60
    v_sub_f32 v61, v61, v43
    v_exp_f32 v61, v61
    v_smfmac_f32_16x16x64_bf16 a[116:119], v[20:23], v[48:55], v12
    v_sub_f32 v62, v62, v43
    v_exp_f32 v62, v62
    v_sub_f32 v63, v63, v43
    v_exp_f32 v63, v63
    v_mfma_f32_32x32x16_bf16 v[80:95], v[96:99], v[200:203], 4.0
    v_sub_f32 v64, v64, v36
    v_exp_f32 v64, v64
    v_sub_f32 v65, v65, v36
    v_exp_f32 v65, v65
    v_sub_f32 v66, v66, v36
    v_exp_f32 v66, v66
    v_mfma_f32_32x32x16_bf16 v[80:95], v[100:103], v[204:207], v[80:95]
    v_sub_f32 v67, v67, v36
    v_exp_f32 v67, v67
    v_sub_f32 v68, v68, v36
    v_exp_f32 v68, v68
    v_sub_f32 v69, v69, v36
    v_exp_f32 v69, v69
    v_smfmac_f32_32x32x32_bf16 a[80:95], v[140:143], v[56:63], v12
    s_waitcnt vmcnt(12)
    v_sub_f32 v70, v70, v36
    v_exp_f32 v70, v70
    v_sub_f32 v71, v71, v36
    v_exp_f32 v71, v71
    v_sub_f32 v72, v72, v36
    v_exp_f32 v72, v72
    v_smfmac_f32_16x16x64_bf16 a[116:119], v[20:23], v[56:63], v12
    ds_read_b128 v[144:147], v4 offset:8192
    v_sub_f32 v73, v73, v36
    v_exp_f32 v73, v73
    v_sub_f32 v74, v74, v36
    v_exp_f32 v74, v74
    v_smfmac_f32_32x32x32_bf16 v[208:223], v[128:131], v[64:71], v12
    v_sub_f32 v75, v75, v36
    v_exp_f32 v75, v75
    v_sub_f32 v76, v76, v36
    v_exp_f32 v76, v76
    v_sub_f32 v77, v77, v36
    v_exp_f32 v77, v77
    v_smfmac_f32_16x16x64_bf16 v[240:243], v[20:23], v[64:71], v12
    ds_read_b128 v[148:151], v5 offset:8192
    v_sub_f32 v78, v78, v36
    v_exp_f32 v78, v78
    v_sub_f32 v79, v79, v36
    v_exp_f32 v79, v79
    v_mfma_f32_32x32x16_bf16 v[48:63], v[96:99], a[120:123], 4.0
    v_sub_f32 v80, v80, v37
    v_exp_f32 v80, v80
    v_sub_f32 v81, v81, v37
    v_exp_f32 v81, v81
    v_sub_f32 v82, v82, v37
    v_exp_f32 v82, v82
    v_mfma_f32_32x32x16_bf16 v[48:63], v[100:103], a[124:127], v[48:63]
    v_sub_f32 v83, v83, v37
    v_exp_f32 v83, v83
    v_sub_f32 v84, v84, v37
    v_exp_f32 v84, v84
    v_sub_f32 v85, v85, v37
    v_exp_f32 v85, v85
    v_smfmac_f32_32x32x32_bf16 v[208:223], v[132:135], v[72:79], v12
    v_sub_f32 v86, v86, v37
    v_exp_f32 v86, v86
    v_sub_f32 v87, v87, v37
    v_exp_f32 v87, v87
    v_sub_f32 v88, v88, v37
    v_exp_f32 v88, v88
    v_smfmac_f32_16x16x64_bf16 v[240:243], v[20:23], v[72:79], v12
    ds_read_b128 v[152:155], v6 offset:8192
    v_sub_f32 v89, v89, v37
    v_exp_f32 v89, v89
    v_sub_f32 v90, v90, v37
    v_exp_f32 v90, v90
    v_smfmac_f32_32x32x32_bf16 v[224:239], v[128:131], v[80:87], v12
    v_sub_f32 v91, v91, v37
    v_exp_f32 v91, v91
    v_sub_f32 v92, v92, v37
    v_exp_f32 v92, v92
    v_sub_f32 v93, v93, v37
    v_exp_f32 v93, v93
    v_smfmac_f32_16x16x64_bf16 v[244:247], v[20:23], v[80:87], v12
    ds_read_b128 v[156:159], v7 offset:8192
    v_sub_f32 v94, v94, v37
    v_exp_f32 v94, v94
    v_sub_f32 v95, v95, v37
    v_exp_f32 v95, v95
    v_mfma_f32_32x32x16_bf16 v[64:79], v[96:99], a[128:131], 4.0
    v_sub_f32 v48, v48, v38
    v_exp_f32 v48, v48
    v_sub_f32 v49, v49, v38
    v_exp_f32 v49, v49
    v_sub_f32 v50, v50, v38
    v_exp_f32 v50, v50
    v_mfma_f32_32x32x16_bf16 v[64:79], v[100:103], a[132:135], v[64:79]
    v_sub_f32 v51, v51, v38
    v_exp_f32 v51, v51
    v_sub_f32 v52, v52, v38
    v_exp_f32 v52, v52
    v_sub_f32 v53, v53, v38
    v_exp_f32 v53, v53
    v_smfmac_f32_32x32x32_bf16 v[224:239], v[132:135], v[88:95], v12
    v_sub_f32 v54, v54, v38
    v_exp_f32 v54, v54
    v_sub_f32 v55, v55, v38
    v_exp_f32 v55, v55
    v_sub_f32 v56, v56, v38
    v_exp_f32 v56, v56
    v_smfmac_f32_16x16x64_bf16 v[244:247], v[20:23], v[88:95], v12
    ds_read_b64_tr_b16 v[136:137], v3 offset:2048
    v_sub_f32 v57, v57, v38
    v_exp_f32 v57, v57
    v_sub_f32 v58, v58, v38
    v_exp_f32 v58, v58
    v_smfmac_f32_32x32x32_bf16 a[0:15], v[128:131], v[48:55], v12
    s_waitcnt lgkmcnt(4)
    v_sub_f32 v59, v59, v38
    v_exp_f32 v59, v59
    v_sub_f32 v60, v60, v38
    v_exp_f32 v60, v60
    v_sub_f32 v61, v61, v38
    v_exp_f32 v61, v61
    v_smfmac_f32_16x16x64_bf16 a[96:99], v[20:23], v[48:55], v12
    ds_read_b64_tr_b16 v[138:139], v3 offset:2304
    v_sub_f32 v62, v62, v38
    v_exp_f32 v62, v62
    v_mfma_f32_4x4x4_16b_bf16 v[24:27], v[144:145], v[144:145], 0
    v_sub_f32 v63, v63, v38
    v_exp_f32 v63, v63
    v_mfma_f32_32x32x16_bf16 v[80:95], v[96:99], a[136:139], 4.0
    v_sub_f32 v64, v64, v39
    v_exp_f32 v64, v64
    v_sub_f32 v65, v65, v39
    v_exp_f32 v65, v65
    v_sub_f32 v66, v66, v39
    v_exp_f32 v66, v66
    v_mfma_f32_32x32x16_bf16 v[80:95], v[100:103], a[140:143], v[80:95]
    v_sub_f32 v67, v67, v39
    v_exp_f32 v67, v67
    v_sub_f32 v68, v68, v39
    v_exp_f32 v68, v68
    v_sub_f32 v69, v69, v39
    v_exp_f32 v69, v69
    v_smfmac_f32_32x32x32_bf16 a[0:15], v[132:135], v[56:63], v12
    v_sub_f32 v70, v70, v39
    v_exp_f32 v70, v70
    v_sub_f32 v71, v71, v39
    v_exp_f32 v71, v71
    v_sub_f32 v72, v72, v39
    v_exp_f32 v72, v72
    v_smfmac_f32_16x16x64_bf16 a[96:99], v[20:23], v[56:63], v12
    ds_read_b64_tr_b16 v[140:141], v3 offset:3072
    v_sub_f32 v73, v73, v39
    v_exp_f32 v73, v73
    v_mfma_f32_4x4x4_16b_bf16 v[24:27], v[146:147], v[146:147], v[24:27]
    v_sub_f32 v74, v74, v39
    v_exp_f32 v74, v74
    v_smfmac_f32_32x32x32_bf16 a[16:31], v[128:131], v[64:71], v12
    s_waitcnt lgkmcnt(5)
    v_sub_f32 v75, v75, v39
    v_exp_f32 v75, v75
    v_sub_f32 v76, v76, v39
    v_exp_f32 v76, v76
    v_sub_f32 v77, v77, v39
    v_exp_f32 v77, v77
    v_smfmac_f32_16x16x64_bf16 a[100:103], v[20:23], v[64:71], v12
    ds_read_b64_tr_b16 v[142:143], v3 offset:3328
    v_sub_f32 v78, v78, v39
    v_exp_f32 v78, v78
    v_mfma_f32_4x4x4_16b_bf16 v[24:27], v[148:149], v[148:149], v[24:27]
    v_sub_f32 v79, v79, v39
    v_exp_f32 v79, v79
    v_mfma_f32_32x32x16_bf16 v[48:63], v[96:99], a[144:147], 4.0
    v_sub_f32 v80, v80, v40
    v_exp_f32 v80, v80
    v_sub_f32 v81, v81, v40
    v_exp_f32 v81, v81
    v_sub_f32 v82, v82, v40
    v_exp_f32 v82, v82
    v_mfma_f32_32x32x16_bf16 v[48:63], v[100:103], a[148:151], v[48:63]
    v_sub_f32 v83, v83, v40
    v_exp_f32 v83, v83
    v_sub_f32 v84, v84, v40
    v_exp_f32 v84, v84
    v_sub_f32 v85, v85, v40
    v_exp_f32 v85, v85
    v_smfmac_f32_32x32x32_bf16 a[16:31], v[132:135], v[72:79], v12
    v_sub_f32 v86, v86, v40
    v_exp_f32 v86, v86
    v_sub_f32 v87, v87, v40
    v_exp_f32 v87, v87
    v_sub_f32 v88, v88, v40
    v_exp_f32 v88, v88
    v_smfmac_f32_16x16x64_bf16 a[100:103], v[20:23], v[72:79], v12
    ds_read_b64_tr_b16 v[160:161], v8 offset:8192
    v_sub_f32 v89, v89, v40
    v_exp_f32 v89, v89
    v_mfma_f32_4x4x4_16b_bf16 v[24:27], v[150:151], v[150:151], v[24:27]
    v_sub_f32 v90, v90, v40
    v_exp_f32 v90, v90
    v_smfmac_f32_32x32x32_bf16 a[32:47], v[128:131], v[80:87], v12
    s_waitcnt lgkmcnt(6)
    v_sub_f32 v91, v91, v40
    v_exp_f32 v91, v91
    v_sub_f32 v92, v92, v40
    v_exp_f32 v92, v92
    v_sub_f32 v93, v93, v40
    v_exp_f32 v93, v93
    v_smfmac_f32_16x16x64_bf16 a[104:107], v[20:23], v[80:87], v12
    ds_read_b64_tr_b16 v[162:163], v8 offset:8200
    v_sub_f32 v94, v94, v40
    v_exp_f32 v94, v94
    v_mfma_f32_4x4x4_16b_bf16 v[24:27], v[152:153], v[152:153], v[24:27]
    v_sub_f32 v95, v95, v40
    v_exp_f32 v95, v95
    v_mfma_f32_32x32x16_bf16 v[64:79], v[96:99], a[152:155], 4.0
    v_sub_f32 v48, v48, v41
    v_exp_f32 v48, v48
    v_sub_f32 v49, v49, v41
    v_exp_f32 v49, v49
    v_sub_f32 v50, v50, v41
    v_exp_f32 v50, v50
    v_mfma_f32_32x32x16_bf16 v[64:79], v[100:103], a[156:159], v[64:79]
    v_sub_f32 v51, v51, v41
    v_exp_f32 v51, v51
    v_sub_f32 v52, v52, v41
    v_exp_f32 v52, v52
    v_sub_f32 v53, v53, v41
    v_exp_f32 v53, v53
    v_smfmac_f32_32x32x32_bf16 a[32:47], v[132:135], v[88:95], v12
    v_sub_f32 v54, v54, v41
    v_exp_f32 v54, v54
    v_sub_f32 v55, v55, v41
    v_exp_f32 v55, v55
    v_sub_f32 v56, v56, v41
    v_exp_f32 v56, v56
    v_smfmac_f32_16x16x64_bf16 a[104:107], v[20:23], v[88:95], v12
    ds_read_b64_tr_b16 v[164:165], v9 offset:8192
    v_sub_f32 v57, v57, v41
    v_exp_f32 v57, v57
    v_mfma_f32_4x4x4_16b_bf16 v[24:27], v[154:155], v[154:155], v[24:27]
    v_sub_f32 v58, v58, v41
    v_exp_f32 v58, v58
    v_smfmac_f32_32x32x32_bf16 a[48:63], v[128:131], v[48:55], v12
    s_waitcnt lgkmcnt(7)
    v_sub_f32 v59, v59, v41
    v_exp_f32 v59, v59
    v_sub_f32 v60, v60, v41
    v_exp_f32 v60, v60
    v_sub_f32 v61, v61, v41
    v_exp_f32 v61, v61
    v_smfmac_f32_16x16x64_bf16 a[108:111], v[20:23], v[48:55], v12
    ds_read_b64_tr_b16 v[166:167], v9 offset:8200
    v_sub_f32 v62, v62, v41
    v_exp_f32 v62, v62
    v_mfma_f32_4x4x4_16b_bf16 v[24:27], v[156:157], v[156:157], v[24:27]
    v_sub_f32 v63, v63, v41
    v_exp_f32 v63, v63
    v_mfma_f32_32x32x16_bf16 v[80:95], v[96:99], a[160:163], 4.0
    v_sub_f32 v64, v64, v42
    v_exp_f32 v64, v64
    v_sub_f32 v65, v65, v42
    v_exp_f32 v65, v65
    v_sub_f32 v66, v66, v42
    v_exp_f32 v66, v66
    v_mfma_f32_32x32x16_bf16 v[80:95], v[100:103], a[164:167], v[80:95]
    v_sub_f32 v67, v67, v42
    v_exp_f32 v67, v67
    v_sub_f32 v68, v68, v42
    v_exp_f32 v68, v68
    v_sub_f32 v69, v69, v42
    v_exp_f32 v69, v69
    v_smfmac_f32_32x32x32_bf16 a[48:63], v[132:135], v[56:63], v12
    v_sub_f32 v70, v70, v42
    v_exp_f32 v70, v70
    v_sub_f32 v71, v71, v42
    v_exp_f32 v71, v71
    v_sub_f32 v72, v72, v42
    v_exp_f32 v72, v72
    v_smfmac_f32_16x16x64_bf16 a[108:111], v[20:23], v[56:63], v12
    ds_read_b64_tr_b16 v[168:169], v8 offset:10240
    v_sub_f32 v73, v73, v42
    v_exp_f32 v73, v73
    v_mfma_f32_4x4x4_16b_bf16 v[24:27], v[158:159], v[158:159], v[24:27]
    v_sub_f32 v74, v74, v42
    v_exp_f32 v74, v74
    v_smfmac_f32_32x32x32_bf16 a[64:79], v[128:131], v[64:71], v12
    v_sub_f32 v75, v75, v42
    v_exp_f32 v75, v75
    v_sub_f32 v76, v76, v42
    v_exp_f32 v76, v76
    v_sub_f32 v77, v77, v42
    v_exp_f32 v77, v77
    v_smfmac_f32_16x16x64_bf16 a[112:115], v[20:23], v[64:71], v12
    ds_read_b64_tr_b16 v[170:171], v8 offset:10248
    v_sub_f32 v78, v78, v42
    v_exp_f32 v78, v78
    v_sub_f32 v79, v79, v42
    v_exp_f32 v79, v79
    v_cndmask_b32 v28, v24, v25, s[40:41]
    v_mfma_f32_32x32x16_bf16 v[48:63], v[104:107], v[192:195], 4.0
    v_sub_f32 v80, v80, v43
    v_exp_f32 v80, v80
    v_sub_f32 v81, v81, v43
    v_exp_f32 v81, v81
    v_sub_f32 v82, v82, v43
    v_exp_f32 v82, v82
    v_cndmask_b32 v28, v28, v26, s[42:43]
    v_mfma_f32_32x32x16_bf16 v[48:63], v[108:111], v[196:199], v[48:63]
    s_waitcnt lgkmcnt(6)
    v_sub_f32 v83, v83, v43
    v_exp_f32 v83, v83
    v_sub_f32 v84, v84, v43
    v_exp_f32 v84, v84
    v_sub_f32 v85, v85, v43
    v_exp_f32 v85, v85
    v_cndmask_b32 v28, v28, v27, s[44:45]
    v_smfmac_f32_32x32x32_bf16 a[64:79], v[132:135], v[72:79], v12
    v_sub_f32 v86, v86, v43
    v_exp_f32 v86, v86
    v_sub_f32 v87, v87, v43
    v_exp_f32 v87, v87
    v_sub_f32 v88, v88, v43
    v_exp_f32 v88, v88
    v_sqrt_f32 v28, v28
    v_smfmac_f32_16x16x64_bf16 a[112:115], v[20:23], v[72:79], v12
    ds_read_b64_tr_b16 v[172:173], v9 offset:10240
    v_sub_f32 v89, v89, v43
    v_exp_f32 v89, v89
    v_sub_f32 v90, v90, v43
    v_exp_f32 v90, v90
    v_add_f32 v28, 0x358637bd, v28
    v_smfmac_f32_32x32x32_bf16 a[80:95], v[128:131], v[80:87], v12
    v_sub_f32 v91, v91, v43
    v_exp_f32 v91, v91
    v_sub_f32 v92, v92, v43
    v_exp_f32 v92, v92
    v_sub_f32 v93, v93, v43
    v_exp_f32 v93, v93
    v_rcp_f32 v28, v28
    v_smfmac_f32_16x16x64_bf16 a[116:119], v[20:23], v[80:87], v12
    ds_read_b64_tr_b16 v[174:175], v9 offset:10248
    v_sub_f32 v94, v94, v43
    v_exp_f32 v94, v94
    v_sub_f32 v95, v95, v43
    v_exp_f32 v95, v95
    v_cvt_pk_bf16_f32 v29, v28, v28
    v_cvt_pk_bf16_f32 v30, v28, v28
    v_mfma_f32_32x32x16_bf16 v[64:79], v[104:107], v[200:203], 4.0
    v_sub_f32 v48, v48, v36
    v_exp_f32 v48, v48
    v_sub_f32 v49, v49, v36
    v_exp_f32 v49, v49
    v_sub_f32 v50, v50, v36
    v_exp_f32 v50, v50
    v_permlane32_swap_b32 v29, v30
    v_mfma_f32_32x32x16_bf16 v[64:79], v[108:111], v[204:207], v[64:79]
    v_sub_f32 v51, v51, v36
    v_exp_f32 v51, v51
    v_sub_f32 v52, v52, v36
    v_exp_f32 v52, v52
    v_sub_f32 v53, v53, v36
    v_exp_f32 v53, v53
    v_and_b32 v32, v29, v10
    v_and_b32 v33, v29, v11
    v_smfmac_f32_32x32x32_bf16 a[80:95], v[132:135], v[88:95], v12
    v_sub_f32 v54, v54, v36
    v_exp_f32 v54, v54
    v_sub_f32 v55, v55, v36
    v_exp_f32 v55, v55
    v_sub_f32 v56, v56, v36
    v_exp_f32 v56, v56
    v_and_b32 v34, v30, v10
    v_and_b32 v35, v30, v11
    v_smfmac_f32_16x16x64_bf16 a[116:119], v[20:23], v[88:95], v12
    v_sub_f32 v57, v57, v36
    v_exp_f32 v57, v57
    v_sub_f32 v58, v58, v36
    v_exp_f32 v58, v58
    v_smfmac_f32_32x32x32_bf16 v[208:223], v[136:139], v[48:55], v12
    s_waitcnt lgkmcnt(4)
    v_sub_f32 v59, v59, v36
    v_exp_f32 v59, v59
    v_sub_f32 v60, v60, v36
    v_exp_f32 v60, v60
    v_sub_f32 v61, v61, v36
    v_exp_f32 v61, v61
    v_smfmac_f32_16x16x64_bf16 v[240:243], v[20:23], v[48:55], v12
    v_sub_f32 v62, v62, v36
    v_exp_f32 v62, v62
    v_mfma_f32_4x4x4_16b_bf16 v[176:179], v[160:161], v[32:33], 0
    v_sub_f32 v63, v63, v36
    v_exp_f32 v63, v63
    v_mfma_f32_32x32x16_bf16 v[80:95], v[104:107], a[120:123], 4.0
    v_sub_f32 v64, v64, v37
    v_exp_f32 v64, v64
    v_sub_f32 v65, v65, v37
    v_exp_f32 v65, v65
    v_sub_f32 v66, v66, v37
    v_exp_f32 v66, v66
    v_mfma_f32_32x32x16_bf16 v[80:95], v[108:111], a[124:127], v[80:95]
    v_sub_f32 v67, v67, v37
    v_exp_f32 v67, v67
    v_sub_f32 v68, v68, v37
    v_exp_f32 v68, v68
    v_sub_f32 v69, v69, v37
    v_exp_f32 v69, v69
    v_cvt_pk_bf16_f32 v112, v176, v177
    v_cvt_pk_bf16_f32 v113, v178, v179
    v_smfmac_f32_32x32x32_bf16 v[208:223], v[140:143], v[56:63], v12
    s_waitcnt vmcnt(10)
    v_sub_f32 v70, v70, v37
    v_exp_f32 v70, v70
    v_sub_f32 v71, v71, v37
    v_exp_f32 v71, v71
    v_sub_f32 v72, v72, v37
    v_exp_f32 v72, v72
    v_smfmac_f32_16x16x64_bf16 v[240:243], v[20:23], v[56:63], v12
    ds_read_b64_tr_b16 v[128:129], v3 offset:8192
    v_sub_f32 v73, v73, v37
    v_exp_f32 v73, v73
    v_mfma_f32_4x4x4_16b_bf16 v[180:183], v[162:163], v[32:33], 0
    v_sub_f32 v74, v74, v37
    v_exp_f32 v74, v74
    v_smfmac_f32_32x32x32_bf16 v[224:239], v[136:139], v[64:71], v12
    v_sub_f32 v75, v75, v37
    v_exp_f32 v75, v75
    v_sub_f32 v76, v76, v37
    v_exp_f32 v76, v76
    v_sub_f32 v77, v77, v37
    v_exp_f32 v77, v77
    v_smfmac_f32_16x16x64_bf16 v[244:247], v[20:23], v[64:71], v12
    ds_read_b64_tr_b16 v[130:131], v3 offset:8448
    v_sub_f32 v78, v78, v37
    v_exp_f32 v78, v78
    v_mfma_f32_4x4x4_16b_bf16 v[184:187], v[164:165], v[32:33], 0
    v_sub_f32 v79, v79, v37
    v_exp_f32 v79, v79
    v_cvt_pk_bf16_f32 v114, v180, v181
    v_cvt_pk_bf16_f32 v115, v182, v183
    v_mfma_f32_32x32x16_bf16 v[48:63], v[104:107], a[128:131], 4.0
    v_sub_f32 v80, v80, v38
    v_exp_f32 v80, v80
    v_sub_f32 v81, v81, v38
    v_exp_f32 v81, v81
    v_sub_f32 v82, v82, v38
    v_exp_f32 v82, v82
    v_mfma_f32_32x32x16_bf16 v[48:63], v[108:111], a[132:135], v[48:63]
    v_sub_f32 v83, v83, v38
    v_exp_f32 v83, v83
    v_sub_f32 v84, v84, v38
    v_exp_f32 v84, v84
    v_sub_f32 v85, v85, v38
    v_exp_f32 v85, v85
    v_cvt_pk_bf16_f32 v116, v184, v185
    v_cvt_pk_bf16_f32 v117, v186, v187
    v_smfmac_f32_32x32x32_bf16 v[224:239], v[140:143], v[72:79], v12
    v_sub_f32 v86, v86, v38
    v_exp_f32 v86, v86
    v_sub_f32 v87, v87, v38
    v_exp_f32 v87, v87
    v_sub_f32 v88, v88, v38
    v_exp_f32 v88, v88
    v_smfmac_f32_16x16x64_bf16 v[244:247], v[20:23], v[72:79], v12
    ds_read_b64_tr_b16 v[132:133], v3 offset:9216
    v_sub_f32 v89, v89, v38
    v_exp_f32 v89, v89
    v_mfma_f32_4x4x4_16b_bf16 v[188:191], v[166:167], v[32:33], 0
    v_sub_f32 v90, v90, v38
    v_exp_f32 v90, v90
    v_smfmac_f32_32x32x32_bf16 a[0:15], v[136:139], v[80:87], v12
    s_waitcnt lgkmcnt(3)
    v_sub_f32 v91, v91, v38
    v_exp_f32 v91, v91
    v_sub_f32 v92, v92, v38
    v_exp_f32 v92, v92
    v_sub_f32 v93, v93, v38
    v_exp_f32 v93, v93
    v_smfmac_f32_16x16x64_bf16 a[96:99], v[20:23], v[80:87], v12
    ds_read_b64_tr_b16 v[134:135], v3 offset:9472
    v_sub_f32 v94, v94, v38
    v_exp_f32 v94, v94
    v_mfma_f32_4x4x4_16b_bf16 v[176:179], v[168:169], v[34:35], 0
    v_sub_f32 v95, v95, v38
    v_exp_f32 v95, v95
    v_cvt_pk_bf16_f32 v118, v188, v189
    v_cvt_pk_bf16_f32 v119, v190, v191
    v_mfma_f32_32x32x16_bf16 v[64:79], v[104:107], a[136:139], 4.0
    s_add_u32 m0, s36, 24576
    v_sub_f32 v48, v48, v39
    v_exp_f32 v48, v48
    v_sub_f32 v49, v49, v39
    v_exp_f32 v49, v49
    v_sub_f32 v50, v50, v39
    v_exp_f32 v50, v50
    v_mfma_f32_32x32x16_bf16 v[64:79], v[108:111], a[140:143], v[64:79]
    s_add_u32 s48, s34, 28672
    v_sub_f32 v51, v51, v39
    v_exp_f32 v51, v51
    v_sub_f32 v52, v52, v39
    v_exp_f32 v52, v52
    v_sub_f32 v53, v53, v39
    v_exp_f32 v53, v53
    v_cvt_pk_bf16_f32 v120, v176, v177
    v_cvt_pk_bf16_f32 v121, v178, v179
    v_smfmac_f32_32x32x32_bf16 a[0:15], v[140:143], v[88:95], v12
    v_sub_f32 v54, v54, v39
    v_exp_f32 v54, v54
    v_sub_f32 v55, v55, v39
    v_exp_f32 v55, v55
    v_sub_f32 v56, v56, v39
    v_exp_f32 v56, v56
    v_smfmac_f32_16x16x64_bf16 a[96:99], v[20:23], v[88:95], v12
    buffer_load_dwordx4 v1, s[20:23], s48 offen lds
    v_sub_f32 v57, v57, v39
    v_exp_f32 v57, v57
    v_mfma_f32_4x4x4_16b_bf16 v[180:183], v[170:171], v[34:35], 0
    v_sub_f32 v58, v58, v39
    v_exp_f32 v58, v58
    v_smfmac_f32_32x32x32_bf16 a[16:31], v[136:139], v[48:55], v12
    v_sub_f32 v59, v59, v39
    v_exp_f32 v59, v59
    v_sub_f32 v60, v60, v39
    v_exp_f32 v60, v60
    v_sub_f32 v61, v61, v39
    v_exp_f32 v61, v61
    v_smfmac_f32_16x16x64_bf16 a[100:103], v[20:23], v[48:55], v12
    buffer_load_dwordx4 v1, s[20:23], s48 offen offset:1024 lds
    v_sub_f32 v62, v62, v39
    v_exp_f32 v62, v62
    v_mfma_f32_4x4x4_16b_bf16 v[184:187], v[172:173], v[34:35], 0
    v_sub_f32 v63, v63, v39
    v_exp_f32 v63, v63
    v_cvt_pk_bf16_f32 v122, v180, v181
    v_cvt_pk_bf16_f32 v123, v182, v183
    v_mfma_f32_32x32x16_bf16 v[80:95], v[104:107], a[144:147], 4.0
    v_sub_f32 v64, v64, v40
    v_exp_f32 v64, v64
    v_sub_f32 v65, v65, v40
    v_exp_f32 v65, v65
    v_sub_f32 v66, v66, v40
    v_exp_f32 v66, v66
    v_mfma_f32_32x32x16_bf16 v[80:95], v[108:111], a[148:151], v[80:95]
    v_sub_f32 v67, v67, v40
    v_exp_f32 v67, v67
    v_sub_f32 v68, v68, v40
    v_exp_f32 v68, v68
    v_sub_f32 v69, v69, v40
    v_exp_f32 v69, v69
    v_cvt_pk_bf16_f32 v124, v184, v185
    v_cvt_pk_bf16_f32 v125, v186, v187
    v_smfmac_f32_32x32x32_bf16 a[16:31], v[140:143], v[56:63], v12
    v_sub_f32 v70, v70, v40
    v_exp_f32 v70, v70
    v_sub_f32 v71, v71, v40
    v_exp_f32 v71, v71
    v_sub_f32 v72, v72, v40
    v_exp_f32 v72, v72
    v_smfmac_f32_16x16x64_bf16 a[100:103], v[20:23], v[56:63], v12
    buffer_load_dwordx4 v1, s[20:23], s48 offen offset:2048 lds
    v_sub_f32 v73, v73, v40
    v_exp_f32 v73, v73
    v_mfma_f32_4x4x4_16b_bf16 v[188:191], v[174:175], v[34:35], 0
    v_sub_f32 v74, v74, v40
    v_exp_f32 v74, v74
    v_smfmac_f32_32x32x32_bf16 a[32:47], v[136:139], v[64:71], v12
    v_sub_f32 v75, v75, v40
    v_exp_f32 v75, v75
    v_sub_f32 v76, v76, v40
    v_exp_f32 v76, v76
    v_sub_f32 v77, v77, v40
    v_exp_f32 v77, v77
    v_smfmac_f32_16x16x64_bf16 a[104:107], v[20:23], v[64:71], v12
    buffer_load_dwordx4 v1, s[20:23], s48 offen offset:3072 lds
    v_sub_f32 v78, v78, v40
    v_exp_f32 v78, v78
    v_sub_f32 v79, v79, v40
    v_exp_f32 v79, v79
    v_cvt_pk_bf16_f32 v126, v188, v189
    v_cvt_pk_bf16_f32 v127, v190, v191
    v_mfma_f32_32x32x16_bf16 v[48:63], v[104:107], a[152:155], 4.0
    s_add_u32 m0, s36, 28672
    v_sub_f32 v80, v80, v41
    v_exp_f32 v80, v80
    v_sub_f32 v81, v81, v41
    v_exp_f32 v81, v81
    v_sub_f32 v82, v82, v41
    v_exp_f32 v82, v82
    v_mfma_f32_32x32x16_bf16 v[48:63], v[108:111], a[156:159], v[48:63]
    s_add_u32 s48, s34, 28672
    v_sub_f32 v83, v83, v41
    v_exp_f32 v83, v83
    v_sub_f32 v84, v84, v41
    v_exp_f32 v84, v84
    v_sub_f32 v85, v85, v41
    v_exp_f32 v85, v85
    v_smfmac_f32_32x32x32_bf16 a[32:47], v[140:143], v[72:79], v12
    v_sub_f32 v86, v86, v41
    v_exp_f32 v86, v86
    v_sub_f32 v87, v87, v41
    v_exp_f32 v87, v87
    v_sub_f32 v88, v88, v41
    v_exp_f32 v88, v88
    v_smfmac_f32_16x16x64_bf16 a[104:107], v[20:23], v[72:79], v12
    buffer_load_dwordx4 v2, s[24:27], s48 offen lds
    v_sub_f32 v89, v89, v41
    v_exp_f32 v89, v89
    v_sub_f32 v90, v90, v41
    v_exp_f32 v90, v90
    v_smfmac_f32_32x32x32_bf16 a[48:63], v[136:139], v[80:87], v12
    v_sub_f32 v91, v91, v41
    v_exp_f32 v91, v91
    v_sub_f32 v92, v92, v41
    v_exp_f32 v92, v92
    v_sub_f32 v93, v93, v41
    v_exp_f32 v93, v93
    v_smfmac_f32_16x16x64_bf16 a[108:111], v[20:23], v[80:87], v12
    buffer_load_dwordx4 v2, s[24:27], s48 offen offset:1024 lds
    v_sub_f32 v94, v94, v41
    v_exp_f32 v94, v94
    v_sub_f32 v95, v95, v41
    v_exp_f32 v95, v95
    v_mfma_f32_32x32x16_bf16 v[64:79], v[104:107], a[160:163], 4.0
    v_sub_f32 v48, v48, v42
    v_exp_f32 v48, v48
    v_sub_f32 v49, v49, v42
    v_exp_f32 v49, v49
    v_sub_f32 v50, v50, v42
    v_exp_f32 v50, v50
    v_mfma_f32_32x32x16_bf16 v[64:79], v[108:111], a[164:167], v[64:79]
    v_sub_f32 v51, v51, v42
    v_exp_f32 v51, v51
    v_sub_f32 v52, v52, v42
    v_exp_f32 v52, v52
    v_sub_f32 v53, v53, v42
    v_exp_f32 v53, v53
    v_smfmac_f32_32x32x32_bf16 a[48:63], v[140:143], v[88:95], v12
    v_sub_f32 v54, v54, v42
    v_exp_f32 v54, v54
    v_sub_f32 v55, v55, v42
    v_exp_f32 v55, v55
    v_sub_f32 v56, v56, v42
    v_exp_f32 v56, v56
    v_smfmac_f32_16x16x64_bf16 a[108:111], v[20:23], v[88:95], v12
    buffer_load_dwordx4 v2, s[24:27], s48 offen offset:2048 lds
    v_sub_f32 v57, v57, v42
    v_exp_f32 v57, v57
    v_sub_f32 v58, v58, v42
    v_exp_f32 v58, v58
    v_smfmac_f32_32x32x32_bf16 a[64:79], v[136:139], v[48:55], v12
    v_sub_f32 v59, v59, v42
    v_exp_f32 v59, v59
    v_sub_f32 v60, v60, v42
    v_exp_f32 v60, v60
    v_sub_f32 v61, v61, v42
    v_exp_f32 v61, v61
    v_smfmac_f32_16x16x64_bf16 a[112:115], v[20:23], v[48:55], v12
    buffer_load_dwordx4 v2, s[24:27], s48 offen offset:3072 lds
    v_sub_f32 v62, v62, v42
    v_exp_f32 v62, v62
    v_sub_f32 v63, v63, v42
    v_exp_f32 v63, v63
    v_mfma_f32_32x32x16_bf16 v[80:95], v[112:115], v[192:195], 4.0
    v_sub_f32 v64, v64, v43
    v_exp_f32 v64, v64
    v_sub_f32 v65, v65, v43
    v_exp_f32 v65, v65
    v_sub_f32 v66, v66, v43
    v_exp_f32 v66, v66
    v_mfma_f32_32x32x16_bf16 v[80:95], v[116:119], v[196:199], v[80:95]
    v_sub_f32 v67, v67, v43
    v_exp_f32 v67, v67
    v_sub_f32 v68, v68, v43
    v_exp_f32 v68, v68
    v_sub_f32 v69, v69, v43
    v_exp_f32 v69, v69
    v_smfmac_f32_32x32x32_bf16 a[64:79], v[140:143], v[56:63], v12
    v_sub_f32 v70, v70, v43
    v_exp_f32 v70, v70
    v_sub_f32 v71, v71, v43
    v_exp_f32 v71, v71
    v_sub_f32 v72, v72, v43
    v_exp_f32 v72, v72
    v_smfmac_f32_16x16x64_bf16 a[112:115], v[20:23], v[56:63], v12
    v_sub_f32 v73, v73, v43
    v_exp_f32 v73, v73
    v_sub_f32 v74, v74, v43
    v_exp_f32 v74, v74
    v_smfmac_f32_32x32x32_bf16 a[80:95], v[136:139], v[64:71], v12
    s_waitcnt lgkmcnt(0)
    v_sub_f32 v75, v75, v43
    v_exp_f32 v75, v75
    v_sub_f32 v76, v76, v43
    v_exp_f32 v76, v76
    v_sub_f32 v77, v77, v43
    v_exp_f32 v77, v77
    v_smfmac_f32_16x16x64_bf16 a[116:119], v[20:23], v[64:71], v12
    v_sub_f32 v78, v78, v43
    v_exp_f32 v78, v78
    v_sub_f32 v79, v79, v43
    v_exp_f32 v79, v79
    v_mfma_f32_32x32x16_bf16 v[48:63], v[112:115], v[200:203], 4.0
    v_sub_f32 v80, v80, v36
    v_exp_f32 v80, v80
    v_sub_f32 v81, v81, v36
    v_exp_f32 v81, v81
    v_sub_f32 v82, v82, v36
    v_exp_f32 v82, v82
    v_mfma_f32_32x32x16_bf16 v[48:63], v[116:119], v[204:207], v[48:63]
    v_sub_f32 v83, v83, v36
    v_exp_f32 v83, v83
    v_sub_f32 v84, v84, v36
    v_exp_f32 v84, v84
    v_sub_f32 v85, v85, v36
    v_exp_f32 v85, v85
    v_smfmac_f32_32x32x32_bf16 a[80:95], v[140:143], v[72:79], v12
    s_waitcnt vmcnt(12)
    v_sub_f32 v86, v86, v36
    v_exp_f32 v86, v86
    v_sub_f32 v87, v87, v36
    v_exp_f32 v87, v87
    v_sub_f32 v88, v88, v36
    v_exp_f32 v88, v88
    v_smfmac_f32_16x16x64_bf16 a[116:119], v[20:23], v[72:79], v12
    ds_read_b128 v[144:147], v4 offset:16384
    v_sub_f32 v89, v89, v36
    v_exp_f32 v89, v89
    v_sub_f32 v90, v90, v36
    v_exp_f32 v90, v90
    v_smfmac_f32_32x32x32_bf16 v[208:223], v[128:131], v[80:87], v12
    v_sub_f32 v91, v91, v36
    v_exp_f32 v91, v91
    v_sub_f32 v92, v92, v36
    v_exp_f32 v92, v92
    v_sub_f32 v93, v93, v36
    v_exp_f32 v93, v93
    v_smfmac_f32_16x16x64_bf16 v[240:243], v[20:23], v[80:87], v12
    ds_read_b128 v[148:151], v5 offset:16384
    v_sub_f32 v94, v94, v36
    v_exp_f32 v94, v94
    v_sub_f32 v95, v95, v36
    v_exp_f32 v95, v95
    v_mfma_f32_32x32x16_bf16 v[64:79], v[112:115], a[120:123], 4.0
    v_sub_f32 v48, v48, v37
    v_exp_f32 v48, v48
    v_sub_f32 v49, v49, v37
    v_exp_f32 v49, v49
    v_sub_f32 v50, v50, v37
    v_exp_f32 v50, v50
    v_mfma_f32_32x32x16_bf16 v[64:79], v[116:119], a[124:127], v[64:79]
    v_sub_f32 v51, v51, v37
    v_exp_f32 v51, v51
    v_sub_f32 v52, v52, v37
    v_exp_f32 v52, v52
    v_sub_f32 v53, v53, v37
    v_exp_f32 v53, v53
    v_smfmac_f32_32x32x32_bf16 v[208:223], v[132:135], v[88:95], v12
    v_sub_f32 v54, v54, v37
    v_exp_f32 v54, v54
    v_sub_f32 v55, v55, v37
    v_exp_f32 v55, v55
    v_sub_f32 v56, v56, v37
    v_exp_f32 v56, v56
    v_smfmac_f32_16x16x64_bf16 v[240:243], v[20:23], v[88:95], v12
    ds_read_b128 v[152:155], v6 offset:16384
    v_sub_f32 v57, v57, v37
    v_exp_f32 v57, v57
    v_sub_f32 v58, v58, v37
    v_exp_f32 v58, v58
    v_smfmac_f32_32x32x32_bf16 v[224:239], v[128:131], v[48:55], v12
    v_sub_f32 v59, v59, v37
    v_exp_f32 v59, v59
    v_sub_f32 v60, v60, v37
    v_exp_f32 v60, v60
    v_sub_f32 v61, v61, v37
    v_exp_f32 v61, v61
    v_smfmac_f32_16x16x64_bf16 v[244:247], v[20:23], v[48:55], v12
    ds_read_b128 v[156:159], v7 offset:16384
    v_sub_f32 v62, v62, v37
    v_exp_f32 v62, v62
    v_sub_f32 v63, v63, v37
    v_exp_f32 v63, v63
    v_mfma_f32_32x32x16_bf16 v[80:95], v[112:115], a[128:131], 4.0
    v_sub_f32 v64, v64, v38
    v_exp_f32 v64, v64
    v_sub_f32 v65, v65, v38
    v_exp_f32 v65, v65
    v_sub_f32 v66, v66, v38
    v_exp_f32 v66, v66
    v_mfma_f32_32x32x16_bf16 v[80:95], v[116:119], a[132:135], v[80:95]
    v_sub_f32 v67, v67, v38
    v_exp_f32 v67, v67
    v_sub_f32 v68, v68, v38
    v_exp_f32 v68, v68
    v_sub_f32 v69, v69, v38
    v_exp_f32 v69, v69
    v_smfmac_f32_32x32x32_bf16 v[224:239], v[132:135], v[56:63], v12
    v_sub_f32 v70, v70, v38
    v_exp_f32 v70, v70
    v_sub_f32 v71, v71, v38
    v_exp_f32 v71, v71
    v_sub_f32 v72, v72, v38
    v_exp_f32 v72, v72
    v_smfmac_f32_16x16x64_bf16 v[244:247], v[20:23], v[56:63], v12
    ds_read_b64_tr_b16 v[136:137], v3 offset:10240
    v_sub_f32 v73, v73, v38
    v_exp_f32 v73, v73
    v_sub_f32 v74, v74, v38
    v_exp_f32 v74, v74
    v_smfmac_f32_32x32x32_bf16 a[0:15], v[128:131], v[64:71], v12
    s_waitcnt lgkmcnt(4)
    v_sub_f32 v75, v75, v38
    v_exp_f32 v75, v75
    v_sub_f32 v76, v76, v38
    v_exp_f32 v76, v76
    v_sub_f32 v77, v77, v38
    v_exp_f32 v77, v77
    v_smfmac_f32_16x16x64_bf16 a[96:99], v[20:23], v[64:71], v12
    ds_read_b64_tr_b16 v[138:139], v3 offset:10496
    v_sub_f32 v78, v78, v38
    v_exp_f32 v78, v78
    v_mfma_f32_4x4x4_16b_bf16 v[24:27], v[144:145], v[144:145], 0
    v_sub_f32 v79, v79, v38
    v_exp_f32 v79, v79
    v_mfma_f32_32x32x16_bf16 v[48:63], v[112:115], a[136:139], 4.0
    v_sub_f32 v80, v80, v39
    v_exp_f32 v80, v80
    v_sub_f32 v81, v81, v39
    v_exp_f32 v81, v81
    v_sub_f32 v82, v82, v39
    v_exp_f32 v82, v82
    v_mfma_f32_32x32x16_bf16 v[48:63], v[116:119], a[140:143], v[48:63]
    v_sub_f32 v83, v83, v39
    v_exp_f32 v83, v83
    v_sub_f32 v84, v84, v39
    v_exp_f32 v84, v84
    v_sub_f32 v85, v85, v39
    v_exp_f32 v85, v85
    v_smfmac_f32_32x32x32_bf16 a[0:15], v[132:135], v[72:79], v12
    v_sub_f32 v86, v86, v39
    v_exp_f32 v86, v86
    v_sub_f32 v87, v87, v39
    v_exp_f32 v87, v87
    v_sub_f32 v88, v88, v39
    v_exp_f32 v88, v88
    v_smfmac_f32_16x16x64_bf16 a[96:99], v[20:23], v[72:79], v12
    ds_read_b64_tr_b16 v[140:141], v3 offset:11264
    v_sub_f32 v89, v89, v39
    v_exp_f32 v89, v89
    v_mfma_f32_4x4x4_16b_bf16 v[24:27], v[146:147], v[146:147], v[24:27]
    v_sub_f32 v90, v90, v39
    v_exp_f32 v90, v90
    v_smfmac_f32_32x32x32_bf16 a[16:31], v[128:131], v[80:87], v12
    s_waitcnt lgkmcnt(5)
    v_sub_f32 v91, v91, v39
    v_exp_f32 v91, v91
    v_sub_f32 v92, v92, v39
    v_exp_f32 v92, v92
    v_sub_f32 v93, v93, v39
    v_exp_f32 v93, v93
    v_smfmac_f32_16x16x64_bf16 a[100:103], v[20:23], v[80:87], v12
    ds_read_b64_tr_b16 v[142:143], v3 offset:11520
    v_sub_f32 v94, v94, v39
    v_exp_f32 v94, v94
    v_mfma_f32_4x4x4_16b_bf16 v[24:27], v[148:149], v[148:149], v[24:27]
    v_sub_f32 v95, v95, v39
    v_exp_f32 v95, v95
    v_mfma_f32_32x32x16_bf16 v[64:79], v[112:115], a[144:147], 4.0
    v_sub_f32 v48, v48, v40
    v_exp_f32 v48, v48
    v_sub_f32 v49, v49, v40
    v_exp_f32 v49, v49
    v_sub_f32 v50, v50, v40
    v_exp_f32 v50, v50
    v_mfma_f32_32x32x16_bf16 v[64:79], v[116:119], a[148:151], v[64:79]
    v_sub_f32 v51, v51, v40
    v_exp_f32 v51, v51
    v_sub_f32 v52, v52, v40
    v_exp_f32 v52, v52
    v_sub_f32 v53, v53, v40
    v_exp_f32 v53, v53
    v_smfmac_f32_32x32x32_bf16 a[16:31], v[132:135], v[88:95], v12
    v_sub_f32 v54, v54, v40
    v_exp_f32 v54, v54
    v_sub_f32 v55, v55, v40
    v_exp_f32 v55, v55
    v_sub_f32 v56, v56, v40
    v_exp_f32 v56, v56
    v_smfmac_f32_16x16x64_bf16 a[100:103], v[20:23], v[88:95], v12
    ds_read_b64_tr_b16 v[160:161], v8 offset:16384
    v_sub_f32 v57, v57, v40
    v_exp_f32 v57, v57
    v_mfma_f32_4x4x4_16b_bf16 v[24:27], v[150:151], v[150:151], v[24:27]
    v_sub_f32 v58, v58, v40
    v_exp_f32 v58, v58
    v_smfmac_f32_32x32x32_bf16 a[32:47], v[128:131], v[48:55], v12
    s_waitcnt lgkmcnt(6)
    v_sub_f32 v59, v59, v40
    v_exp_f32 v59, v59
    v_sub_f32 v60, v60, v40
    v_exp_f32 v60, v60
    v_sub_f32 v61, v61, v40
    v_exp_f32 v61, v61
    v_smfmac_f32_16x16x64_bf16 a[104:107], v[20:23], v[48:55], v12
    ds_read_b64_tr_b16 v[162:163], v8 offset:16392
    v_sub_f32 v62, v62, v40
    v_exp_f32 v62, v62
    v_mfma_f32_4x4x4_16b_bf16 v[24:27], v[152:153], v[152:153], v[24:27]
    v_sub_f32 v63, v63, v40
    v_exp_f32 v63, v63
    v_mfma_f32_32x32x16_bf16 v[80:95], v[112:115], a[152:155], 4.0
    v_sub_f32 v64, v64, v41
    v_exp_f32 v64, v64
    v_sub_f32 v65, v65, v41
    v_exp_f32 v65, v65
    v_sub_f32 v66, v66, v41
    v_exp_f32 v66, v66
    v_mfma_f32_32x32x16_bf16 v[80:95], v[116:119], a[156:159], v[80:95]
    v_sub_f32 v67, v67, v41
    v_exp_f32 v67, v67
    v_sub_f32 v68, v68, v41
    v_exp_f32 v68, v68
    v_sub_f32 v69, v69, v41
    v_exp_f32 v69, v69
    v_smfmac_f32_32x32x32_bf16 a[32:47], v[132:135], v[56:63], v12
    v_sub_f32 v70, v70, v41
    v_exp_f32 v70, v70
    v_sub_f32 v71, v71, v41
    v_exp_f32 v71, v71
    v_sub_f32 v72, v72, v41
    v_exp_f32 v72, v72
    v_smfmac_f32_16x16x64_bf16 a[104:107], v[20:23], v[56:63], v12
    ds_read_b64_tr_b16 v[164:165], v9 offset:16384
    v_sub_f32 v73, v73, v41
    v_exp_f32 v73, v73
    v_mfma_f32_4x4x4_16b_bf16 v[24:27], v[154:155], v[154:155], v[24:27]
    v_sub_f32 v74, v74, v41
    v_exp_f32 v74, v74
    v_smfmac_f32_32x32x32_bf16 a[48:63], v[128:131], v[64:71], v12
    s_waitcnt lgkmcnt(7)
    v_sub_f32 v75, v75, v41
    v_exp_f32 v75, v75
    v_sub_f32 v76, v76, v41
    v_exp_f32 v76, v76
    v_sub_f32 v77, v77, v41
    v_exp_f32 v77, v77
    v_smfmac_f32_16x16x64_bf16 a[108:111], v[20:23], v[64:71], v12
    ds_read_b64_tr_b16 v[166:167], v9 offset:16392
    v_sub_f32 v78, v78, v41
    v_exp_f32 v78, v78
    v_mfma_f32_4x4x4_16b_bf16 v[24:27], v[156:157], v[156:157], v[24:27]
    v_sub_f32 v79, v79, v41
    v_exp_f32 v79, v79
    v_mfma_f32_32x32x16_bf16 v[48:63], v[112:115], a[160:163], 4.0
    v_sub_f32 v80, v80, v42
    v_exp_f32 v80, v80
    v_sub_f32 v81, v81, v42
    v_exp_f32 v81, v81
    v_sub_f32 v82, v82, v42
    v_exp_f32 v82, v82
    v_mfma_f32_32x32x16_bf16 v[48:63], v[116:119], a[164:167], v[48:63]
    v_sub_f32 v83, v83, v42
    v_exp_f32 v83, v83
    v_sub_f32 v84, v84, v42
    v_exp_f32 v84, v84
    v_sub_f32 v85, v85, v42
    v_exp_f32 v85, v85
    v_smfmac_f32_32x32x32_bf16 a[48:63], v[132:135], v[72:79], v12
    v_sub_f32 v86, v86, v42
    v_exp_f32 v86, v86
    v_sub_f32 v87, v87, v42
    v_exp_f32 v87, v87
    v_sub_f32 v88, v88, v42
    v_exp_f32 v88, v88
    v_smfmac_f32_16x16x64_bf16 a[108:111], v[20:23], v[72:79], v12
    ds_read_b64_tr_b16 v[168:169], v8 offset:18432
    v_sub_f32 v89, v89, v42
    v_exp_f32 v89, v89
    v_mfma_f32_4x4x4_16b_bf16 v[24:27], v[158:159], v[158:159], v[24:27]
    v_sub_f32 v90, v90, v42
    v_exp_f32 v90, v90
    v_smfmac_f32_32x32x32_bf16 a[64:79], v[128:131], v[80:87], v12
    v_sub_f32 v91, v91, v42
    v_exp_f32 v91, v91
    v_sub_f32 v92, v92, v42
    v_exp_f32 v92, v92
    v_sub_f32 v93, v93, v42
    v_exp_f32 v93, v93
    v_smfmac_f32_16x16x64_bf16 a[112:115], v[20:23], v[80:87], v12
    ds_read_b64_tr_b16 v[170:171], v8 offset:18440
    v_sub_f32 v94, v94, v42
    v_exp_f32 v94, v94
    v_sub_f32 v95, v95, v42
    v_exp_f32 v95, v95
    v_cndmask_b32 v28, v24, v25, s[40:41]
    v_mfma_f32_32x32x16_bf16 v[64:79], v[120:123], v[192:195], 4.0
    v_sub_f32 v48, v48, v43
    v_exp_f32 v48, v48
    v_sub_f32 v49, v49, v43
    v_exp_f32 v49, v49
    v_sub_f32 v50, v50, v43
    v_exp_f32 v50, v50
    v_cndmask_b32 v28, v28, v26, s[42:43]
    v_mfma_f32_32x32x16_bf16 v[64:79], v[124:127], v[196:199], v[64:79]
    s_waitcnt lgkmcnt(6)
    v_sub_f32 v51, v51, v43
    v_exp_f32 v51, v51
    v_sub_f32 v52, v52, v43
    v_exp_f32 v52, v52
    v_sub_f32 v53, v53, v43
    v_exp_f32 v53, v53
    v_cndmask_b32 v28, v28, v27, s[44:45]
    v_smfmac_f32_32x32x32_bf16 a[64:79], v[132:135], v[88:95], v12
    v_sub_f32 v54, v54, v43
    v_exp_f32 v54, v54
    v_sub_f32 v55, v55, v43
    v_exp_f32 v55, v55
    v_sub_f32 v56, v56, v43
    v_exp_f32 v56, v56
    v_sqrt_f32 v28, v28
    v_smfmac_f32_16x16x64_bf16 a[112:115], v[20:23], v[88:95], v12
    ds_read_b64_tr_b16 v[172:173], v9 offset:18432
    v_sub_f32 v57, v57, v43
    v_exp_f32 v57, v57
    v_sub_f32 v58, v58, v43
    v_exp_f32 v58, v58
    v_add_f32 v28, 0x358637bd, v28
    v_smfmac_f32_32x32x32_bf16 a[80:95], v[128:131], v[48:55], v12
    v_sub_f32 v59, v59, v43
    v_exp_f32 v59, v59
    v_sub_f32 v60, v60, v43
    v_exp_f32 v60, v60
    v_sub_f32 v61, v61, v43
    v_exp_f32 v61, v61
    v_rcp_f32 v28, v28
    v_smfmac_f32_16x16x64_bf16 a[116:119], v[20:23], v[48:55], v12
    ds_read_b64_tr_b16 v[174:175], v9 offset:18440
    v_sub_f32 v62, v62, v43
    v_exp_f32 v62, v62
    v_sub_f32 v63, v63, v43
    v_exp_f32 v63, v63
    v_cvt_pk_bf16_f32 v29, v28, v28
    v_cvt_pk_bf16_f32 v30, v28, v28
    v_mfma_f32_32x32x16_bf16 v[80:95], v[120:123], v[200:203], 4.0
    v_sub_f32 v64, v64, v36
    v_exp_f32 v64, v64
    v_sub_f32 v65, v65, v36
    v_exp_f32 v65, v65
    v_sub_f32 v66, v66, v36
    v_exp_f32 v66, v66
    v_permlane32_swap_b32 v29, v30
    v_mfma_f32_32x32x16_bf16 v[80:95], v[124:127], v[204:207], v[80:95]
    v_sub_f32 v67, v67, v36
    v_exp_f32 v67, v67
    v_sub_f32 v68, v68, v36
    v_exp_f32 v68, v68
    v_sub_f32 v69, v69, v36
    v_exp_f32 v69, v69
    v_and_b32 v32, v29, v10
    v_and_b32 v33, v29, v11
    v_smfmac_f32_32x32x32_bf16 a[80:95], v[132:135], v[56:63], v12
    v_sub_f32 v70, v70, v36
    v_exp_f32 v70, v70
    v_sub_f32 v71, v71, v36
    v_exp_f32 v71, v71
    v_sub_f32 v72, v72, v36
    v_exp_f32 v72, v72
    v_and_b32 v34, v30, v10
    v_and_b32 v35, v30, v11
    v_smfmac_f32_16x16x64_bf16 a[116:119], v[20:23], v[56:63], v12
    v_sub_f32 v73, v73, v36
    v_exp_f32 v73, v73
    v_sub_f32 v74, v74, v36
    v_exp_f32 v74, v74
    v_smfmac_f32_32x32x32_bf16 v[208:223], v[136:139], v[64:71], v12
    s_waitcnt lgkmcnt(4)
    v_sub_f32 v75, v75, v36
    v_exp_f32 v75, v75
    v_sub_f32 v76, v76, v36
    v_exp_f32 v76, v76
    v_sub_f32 v77, v77, v36
    v_exp_f32 v77, v77
    v_smfmac_f32_16x16x64_bf16 v[240:243], v[20:23], v[64:71], v12
    v_sub_f32 v78, v78, v36
    v_exp_f32 v78, v78
    v_mfma_f32_4x4x4_16b_bf16 v[176:179], v[160:161], v[32:33], 0
    v_sub_f32 v79, v79, v36
    v_exp_f32 v79, v79
    v_mfma_f32_32x32x16_bf16 v[48:63], v[120:123], a[120:123], 4.0
    v_sub_f32 v80, v80, v37
    v_exp_f32 v80, v80
    v_sub_f32 v81, v81, v37
    v_exp_f32 v81, v81
    v_sub_f32 v82, v82, v37
    v_exp_f32 v82, v82
    v_mfma_f32_32x32x16_bf16 v[48:63], v[124:127], a[124:127], v[48:63]
    v_sub_f32 v83, v83, v37
    v_exp_f32 v83, v83
    v_sub_f32 v84, v84, v37
    v_exp_f32 v84, v84
    v_sub_f32 v85, v85, v37
    v_exp_f32 v85, v85
    v_cvt_pk_bf16_f32 v96, v176, v177
    v_cvt_pk_bf16_f32 v97, v178, v179
    v_smfmac_f32_32x32x32_bf16 v[208:223], v[140:143], v[72:79], v12
    s_waitcnt vmcnt(10)
    v_sub_f32 v86, v86, v37
    v_exp_f32 v86, v86
    v_sub_f32 v87, v87, v37
    v_exp_f32 v87, v87
    v_sub_f32 v88, v88, v37
    v_exp_f32 v88, v88
    v_smfmac_f32_16x16x64_bf16 v[240:243], v[20:23], v[72:79], v12
    ds_read_b64_tr_b16 v[128:129], v3 offset:16384
    v_sub_f32 v89, v89, v37
    v_exp_f32 v89, v89
    v_mfma_f32_4x4x4_16b_bf16 v[180:183], v[162:163], v[32:33], 0
    v_sub_f32 v90, v90, v37
    v_exp_f32 v90, v90
    v_smfmac_f32_32x32x32_bf16 v[224:239], v[136:139], v[80:87], v12
    v_sub_f32 v91, v91, v37
    v_exp_f32 v91, v91
    v_sub_f32 v92, v92, v37
    v_exp_f32 v92, v92
    v_sub_f32 v93, v93, v37
    v_exp_f32 v93, v93
    v_smfmac_f32_16x16x64_bf16 v[244:247], v[20:23], v[80:87], v12
    ds_read_b64_tr_b16 v[130:131], v3 offset:16640
    v_sub_f32 v94, v94, v37
    v_exp_f32 v94, v94
    v_mfma_f32_4x4x4_16b_bf16 v[184:187], v[164:165], v[32:33], 0
    v_sub_f32 v95, v95, v37
    v_exp_f32 v95, v95
    v_cvt_pk_bf16_f32 v98, v180, v181
    v_cvt_pk_bf16_f32 v99, v182, v183
    v_mfma_f32_32x32x16_bf16 v[64:79], v[120:123], a[128:131], 4.0
    v_sub_f32 v48, v48, v38
    v_exp_f32 v48, v48
    v_sub_f32 v49, v49, v38
    v_exp_f32 v49, v49
    v_sub_f32 v50, v50, v38
    v_exp_f32 v50, v50
    v_mfma_f32_32x32x16_bf16 v[64:79], v[124:127], a[132:135], v[64:79]
    v_sub_f32 v51, v51, v38
    v_exp_f32 v51, v51
    v_sub_f32 v52, v52, v38
    v_exp_f32 v52, v52
    v_sub_f32 v53, v53, v38
    v_exp_f32 v53, v53
    v_cvt_pk_bf16_f32 v100, v184, v185
    v_cvt_pk_bf16_f32 v101, v186, v187
    v_smfmac_f32_32x32x32_bf16 v[224:239], v[140:143], v[88:95], v12
    v_sub_f32 v54, v54, v38
    v_exp_f32 v54, v54
    v_sub_f32 v55, v55, v38
    v_exp_f32 v55, v55
    v_sub_f32 v56, v56, v38
    v_exp_f32 v56, v56
    v_smfmac_f32_16x16x64_bf16 v[244:247], v[20:23], v[88:95], v12
    ds_read_b64_tr_b16 v[132:133], v3 offset:17408
    v_sub_f32 v57, v57, v38
    v_exp_f32 v57, v57
    v_mfma_f32_4x4x4_16b_bf16 v[188:191], v[166:167], v[32:33], 0
    v_sub_f32 v58, v58, v38
    v_exp_f32 v58, v58
    v_smfmac_f32_32x32x32_bf16 a[0:15], v[136:139], v[48:55], v12
    s_waitcnt lgkmcnt(3)
    v_sub_f32 v59, v59, v38
    v_exp_f32 v59, v59
    v_sub_f32 v60, v60, v38
    v_exp_f32 v60, v60
    v_sub_f32 v61, v61, v38
    v_exp_f32 v61, v61
    v_smfmac_f32_16x16x64_bf16 a[96:99], v[20:23], v[48:55], v12
    ds_read_b64_tr_b16 v[134:135], v3 offset:17664
    v_sub_f32 v62, v62, v38
    v_exp_f32 v62, v62
    v_mfma_f32_4x4x4_16b_bf16 v[176:179], v[168:169], v[34:35], 0
    v_sub_f32 v63, v63, v38
    v_exp_f32 v63, v63
    v_cvt_pk_bf16_f32 v102, v188, v189
    v_cvt_pk_bf16_f32 v103, v190, v191
    v_mfma_f32_32x32x16_bf16 v[80:95], v[120:123], a[136:139], 4.0
    v_sub_f32 v64, v64, v39
    v_exp_f32 v64, v64
    v_sub_f32 v65, v65, v39
    v_exp_f32 v65, v65
    v_sub_f32 v66, v66, v39
    v_exp_f32 v66, v66
    v_mfma_f32_32x32x16_bf16 v[80:95], v[124:127], a[140:143], v[80:95]
    v_sub_f32 v67, v67, v39
    v_exp_f32 v67, v67
    v_sub_f32 v68, v68, v39
    v_exp_f32 v68, v68
    v_sub_f32 v69, v69, v39
    v_exp_f32 v69, v69
    v_cvt_pk_bf16_f32 v104, v176, v177
    v_cvt_pk_bf16_f32 v105, v178, v179
    v_smfmac_f32_32x32x32_bf16 a[0:15], v[140:143], v[56:63], v12
    v_sub_f32 v70, v70, v39
    v_exp_f32 v70, v70
    v_sub_f32 v71, v71, v39
    v_exp_f32 v71, v71
    v_sub_f32 v72, v72, v39
    v_exp_f32 v72, v72
    v_smfmac_f32_16x16x64_bf16 a[96:99], v[20:23], v[56:63], v12
    v_sub_f32 v73, v73, v39
    v_exp_f32 v73, v73
    v_mfma_f32_4x4x4_16b_bf16 v[180:183], v[170:171], v[34:35], 0
    v_sub_f32 v74, v74, v39
    v_exp_f32 v74, v74
    v_smfmac_f32_32x32x32_bf16 a[16:31], v[136:139], v[64:71], v12
    v_sub_f32 v75, v75, v39
    v_exp_f32 v75, v75
    v_sub_f32 v76, v76, v39
    v_exp_f32 v76, v76
    v_sub_f32 v77, v77, v39
    v_exp_f32 v77, v77
    v_smfmac_f32_16x16x64_bf16 a[100:103], v[20:23], v[64:71], v12
    v_sub_f32 v78, v78, v39
    v_exp_f32 v78, v78
    v_mfma_f32_4x4x4_16b_bf16 v[184:187], v[172:173], v[34:35], 0
    v_sub_f32 v79, v79, v39
    v_exp_f32 v79, v79
    v_cvt_pk_bf16_f32 v106, v180, v181
    v_cvt_pk_bf16_f32 v107, v182, v183
    v_mfma_f32_32x32x16_bf16 v[48:63], v[120:123], a[144:147], 4.0
    v_sub_f32 v80, v80, v40
    v_exp_f32 v80, v80
    v_sub_f32 v81, v81, v40
    v_exp_f32 v81, v81
    v_sub_f32 v82, v82, v40
    v_exp_f32 v82, v82
    v_mfma_f32_32x32x16_bf16 v[48:63], v[124:127], a[148:151], v[48:63]
    v_sub_f32 v83, v83, v40
    v_exp_f32 v83, v83
    v_sub_f32 v84, v84, v40
    v_exp_f32 v84, v84
    v_sub_f32 v85, v85, v40
    v_exp_f32 v85, v85
    v_cvt_pk_bf16_f32 v108, v184, v185
    v_cvt_pk_bf16_f32 v109, v186, v187
    v_smfmac_f32_32x32x32_bf16 a[16:31], v[140:143], v[72:79], v12
    v_sub_f32 v86, v86, v40
    v_exp_f32 v86, v86
    v_sub_f32 v87, v87, v40
    v_exp_f32 v87, v87
    v_sub_f32 v88, v88, v40
    v_exp_f32 v88, v88
    v_smfmac_f32_16x16x64_bf16 a[100:103], v[20:23], v[72:79], v12
    v_sub_f32 v89, v89, v40
    v_exp_f32 v89, v89
    v_mfma_f32_4x4x4_16b_bf16 v[188:191], v[174:175], v[34:35], 0
    v_sub_f32 v90, v90, v40
    v_exp_f32 v90, v90
    v_smfmac_f32_32x32x32_bf16 a[32:47], v[136:139], v[80:87], v12
    v_sub_f32 v91, v91, v40
    v_exp_f32 v91, v91
    v_sub_f32 v92, v92, v40
    v_exp_f32 v92, v92
    v_sub_f32 v93, v93, v40
    v_exp_f32 v93, v93
    v_smfmac_f32_16x16x64_bf16 a[104:107], v[20:23], v[80:87], v12
    v_sub_f32 v94, v94, v40
    v_exp_f32 v94, v94
    v_sub_f32 v95, v95, v40
    v_exp_f32 v95, v95
    v_cvt_pk_bf16_f32 v110, v188, v189
    v_cvt_pk_bf16_f32 v111, v190, v191
    v_mfma_f32_32x32x16_bf16 v[64:79], v[120:123], a[152:155], 4.0
    v_sub_f32 v48, v48, v41
    v_exp_f32 v48, v48
    v_sub_f32 v49, v49, v41
    v_exp_f32 v49, v49
    v_sub_f32 v50, v50, v41
    v_exp_f32 v50, v50
    v_mfma_f32_32x32x16_bf16 v[64:79], v[124:127], a[156:159], v[64:79]
    v_sub_f32 v51, v51, v41
    v_exp_f32 v51, v51
    v_sub_f32 v52, v52, v41
    v_exp_f32 v52, v52
    v_sub_f32 v53, v53, v41
    v_exp_f32 v53, v53
    v_smfmac_f32_32x32x32_bf16 a[32:47], v[140:143], v[88:95], v12
    v_sub_f32 v54, v54, v41
    v_exp_f32 v54, v54
    v_sub_f32 v55, v55, v41
    v_exp_f32 v55, v55
    v_sub_f32 v56, v56, v41
    v_exp_f32 v56, v56
    v_smfmac_f32_16x16x64_bf16 a[104:107], v[20:23], v[88:95], v12
    v_sub_f32 v57, v57, v41
    v_exp_f32 v57, v57
    v_sub_f32 v58, v58, v41
    v_exp_f32 v58, v58
    v_smfmac_f32_32x32x32_bf16 a[48:63], v[136:139], v[48:55], v12
    v_sub_f32 v59, v59, v41
    v_exp_f32 v59, v59
    v_sub_f32 v60, v60, v41
    v_exp_f32 v60, v60
    v_sub_f32 v61, v61, v41
    v_exp_f32 v61, v61
    v_smfmac_f32_16x16x64_bf16 a[108:111], v[20:23], v[48:55], v12
    v_sub_f32 v62, v62, v41
    v_exp_f32 v62, v62
    v_sub_f32 v63, v63, v41
    v_exp_f32 v63, v63
    v_mfma_f32_32x32x16_bf16 v[80:95], v[120:123], a[160:163], 4.0
    v_sub_f32 v64, v64, v42
    v_exp_f32 v64, v64
    v_sub_f32 v65, v65, v42
    v_exp_f32 v65, v65
    v_sub_f32 v66, v66, v42
    v_exp_f32 v66, v66
    v_mfma_f32_32x32x16_bf16 v[80:95], v[124:127], a[164:167], v[80:95]
    v_sub_f32 v67, v67, v42
    v_exp_f32 v67, v67
    v_sub_f32 v68, v68, v42
    v_exp_f32 v68, v68
    v_sub_f32 v69, v69, v42
    v_exp_f32 v69, v69
    v_smfmac_f32_32x32x32_bf16 a[48:63], v[140:143], v[56:63], v12
    v_sub_f32 v70, v70, v42
    v_exp_f32 v70, v70
    v_sub_f32 v71, v71, v42
    v_exp_f32 v71, v71
    v_sub_f32 v72, v72, v42
    v_exp_f32 v72, v72
    v_smfmac_f32_16x16x64_bf16 a[108:111], v[20:23], v[56:63], v12
    v_sub_f32 v73, v73, v42
    v_exp_f32 v73, v73
    v_sub_f32 v74, v74, v42
    v_exp_f32 v74, v74
    v_smfmac_f32_32x32x32_bf16 a[64:79], v[136:139], v[64:71], v12
    v_sub_f32 v75, v75, v42
    v_exp_f32 v75, v75
    v_sub_f32 v76, v76, v42
    v_exp_f32 v76, v76
    v_sub_f32 v77, v77, v42
    v_exp_f32 v77, v77
    v_smfmac_f32_16x16x64_bf16 a[112:115], v[20:23], v[64:71], v12
    v_sub_f32 v78, v78, v42
    v_exp_f32 v78, v78
    v_sub_f32 v79, v79, v42
    v_exp_f32 v79, v79
    v_mfma_f32_32x32x16_bf16 v[48:63], v[96:99], v[192:195], 4.0
    v_sub_f32 v80, v80, v43
    v_exp_f32 v80, v80
    v_sub_f32 v81, v81, v43
    v_exp_f32 v81, v81
    v_sub_f32 v82, v82, v43
    v_exp_f32 v82, v82
    v_mfma_f32_32x32x16_bf16 v[48:63], v[100:103], v[196:199], v[48:63]
    v_sub_f32 v83, v83, v43
    v_exp_f32 v83, v83
    v_sub_f32 v84, v84, v43
    v_exp_f32 v84, v84
    v_sub_f32 v85, v85, v43
    v_exp_f32 v85, v85
    v_smfmac_f32_32x32x32_bf16 a[64:79], v[140:143], v[72:79], v12
    v_sub_f32 v86, v86, v43
    v_exp_f32 v86, v86
    v_sub_f32 v87, v87, v43
    v_exp_f32 v87, v87
    v_sub_f32 v88, v88, v43
    v_exp_f32 v88, v88
    v_smfmac_f32_16x16x64_bf16 a[112:115], v[20:23], v[72:79], v12
    v_sub_f32 v89, v89, v43
    v_exp_f32 v89, v89
    v_sub_f32 v90, v90, v43
    v_exp_f32 v90, v90
    v_smfmac_f32_32x32x32_bf16 a[80:95], v[136:139], v[80:87], v12
    s_waitcnt lgkmcnt(0)
    v_sub_f32 v91, v91, v43
    v_exp_f32 v91, v91
    v_sub_f32 v92, v92, v43
    v_exp_f32 v92, v92
    v_sub_f32 v93, v93, v43
    v_exp_f32 v93, v93
    v_smfmac_f32_16x16x64_bf16 a[116:119], v[20:23], v[80:87], v12
    v_sub_f32 v94, v94, v43
    v_exp_f32 v94, v94
    v_sub_f32 v95, v95, v43
    v_exp_f32 v95, v95
    v_mfma_f32_32x32x16_bf16 v[64:79], v[96:99], a[120:123], 4.0
    v_sub_f32 v48, v48, v36
    v_exp_f32 v48, v48
    v_sub_f32 v49, v49, v36
    v_exp_f32 v49, v49
    v_sub_f32 v50, v50, v36
    v_exp_f32 v50, v50
    v_mfma_f32_32x32x16_bf16 v[64:79], v[100:103], a[124:127], v[64:79]
    v_sub_f32 v51, v51, v36
    v_exp_f32 v51, v51
    v_sub_f32 v52, v52, v36
    v_exp_f32 v52, v52
    v_sub_f32 v53, v53, v36
    v_exp_f32 v53, v53
    v_smfmac_f32_32x32x32_bf16 a[80:95], v[140:143], v[88:95], v12
    s_waitcnt vmcnt(4)
    v_sub_f32 v54, v54, v36
    v_exp_f32 v54, v54
    v_sub_f32 v55, v55, v36
    v_exp_f32 v55, v55
    v_sub_f32 v56, v56, v36
    v_exp_f32 v56, v56
    v_smfmac_f32_16x16x64_bf16 a[116:119], v[20:23], v[88:95], v12
    ds_read_b128 v[144:147], v4 offset:24576
    v_sub_f32 v57, v57, v36
    v_exp_f32 v57, v57
    v_sub_f32 v58, v58, v36
    v_exp_f32 v58, v58
    v_smfmac_f32_32x32x32_bf16 v[208:223], v[128:131], v[48:55], v12
    v_sub_f32 v59, v59, v36
    v_exp_f32 v59, v59
    v_sub_f32 v60, v60, v36
    v_exp_f32 v60, v60
    v_sub_f32 v61, v61, v36
    v_exp_f32 v61, v61
    v_smfmac_f32_16x16x64_bf16 v[240:243], v[20:23], v[48:55], v12
    ds_read_b128 v[148:151], v5 offset:24576
    v_sub_f32 v62, v62, v36
    v_exp_f32 v62, v62
    v_sub_f32 v63, v63, v36
    v_exp_f32 v63, v63
    v_mfma_f32_32x32x16_bf16 v[80:95], v[96:99], a[128:131], 4.0
    v_sub_f32 v64, v64, v38
    v_exp_f32 v64, v64
    v_sub_f32 v65, v65, v38
    v_exp_f32 v65, v65
    v_sub_f32 v66, v66, v38
    v_exp_f32 v66, v66
    v_mfma_f32_32x32x16_bf16 v[80:95], v[100:103], a[132:135], v[80:95]
    v_sub_f32 v67, v67, v38
    v_exp_f32 v67, v67
    v_sub_f32 v68, v68, v38
    v_exp_f32 v68, v68
    v_sub_f32 v69, v69, v38
    v_exp_f32 v69, v69
    v_smfmac_f32_32x32x32_bf16 v[208:223], v[132:135], v[56:63], v12
    v_sub_f32 v70, v70, v38
    v_exp_f32 v70, v70
    v_sub_f32 v71, v71, v38
    v_exp_f32 v71, v71
    v_sub_f32 v72, v72, v38
    v_exp_f32 v72, v72
    v_smfmac_f32_16x16x64_bf16 v[240:243], v[20:23], v[56:63], v12
    ds_read_b128 v[152:155], v6 offset:24576
    v_sub_f32 v73, v73, v38
    v_exp_f32 v73, v73
    v_sub_f32 v74, v74, v38
    v_exp_f32 v74, v74
    v_smfmac_f32_32x32x32_bf16 a[0:15], v[128:131], v[64:71], v12
    v_sub_f32 v75, v75, v38
    v_exp_f32 v75, v75
    v_sub_f32 v76, v76, v38
    v_exp_f32 v76, v76
    v_sub_f32 v77, v77, v38
    v_exp_f32 v77, v77
    v_smfmac_f32_16x16x64_bf16 a[96:99], v[20:23], v[64:71], v12
    ds_read_b128 v[156:159], v7 offset:24576
    v_sub_f32 v78, v78, v38
    v_exp_f32 v78, v78
    v_sub_f32 v79, v79, v38
    v_exp_f32 v79, v79
    v_mfma_f32_32x32x16_bf16 v[48:63], v[96:99], a[136:139], 4.0
    v_sub_f32 v80, v80, v39
    v_exp_f32 v80, v80
    v_sub_f32 v81, v81, v39
    v_exp_f32 v81, v81
    v_sub_f32 v82, v82, v39
    v_exp_f32 v82, v82
    v_mfma_f32_32x32x16_bf16 v[48:63], v[100:103], a[140:143], v[48:63]
    v_sub_f32 v83, v83, v39
    v_exp_f32 v83, v83
    v_sub_f32 v84, v84, v39
    v_exp_f32 v84, v84
    v_sub_f32 v85, v85, v39
    v_exp_f32 v85, v85
    v_smfmac_f32_32x32x32_bf16 a[0:15], v[132:135], v[72:79], v12
    v_sub_f32 v86, v86, v39
    v_exp_f32 v86, v86
    v_sub_f32 v87, v87, v39
    v_exp_f32 v87, v87
    v_sub_f32 v88, v88, v39
    v_exp_f32 v88, v88
    v_smfmac_f32_16x16x64_bf16 a[96:99], v[20:23], v[72:79], v12
    ds_read_b64_tr_b16 v[136:137], v3 offset:18432
    v_sub_f32 v89, v89, v39
    v_exp_f32 v89, v89
    v_sub_f32 v90, v90, v39
    v_exp_f32 v90, v90
    v_smfmac_f32_32x32x32_bf16 a[16:31], v[128:131], v[80:87], v12
    s_waitcnt lgkmcnt(4)
    v_sub_f32 v91, v91, v39
    v_exp_f32 v91, v91
    v_sub_f32 v92, v92, v39
    v_exp_f32 v92, v92
    v_sub_f32 v93, v93, v39
    v_exp_f32 v93, v93
    v_smfmac_f32_16x16x64_bf16 a[100:103], v[20:23], v[80:87], v12
    ds_read_b64_tr_b16 v[138:139], v3 offset:18688
    v_sub_f32 v94, v94, v39
    v_exp_f32 v94, v94
    v_mfma_f32_4x4x4_16b_bf16 v[24:27], v[144:145], v[144:145], 0
    v_sub_f32 v95, v95, v39
    v_exp_f32 v95, v95
    v_mfma_f32_32x32x16_bf16 v[64:79], v[96:99], a[144:147], 4.0
    v_sub_f32 v48, v48, v40
    v_exp_f32 v48, v48
    v_sub_f32 v49, v49, v40
    v_exp_f32 v49, v49
    v_sub_f32 v50, v50, v40
    v_exp_f32 v50, v50
    v_mfma_f32_32x32x16_bf16 v[64:79], v[100:103], a[148:151], v[64:79]
    v_sub_f32 v51, v51, v40
    v_exp_f32 v51, v51
    v_sub_f32 v52, v52, v40
    v_exp_f32 v52, v52
    v_sub_f32 v53, v53, v40
    v_exp_f32 v53, v53
    v_smfmac_f32_32x32x32_bf16 a[16:31], v[132:135], v[88:95], v12
    v_sub_f32 v54, v54, v40
    v_exp_f32 v54, v54
    v_sub_f32 v55, v55, v40
    v_exp_f32 v55, v55
    v_sub_f32 v56, v56, v40
    v_exp_f32 v56, v56
    v_smfmac_f32_16x16x64_bf16 a[100:103], v[20:23], v[88:95], v12
    ds_read_b64_tr_b16 v[140:141], v3 offset:19456
    v_sub_f32 v57, v57, v40
    v_exp_f32 v57, v57
    v_mfma_f32_4x4x4_16b_bf16 v[24:27], v[146:147], v[146:147], v[24:27]
    v_sub_f32 v58, v58, v40
    v_exp_f32 v58, v58
    v_smfmac_f32_32x32x32_bf16 a[32:47], v[128:131], v[48:55], v12
    s_waitcnt lgkmcnt(5)
    v_sub_f32 v59, v59, v40
    v_exp_f32 v59, v59
    v_sub_f32 v60, v60, v40
    v_exp_f32 v60, v60
    v_sub_f32 v61, v61, v40
    v_exp_f32 v61, v61
    v_smfmac_f32_16x16x64_bf16 a[104:107], v[20:23], v[48:55], v12
    ds_read_b64_tr_b16 v[142:143], v3 offset:19712
    v_sub_f32 v62, v62, v40
    v_exp_f32 v62, v62
    v_mfma_f32_4x4x4_16b_bf16 v[24:27], v[148:149], v[148:149], v[24:27]
    v_sub_f32 v63, v63, v40
    v_exp_f32 v63, v63
    v_mfma_f32_32x32x16_bf16 v[80:95], v[96:99], a[152:155], 4.0
    v_sub_f32 v64, v64, v41
    v_exp_f32 v64, v64
    v_sub_f32 v65, v65, v41
    v_exp_f32 v65, v65
    v_sub_f32 v66, v66, v41
    v_exp_f32 v66, v66
    v_mfma_f32_32x32x16_bf16 v[80:95], v[100:103], a[156:159], v[80:95]
    v_sub_f32 v67, v67, v41
    v_exp_f32 v67, v67
    v_sub_f32 v68, v68, v41
    v_exp_f32 v68, v68
    v_sub_f32 v69, v69, v41
    v_exp_f32 v69, v69
    v_smfmac_f32_32x32x32_bf16 a[32:47], v[132:135], v[56:63], v12
    v_sub_f32 v70, v70, v41
    v_exp_f32 v70, v70
    v_sub_f32 v71, v71, v41
    v_exp_f32 v71, v71
    v_sub_f32 v72, v72, v41
    v_exp_f32 v72, v72
    v_smfmac_f32_16x16x64_bf16 a[104:107], v[20:23], v[56:63], v12
    ds_read_b64_tr_b16 v[160:161], v8 offset:24576
    v_sub_f32 v73, v73, v41
    v_exp_f32 v73, v73
    v_mfma_f32_4x4x4_16b_bf16 v[24:27], v[150:151], v[150:151], v[24:27]
    v_sub_f32 v74, v74, v41
    v_exp_f32 v74, v74
    v_smfmac_f32_32x32x32_bf16 a[48:63], v[128:131], v[64:71], v12
    s_waitcnt lgkmcnt(6)
    v_sub_f32 v75, v75, v41
    v_exp_f32 v75, v75
    v_sub_f32 v76, v76, v41
    v_exp_f32 v76, v76
    v_sub_f32 v77, v77, v41
    v_exp_f32 v77, v77
    v_smfmac_f32_16x16x64_bf16 a[108:111], v[20:23], v[64:71], v12
    ds_read_b64_tr_b16 v[162:163], v8 offset:24584
    v_sub_f32 v78, v78, v41
    v_exp_f32 v78, v78
    v_mfma_f32_4x4x4_16b_bf16 v[24:27], v[152:153], v[152:153], v[24:27]
    v_sub_f32 v79, v79, v41
    v_exp_f32 v79, v79
    v_mfma_f32_32x32x16_bf16 v[48:63], v[96:99], a[160:163], 4.0
    v_sub_f32 v80, v80, v42
    v_exp_f32 v80, v80
    v_sub_f32 v81, v81, v42
    v_exp_f32 v81, v81
    v_sub_f32 v82, v82, v42
    v_exp_f32 v82, v82
    v_mfma_f32_32x32x16_bf16 v[48:63], v[100:103], a[164:167], v[48:63]
    v_sub_f32 v83, v83, v42
    v_exp_f32 v83, v83
    v_sub_f32 v84, v84, v42
    v_exp_f32 v84, v84
    v_sub_f32 v85, v85, v42
    v_exp_f32 v85, v85
    v_smfmac_f32_32x32x32_bf16 a[48:63], v[132:135], v[72:79], v12
    v_sub_f32 v86, v86, v42
    v_exp_f32 v86, v86
    v_sub_f32 v87, v87, v42
    v_exp_f32 v87, v87
    v_sub_f32 v88, v88, v42
    v_exp_f32 v88, v88
    v_smfmac_f32_16x16x64_bf16 a[108:111], v[20:23], v[72:79], v12
    ds_read_b64_tr_b16 v[164:165], v9 offset:24576
    v_sub_f32 v89, v89, v42
    v_exp_f32 v89, v89
    v_mfma_f32_4x4x4_16b_bf16 v[24:27], v[154:155], v[154:155], v[24:27]
    v_sub_f32 v90, v90, v42
    v_exp_f32 v90, v90
    v_smfmac_f32_32x32x32_bf16 a[64:79], v[128:131], v[80:87], v12
    s_waitcnt lgkmcnt(7)
    v_sub_f32 v91, v91, v42
    v_exp_f32 v91, v91
    v_sub_f32 v92, v92, v42
    v_exp_f32 v92, v92
    v_sub_f32 v93, v93, v42
    v_exp_f32 v93, v93
    v_smfmac_f32_16x16x64_bf16 a[112:115], v[20:23], v[80:87], v12
    ds_read_b64_tr_b16 v[166:167], v9 offset:24584
    v_sub_f32 v94, v94, v42
    v_exp_f32 v94, v94
    v_mfma_f32_4x4x4_16b_bf16 v[24:27], v[156:157], v[156:157], v[24:27]
    v_sub_f32 v95, v95, v42
    v_exp_f32 v95, v95
    v_mfma_f32_32x32x16_bf16 v[64:79], v[104:107], v[192:195], 4.0
    v_sub_f32 v48, v48, v43
    v_exp_f32 v48, v48
    v_sub_f32 v49, v49, v43
    v_exp_f32 v49, v49
    v_sub_f32 v50, v50, v43
    v_exp_f32 v50, v50
    v_mfma_f32_32x32x16_bf16 v[64:79], v[108:111], v[196:199], v[64:79]
    v_sub_f32 v51, v51, v43
    v_exp_f32 v51, v51
    v_sub_f32 v52, v52, v43
    v_exp_f32 v52, v52
    v_sub_f32 v53, v53, v43
    v_exp_f32 v53, v53
    v_smfmac_f32_32x32x32_bf16 a[64:79], v[132:135], v[88:95], v12
    v_sub_f32 v54, v54, v43
    v_exp_f32 v54, v54
    v_sub_f32 v55, v55, v43
    v_exp_f32 v55, v55
    v_sub_f32 v56, v56, v43
    v_exp_f32 v56, v56
    v_smfmac_f32_16x16x64_bf16 a[112:115], v[20:23], v[88:95], v12
    ds_read_b64_tr_b16 v[168:169], v8 offset:26624
    v_sub_f32 v57, v57, v43
    v_exp_f32 v57, v57
    v_mfma_f32_4x4x4_16b_bf16 v[24:27], v[158:159], v[158:159], v[24:27]
    v_sub_f32 v58, v58, v43
    v_exp_f32 v58, v58
    v_smfmac_f32_32x32x32_bf16 a[80:95], v[128:131], v[48:55], v12
    v_sub_f32 v59, v59, v43
    v_exp_f32 v59, v59
    v_sub_f32 v60, v60, v43
    v_exp_f32 v60, v60
    v_sub_f32 v61, v61, v43
    v_exp_f32 v61, v61
    v_smfmac_f32_16x16x64_bf16 a[116:119], v[20:23], v[48:55], v12
    ds_read_b64_tr_b16 v[170:171], v8 offset:26632
    v_sub_f32 v62, v62, v43
    v_exp_f32 v62, v62
    v_sub_f32 v63, v63, v43
    v_exp_f32 v63, v63
    v_cndmask_b32 v28, v24, v25, s[40:41]
    v_mfma_f32_32x32x16_bf16 v[80:95], v[104:107], a[120:123], 4.0
    v_sub_f32 v64, v64, v36
    v_exp_f32 v64, v64
    v_sub_f32 v65, v65, v36
    v_exp_f32 v65, v65
    v_sub_f32 v66, v66, v36
    v_exp_f32 v66, v66
    v_cndmask_b32 v28, v28, v26, s[42:43]
    v_mfma_f32_32x32x16_bf16 v[80:95], v[108:111], a[124:127], v[80:95]
    s_waitcnt lgkmcnt(6)
    v_sub_f32 v67, v67, v36
    v_exp_f32 v67, v67
    v_sub_f32 v68, v68, v36
    v_exp_f32 v68, v68
    v_sub_f32 v69, v69, v36
    v_exp_f32 v69, v69
    v_cndmask_b32 v28, v28, v27, s[44:45]
    v_smfmac_f32_32x32x32_bf16 a[80:95], v[132:135], v[56:63], v12
    v_sub_f32 v70, v70, v36
    v_exp_f32 v70, v70
    v_sub_f32 v71, v71, v36
    v_exp_f32 v71, v71
    v_sub_f32 v72, v72, v36
    v_exp_f32 v72, v72
    v_sqrt_f32 v28, v28
    v_smfmac_f32_16x16x64_bf16 a[116:119], v[20:23], v[56:63], v12
    ds_read_b64_tr_b16 v[172:173], v9 offset:26624
    v_sub_f32 v73, v73, v36
    v_exp_f32 v73, v73
    v_sub_f32 v74, v74, v36
    v_exp_f32 v74, v74
    v_add_f32 v28, 0x358637bd, v28
    v_smfmac_f32_32x32x32_bf16 v[208:223], v[136:139], v[64:71], v12
    v_sub_f32 v75, v75, v36
    v_exp_f32 v75, v75
    v_sub_f32 v76, v76, v36
    v_exp_f32 v76, v76
    v_sub_f32 v77, v77, v36
    v_exp_f32 v77, v77
    v_rcp_f32 v28, v28
    v_smfmac_f32_16x16x64_bf16 v[240:243], v[20:23], v[64:71], v12
    ds_read_b64_tr_b16 v[174:175], v9 offset:26632
    v_sub_f32 v78, v78, v36
    v_exp_f32 v78, v78
    v_sub_f32 v79, v79, v36
    v_exp_f32 v79, v79
    v_cvt_pk_bf16_f32 v29, v28, v28
    v_cvt_pk_bf16_f32 v30, v28, v28
    v_mfma_f32_32x32x16_bf16 v[48:63], v[104:107], a[128:131], 4.0
    v_sub_f32 v80, v80, v38
    v_exp_f32 v80, v80
    v_sub_f32 v81, v81, v38
    v_exp_f32 v81, v81
    v_sub_f32 v82, v82, v38
    v_exp_f32 v82, v82
    v_permlane32_swap_b32 v29, v30
    v_mfma_f32_32x32x16_bf16 v[48:63], v[108:111], a[132:135], v[48:63]
    v_sub_f32 v83, v83, v38
    v_exp_f32 v83, v83
    v_sub_f32 v84, v84, v38
    v_exp_f32 v84, v84
    v_sub_f32 v85, v85, v38
    v_exp_f32 v85, v85
    v_and_b32 v32, v29, v10
    v_and_b32 v33, v29, v11
    v_smfmac_f32_32x32x32_bf16 v[208:223], v[140:143], v[72:79], v12
    v_sub_f32 v86, v86, v38
    v_exp_f32 v86, v86
    v_sub_f32 v87, v87, v38
    v_exp_f32 v87, v87
    v_sub_f32 v88, v88, v38
    v_exp_f32 v88, v88
    v_and_b32 v34, v30, v10
    v_and_b32 v35, v30, v11
    v_smfmac_f32_16x16x64_bf16 v[240:243], v[20:23], v[72:79], v12
    v_sub_f32 v89, v89, v38
    v_exp_f32 v89, v89
    v_sub_f32 v90, v90, v38
    v_exp_f32 v90, v90
    v_smfmac_f32_32x32x32_bf16 a[0:15], v[136:139], v[80:87], v12
    s_waitcnt lgkmcnt(4)
    v_sub_f32 v91, v91, v38
    v_exp_f32 v91, v91
    v_sub_f32 v92, v92, v38
    v_exp_f32 v92, v92
    v_sub_f32 v93, v93, v38
    v_exp_f32 v93, v93
    v_smfmac_f32_16x16x64_bf16 a[96:99], v[20:23], v[80:87], v12
    v_sub_f32 v94, v94, v38
    v_exp_f32 v94, v94
    v_mfma_f32_4x4x4_16b_bf16 v[176:179], v[160:161], v[32:33], 0
    v_sub_f32 v95, v95, v38
    v_exp_f32 v95, v95
    v_mfma_f32_32x32x16_bf16 v[64:79], v[104:107], a[136:139], 4.0
    v_sub_f32 v48, v48, v39
    v_exp_f32 v48, v48
    v_sub_f32 v49, v49, v39
    v_exp_f32 v49, v49
    v_sub_f32 v50, v50, v39
    v_exp_f32 v50, v50
    v_mfma_f32_32x32x16_bf16 v[64:79], v[108:111], a[140:143], v[64:79]
    v_sub_f32 v51, v51, v39
    v_exp_f32 v51, v51
    v_sub_f32 v52, v52, v39
    v_exp_f32 v52, v52
    v_sub_f32 v53, v53, v39
    v_exp_f32 v53, v53
    v_cvt_pk_bf16_f32 v112, v176, v177
    v_cvt_pk_bf16_f32 v113, v178, v179
    v_smfmac_f32_32x32x32_bf16 a[0:15], v[140:143], v[88:95], v12
    s_waitcnt vmcnt(2)
    v_sub_f32 v54, v54, v39
    v_exp_f32 v54, v54
    v_sub_f32 v55, v55, v39
    v_exp_f32 v55, v55
    v_sub_f32 v56, v56, v39
    v_exp_f32 v56, v56
    v_smfmac_f32_16x16x64_bf16 a[96:99], v[20:23], v[88:95], v12
    ds_read_b64_tr_b16 a[168:169], v3 offset:24576
    v_sub_f32 v57, v57, v39
    v_exp_f32 v57, v57
    v_mfma_f32_4x4x4_16b_bf16 v[180:183], v[162:163], v[32:33], 0
    v_sub_f32 v58, v58, v39
    v_exp_f32 v58, v58
    v_smfmac_f32_32x32x32_bf16 a[16:31], v[136:139], v[48:55], v12
    v_sub_f32 v59, v59, v39
    v_exp_f32 v59, v59
    v_sub_f32 v60, v60, v39
    v_exp_f32 v60, v60
    v_sub_f32 v61, v61, v39
    v_exp_f32 v61, v61
    v_smfmac_f32_16x16x64_bf16 a[100:103], v[20:23], v[48:55], v12
    ds_read_b64_tr_b16 a[170:171], v3 offset:24832
    v_sub_f32 v62, v62, v39
    v_exp_f32 v62, v62
    v_mfma_f32_4x4x4_16b_bf16 v[184:187], v[164:165], v[32:33], 0
    v_sub_f32 v63, v63, v39
    v_exp_f32 v63, v63
    v_cvt_pk_bf16_f32 v114, v180, v181
    v_cvt_pk_bf16_f32 v115, v182, v183
    v_mfma_f32_32x32x16_bf16 v[80:95], v[104:107], a[144:147], 4.0
    v_sub_f32 v64, v64, v40
    v_exp_f32 v64, v64
    v_sub_f32 v65, v65, v40
    v_exp_f32 v65, v65
    v_sub_f32 v66, v66, v40
    v_exp_f32 v66, v66
    v_mfma_f32_32x32x16_bf16 v[80:95], v[108:111], a[148:151], v[80:95]
    v_sub_f32 v67, v67, v40
    v_exp_f32 v67, v67
    v_sub_f32 v68, v68, v40
    v_exp_f32 v68, v68
    v_sub_f32 v69, v69, v40
    v_exp_f32 v69, v69
    v_cvt_pk_bf16_f32 v116, v184, v185
    v_cvt_pk_bf16_f32 v117, v186, v187
    v_smfmac_f32_32x32x32_bf16 a[16:31], v[140:143], v[56:63], v12
    v_sub_f32 v70, v70, v40
    v_exp_f32 v70, v70
    v_sub_f32 v71, v71, v40
    v_exp_f32 v71, v71
    v_sub_f32 v72, v72, v40
    v_exp_f32 v72, v72
    v_smfmac_f32_16x16x64_bf16 a[100:103], v[20:23], v[56:63], v12
    ds_read_b64_tr_b16 a[172:173], v3 offset:25600
    v_sub_f32 v73, v73, v40
    v_exp_f32 v73, v73
    v_mfma_f32_4x4x4_16b_bf16 v[188:191], v[166:167], v[32:33], 0
    v_sub_f32 v74, v74, v40
    v_exp_f32 v74, v74
    v_smfmac_f32_32x32x32_bf16 a[32:47], v[136:139], v[64:71], v12
    s_waitcnt lgkmcnt(3)
    v_sub_f32 v75, v75, v40
    v_exp_f32 v75, v75
    v_sub_f32 v76, v76, v40
    v_exp_f32 v76, v76
    v_sub_f32 v77, v77, v40
    v_exp_f32 v77, v77
    v_smfmac_f32_16x16x64_bf16 a[104:107], v[20:23], v[64:71], v12
    ds_read_b64_tr_b16 a[174:175], v3 offset:25856
    v_sub_f32 v78, v78, v40
    v_exp_f32 v78, v78
    v_mfma_f32_4x4x4_16b_bf16 v[176:179], v[168:169], v[34:35], 0
    v_sub_f32 v79, v79, v40
    v_exp_f32 v79, v79
    v_cvt_pk_bf16_f32 v118, v188, v189
    v_cvt_pk_bf16_f32 v119, v190, v191
    v_mfma_f32_32x32x16_bf16 v[48:63], v[104:107], a[152:155], 4.0
    v_sub_f32 v80, v80, v41
    v_exp_f32 v80, v80
    v_sub_f32 v81, v81, v41
    v_exp_f32 v81, v81
    v_sub_f32 v82, v82, v41
    v_exp_f32 v82, v82
    v_mfma_f32_32x32x16_bf16 v[48:63], v[108:111], a[156:159], v[48:63]
    v_sub_f32 v83, v83, v41
    v_exp_f32 v83, v83
    v_sub_f32 v84, v84, v41
    v_exp_f32 v84, v84
    v_sub_f32 v85, v85, v41
    v_exp_f32 v85, v85
    v_cvt_pk_bf16_f32 v120, v176, v177
    v_cvt_pk_bf16_f32 v121, v178, v179
    v_smfmac_f32_32x32x32_bf16 a[32:47], v[140:143], v[72:79], v12
    s_waitcnt vmcnt(0)
    v_sub_f32 v86, v86, v41
    v_exp_f32 v86, v86
    v_sub_f32 v87, v87, v41
    v_exp_f32 v87, v87
    v_sub_f32 v88, v88, v41
    v_exp_f32 v88, v88
    v_smfmac_f32_16x16x64_bf16 a[104:107], v[20:23], v[72:79], v12
    ds_read_b64_tr_b16 a[176:177], v3 offset:26624
    v_sub_f32 v89, v89, v41
    v_exp_f32 v89, v89
    v_mfma_f32_4x4x4_16b_bf16 v[180:183], v[170:171], v[34:35], 0
    v_sub_f32 v90, v90, v41
    v_exp_f32 v90, v90
    v_smfmac_f32_32x32x32_bf16 a[48:63], v[136:139], v[80:87], v12
    v_sub_f32 v91, v91, v41
    v_exp_f32 v91, v91
    v_sub_f32 v92, v92, v41
    v_exp_f32 v92, v92
    v_sub_f32 v93, v93, v41
    v_exp_f32 v93, v93
    v_smfmac_f32_16x16x64_bf16 a[108:111], v[20:23], v[80:87], v12
    ds_read_b64_tr_b16 a[178:179], v3 offset:26880
    v_sub_f32 v94, v94, v41
    v_exp_f32 v94, v94
    v_mfma_f32_4x4x4_16b_bf16 v[184:187], v[172:173], v[34:35], 0
    v_sub_f32 v95, v95, v41
    v_exp_f32 v95, v95
    v_cvt_pk_bf16_f32 v122, v180, v181
    v_cvt_pk_bf16_f32 v123, v182, v183
    v_mfma_f32_32x32x16_bf16 v[64:79], v[104:107], a[160:163], 4.0
    v_sub_f32 v48, v48, v42
    v_exp_f32 v48, v48
    v_sub_f32 v49, v49, v42
    v_exp_f32 v49, v49
    v_sub_f32 v50, v50, v42
    v_exp_f32 v50, v50
    v_mfma_f32_32x32x16_bf16 v[64:79], v[108:111], a[164:167], v[64:79]
    v_sub_f32 v51, v51, v42
    v_exp_f32 v51, v51
    v_sub_f32 v52, v52, v42
    v_exp_f32 v52, v52
    v_sub_f32 v53, v53, v42
    v_exp_f32 v53, v53
    v_cvt_pk_bf16_f32 v124, v184, v185
    v_cvt_pk_bf16_f32 v125, v186, v187
    v_smfmac_f32_32x32x32_bf16 a[48:63], v[140:143], v[88:95], v12
    v_sub_f32 v54, v54, v42
    v_exp_f32 v54, v54
    v_sub_f32 v55, v55, v42
    v_exp_f32 v55, v55
    v_sub_f32 v56, v56, v42
    v_exp_f32 v56, v56
    v_smfmac_f32_16x16x64_bf16 a[108:111], v[20:23], v[88:95], v12
    ds_read_b64_tr_b16 a[180:181], v3 offset:27648
    v_sub_f32 v57, v57, v42
    v_exp_f32 v57, v57
    v_mfma_f32_4x4x4_16b_bf16 v[188:191], v[174:175], v[34:35], 0
    v_sub_f32 v58, v58, v42
    v_exp_f32 v58, v58
    v_smfmac_f32_32x32x32_bf16 a[64:79], v[136:139], v[48:55], v12
    v_sub_f32 v59, v59, v42
    v_exp_f32 v59, v59
    v_sub_f32 v60, v60, v42
    v_exp_f32 v60, v60
    v_sub_f32 v61, v61, v42
    v_exp_f32 v61, v61
    v_smfmac_f32_16x16x64_bf16 a[112:115], v[20:23], v[48:55], v12
    ds_read_b64_tr_b16 a[182:183], v3 offset:27904
    v_sub_f32 v62, v62, v42
    v_exp_f32 v62, v62
    v_sub_f32 v63, v63, v42
    v_exp_f32 v63, v63
    v_cvt_pk_bf16_f32 v126, v188, v189
    v_cvt_pk_bf16_f32 v127, v190, v191
    v_mfma_f32_32x32x16_bf16 v[80:95], v[112:115], a[120:123], 4.0
    v_sub_f32 v64, v64, v43
    v_exp_f32 v64, v64
    v_sub_f32 v65, v65, v43
    v_exp_f32 v65, v65
    v_sub_f32 v66, v66, v43
    v_exp_f32 v66, v66
    v_mfma_f32_32x32x16_bf16 v[80:95], v[116:119], a[124:127], v[80:95]
    v_sub_f32 v67, v67, v43
    v_exp_f32 v67, v67
    v_sub_f32 v68, v68, v43
    v_exp_f32 v68, v68
    v_sub_f32 v69, v69, v43
    v_exp_f32 v69, v69
    v_smfmac_f32_32x32x32_bf16 a[64:79], v[140:143], v[56:63], v12
    v_sub_f32 v70, v70, v43
    v_exp_f32 v70, v70
    v_sub_f32 v71, v71, v43
    v_exp_f32 v71, v71
    v_sub_f32 v72, v72, v43
    v_exp_f32 v72, v72
    v_smfmac_f32_16x16x64_bf16 a[112:115], v[20:23], v[56:63], v12
    v_sub_f32 v73, v73, v43
    v_exp_f32 v73, v73
    v_sub_f32 v74, v74, v43
    v_exp_f32 v74, v74
    v_smfmac_f32_32x32x32_bf16 a[80:95], v[136:139], v[64:71], v12
    s_waitcnt lgkmcnt(4)
    v_sub_f32 v75, v75, v43
    v_exp_f32 v75, v75
    v_sub_f32 v76, v76, v43
    v_exp_f32 v76, v76
    v_sub_f32 v77, v77, v43
    v_exp_f32 v77, v77
    v_smfmac_f32_16x16x64_bf16 a[116:119], v[20:23], v[64:71], v12
    v_sub_f32 v78, v78, v43
    v_exp_f32 v78, v78
    v_sub_f32 v79, v79, v43
    v_exp_f32 v79, v79
    v_mfma_f32_32x32x16_bf16 v[48:63], v[120:123], a[120:123], 4.0
    v_sub_f32 v80, v80, v38
    v_exp_f32 v80, v80
    v_sub_f32 v81, v81, v38
    v_exp_f32 v81, v81
    v_sub_f32 v82, v82, v38
    v_exp_f32 v82, v82
    v_mfma_f32_32x32x16_bf16 v[48:63], v[124:127], a[124:127], v[48:63]
    v_sub_f32 v83, v83, v38
    v_exp_f32 v83, v83
    v_sub_f32 v84, v84, v38
    v_exp_f32 v84, v84
    v_sub_f32 v85, v85, v38
    v_exp_f32 v85, v85
    v_smfmac_f32_32x32x32_bf16 a[80:95], v[140:143], v[72:79], v12
    s_waitcnt lgkmcnt(0)
    v_sub_f32 v86, v86, v38
    v_exp_f32 v86, v86
    v_sub_f32 v87, v87, v38
    v_exp_f32 v87, v87
    v_sub_f32 v88, v88, v38
    v_exp_f32 v88, v88
    v_smfmac_f32_16x16x64_bf16 a[116:119], v[20:23], v[72:79], v12
    v_sub_f32 v89, v89, v38
    v_exp_f32 v89, v89
    v_sub_f32 v90, v90, v38
    v_exp_f32 v90, v90
    v_smfmac_f32_32x32x32_bf16 a[0:15], a[168:171], v[80:87], v12
    v_sub_f32 v91, v91, v38
    v_exp_f32 v91, v91
    v_sub_f32 v92, v92, v38
    v_exp_f32 v92, v92
    v_sub_f32 v93, v93, v38
    v_exp_f32 v93, v93
    v_smfmac_f32_16x16x64_bf16 a[96:99], v[20:23], v[80:87], v12
    v_sub_f32 v94, v94, v38
    v_exp_f32 v94, v94
    v_sub_f32 v95, v95, v38
    v_exp_f32 v95, v95
    v_mfma_f32_32x32x16_bf16 v[64:79], v[112:115], a[136:139], 4.0
    v_sub_f32 v48, v48, v38
    v_exp_f32 v48, v48
    v_sub_f32 v49, v49, v38
    v_exp_f32 v49, v49
    v_sub_f32 v50, v50, v38
    v_exp_f32 v50, v50
    v_mfma_f32_32x32x16_bf16 v[64:79], v[116:119], a[140:143], v[64:79]
    v_sub_f32 v51, v51, v38
    v_exp_f32 v51, v51
    v_sub_f32 v52, v52, v38
    v_exp_f32 v52, v52
    v_sub_f32 v53, v53, v38
    v_exp_f32 v53, v53
    v_smfmac_f32_32x32x32_bf16 a[0:15], a[172:175], v[88:95], v12
    v_sub_f32 v54, v54, v38
    v_exp_f32 v54, v54
    v_sub_f32 v55, v55, v38
    v_exp_f32 v55, v55
    v_sub_f32 v56, v56, v38
    v_exp_f32 v56, v56
    v_smfmac_f32_16x16x64_bf16 a[96:99], v[20:23], v[88:95], v12
    v_sub_f32 v57, v57, v38
    v_exp_f32 v57, v57
    v_sub_f32 v58, v58, v38
    v_exp_f32 v58, v58
    v_smfmac_f32_32x32x32_bf16 a[0:15], a[176:179], v[48:55], v12
    v_sub_f32 v59, v59, v38
    v_exp_f32 v59, v59
    v_sub_f32 v60, v60, v38
    v_exp_f32 v60, v60
    v_sub_f32 v61, v61, v38
    v_exp_f32 v61, v61
    v_smfmac_f32_16x16x64_bf16 a[96:99], v[20:23], v[48:55], v12
    v_sub_f32 v62, v62, v38
    v_exp_f32 v62, v62
    v_sub_f32 v63, v63, v38
    v_exp_f32 v63, v63
    v_mfma_f32_32x32x16_bf16 v[80:95], v[120:123], a[136:139], 4.0
    v_sub_f32 v64, v64, v40
    v_exp_f32 v64, v64
    v_sub_f32 v65, v65, v40
    v_exp_f32 v65, v65
    v_sub_f32 v66, v66, v40
    v_exp_f32 v66, v66
    v_mfma_f32_32x32x16_bf16 v[80:95], v[124:127], a[140:143], v[80:95]
    v_sub_f32 v67, v67, v40
    v_exp_f32 v67, v67
    v_sub_f32 v68, v68, v40
    v_exp_f32 v68, v68
    v_sub_f32 v69, v69, v40
    v_exp_f32 v69, v69
    v_smfmac_f32_32x32x32_bf16 a[0:15], a[180:183], v[56:63], v12
    v_sub_f32 v70, v70, v40
    v_exp_f32 v70, v70
    v_sub_f32 v71, v71, v40
    v_exp_f32 v71, v71
    v_sub_f32 v72, v72, v40
    v_exp_f32 v72, v72
    v_smfmac_f32_16x16x64_bf16 a[96:99], v[20:23], v[56:63], v12
    v_sub_f32 v73, v73, v40
    v_exp_f32 v73, v73
    v_sub_f32 v74, v74, v40
    v_exp_f32 v74, v74
    v_smfmac_f32_32x32x32_bf16 a[32:47], a[168:171], v[64:71], v12
    v_sub_f32 v75, v75, v40
    v_exp_f32 v75, v75
    v_sub_f32 v76, v76, v40
    v_exp_f32 v76, v76
    v_sub_f32 v77, v77, v40
    v_exp_f32 v77, v77
    v_smfmac_f32_16x16x64_bf16 a[104:107], v[20:23], v[64:71], v12
    v_sub_f32 v78, v78, v40
    v_exp_f32 v78, v78
    v_sub_f32 v79, v79, v40
    v_exp_f32 v79, v79
    v_mfma_f32_32x32x16_bf16 v[48:63], v[112:115], a[152:155], 4.0
    v_sub_f32 v80, v80, v40
    v_exp_f32 v80, v80
    v_sub_f32 v81, v81, v40
    v_exp_f32 v81, v81
    v_sub_f32 v82, v82, v40
    v_exp_f32 v82, v82
    v_mfma_f32_32x32x16_bf16 v[48:63], v[116:119], a[156:159], v[48:63]
    ds_write_b128 v14, a[0:3]
    v_sub_f32 v83, v83, v40
    v_exp_f32 v83, v83
    v_sub_f32 v84, v84, v40
    v_exp_f32 v84, v84
    v_sub_f32 v85, v85, v40
    v_exp_f32 v85, v85
    v_smfmac_f32_32x32x32_bf16 a[32:47], a[172:175], v[72:79], v12
    v_sub_f32 v86, v86, v40
    v_exp_f32 v86, v86
    v_sub_f32 v87, v87, v40
    v_exp_f32 v87, v87
    v_sub_f32 v88, v88, v40
    v_exp_f32 v88, v88
    v_smfmac_f32_16x16x64_bf16 a[104:107], v[20:23], v[72:79], v12
    ds_write_b128 v14, a[4:7] offset:1024
    v_sub_f32 v89, v89, v40
    v_exp_f32 v89, v89
    v_sub_f32 v90, v90, v40
    v_exp_f32 v90, v90
    v_smfmac_f32_32x32x32_bf16 a[32:47], a[176:179], v[80:87], v12
    v_sub_f32 v91, v91, v40
    v_exp_f32 v91, v91
    v_sub_f32 v92, v92, v40
    v_exp_f32 v92, v92
    v_sub_f32 v93, v93, v40
    v_exp_f32 v93, v93
    v_smfmac_f32_16x16x64_bf16 a[104:107], v[20:23], v[80:87], v12
    ds_write_b128 v14, a[8:11] offset:2048
    v_sub_f32 v94, v94, v40
    v_exp_f32 v94, v94
    v_sub_f32 v95, v95, v40
    v_exp_f32 v95, v95
    v_mfma_f32_32x32x16_bf16 v[64:79], v[120:123], a[152:155], 4.0
    v_sub_f32 v48, v48, v42
    v_exp_f32 v48, v48
    v_sub_f32 v49, v49, v42
    v_exp_f32 v49, v49
    v_sub_f32 v50, v50, v42
    v_exp_f32 v50, v50
    v_mfma_f32_32x32x16_bf16 v[64:79], v[124:127], a[156:159], v[64:79]
    v_sub_f32 v51, v51, v42
    v_exp_f32 v51, v51
    v_sub_f32 v52, v52, v42
    v_exp_f32 v52, v52
    v_sub_f32 v53, v53, v42
    v_exp_f32 v53, v53
    v_smfmac_f32_32x32x32_bf16 a[32:47], a[180:183], v[88:95], v12
    v_sub_f32 v54, v54, v42
    v_exp_f32 v54, v54
    v_sub_f32 v55, v55, v42
    v_exp_f32 v55, v55
    v_sub_f32 v56, v56, v42
    v_exp_f32 v56, v56
    v_smfmac_f32_16x16x64_bf16 a[104:107], v[20:23], v[88:95], v12
    ds_write_b128 v14, a[12:15] offset:3072
    v_sub_f32 v57, v57, v42
    v_exp_f32 v57, v57
    v_sub_f32 v58, v58, v42
    v_exp_f32 v58, v58
    v_smfmac_f32_32x32x32_bf16 a[64:79], a[168:171], v[48:55], v12
    v_sub_f32 v59, v59, v42
    v_exp_f32 v59, v59
    v_sub_f32 v60, v60, v42
    v_exp_f32 v60, v60
    v_sub_f32 v61, v61, v42
    v_exp_f32 v61, v61
    v_smfmac_f32_16x16x64_bf16 a[112:115], v[20:23], v[48:55], v12
    ds_write_b32 v14, a96 offset:4096
    v_sub_f32 v62, v62, v42
    v_exp_f32 v62, v62
    v_sub_f32 v63, v63, v42
    v_exp_f32 v63, v63
    v_mfma_f32_32x32x16_bf16 v[80:95], v[112:115], v[192:195], 4.0
    v_sub_f32 v64, v64, v42
    v_exp_f32 v64, v64
    v_sub_f32 v65, v65, v42
    v_exp_f32 v65, v65
    v_sub_f32 v66, v66, v42
    v_exp_f32 v66, v66
    v_mfma_f32_32x32x16_bf16 v[80:95], v[116:119], v[196:199], v[80:95]
    ds_write_b128 v14, a[32:35] offset:10240
    v_sub_f32 v67, v67, v42
    v_exp_f32 v67, v67
    v_sub_f32 v68, v68, v42
    v_exp_f32 v68, v68
    v_sub_f32 v69, v69, v42
    v_exp_f32 v69, v69
    v_smfmac_f32_32x32x32_bf16 a[64:79], a[172:175], v[56:63], v12
    v_sub_f32 v70, v70, v42
    v_exp_f32 v70, v70
    v_sub_f32 v71, v71, v42
    v_exp_f32 v71, v71
    v_sub_f32 v72, v72, v42
    v_exp_f32 v72, v72
    v_smfmac_f32_16x16x64_bf16 a[112:115], v[20:23], v[56:63], v12
    ds_write_b128 v14, a[36:39] offset:11264
    v_sub_f32 v73, v73, v42
    v_exp_f32 v73, v73
    v_sub_f32 v74, v74, v42
    v_exp_f32 v74, v74
    v_smfmac_f32_32x32x32_bf16 a[64:79], a[176:179], v[64:71], v12
    v_sub_f32 v75, v75, v42
    v_exp_f32 v75, v75
    v_sub_f32 v76, v76, v42
    v_exp_f32 v76, v76
    v_sub_f32 v77, v77, v42
    v_exp_f32 v77, v77
    v_smfmac_f32_16x16x64_bf16 a[112:115], v[20:23], v[64:71], v12
    ds_write_b128 v14, a[40:43] offset:12288
    v_sub_f32 v78, v78, v42
    v_exp_f32 v78, v78
    v_sub_f32 v79, v79, v42
    v_exp_f32 v79, v79
    v_mfma_f32_32x32x16_bf16 v[48:63], v[120:123], v[192:195], 4.0
    v_sub_f32 v80, v80, v36
    v_exp_f32 v80, v80
    v_sub_f32 v81, v81, v36
    v_exp_f32 v81, v81
    v_sub_f32 v82, v82, v36
    v_exp_f32 v82, v82
    v_mfma_f32_32x32x16_bf16 v[48:63], v[124:127], v[196:199], v[48:63]
    v_sub_f32 v83, v83, v36
    v_exp_f32 v83, v83
    v_sub_f32 v84, v84, v36
    v_exp_f32 v84, v84
    v_sub_f32 v85, v85, v36
    v_exp_f32 v85, v85
    v_smfmac_f32_32x32x32_bf16 a[64:79], a[180:183], v[72:79], v12
    v_sub_f32 v86, v86, v36
    v_exp_f32 v86, v86
    v_sub_f32 v87, v87, v36
    v_exp_f32 v87, v87
    v_sub_f32 v88, v88, v36
    v_exp_f32 v88, v88
    v_smfmac_f32_16x16x64_bf16 a[112:115], v[20:23], v[72:79], v12
    ds_write_b128 v14, a[44:47] offset:13312
    v_sub_f32 v89, v89, v36
    v_exp_f32 v89, v89
    v_sub_f32 v90, v90, v36
    v_exp_f32 v90, v90
    v_smfmac_f32_32x32x32_bf16 v[208:223], a[168:171], v[80:87], v12
    v_sub_f32 v91, v91, v36
    v_exp_f32 v91, v91
    v_sub_f32 v92, v92, v36
    v_exp_f32 v92, v92
    v_sub_f32 v93, v93, v36
    v_exp_f32 v93, v93
    v_smfmac_f32_16x16x64_bf16 v[240:243], v[20:23], v[80:87], v12
    ds_write_b32 v14, a104 offset:14336
    v_sub_f32 v94, v94, v36
    v_exp_f32 v94, v94
    v_sub_f32 v95, v95, v36
    v_exp_f32 v95, v95
    v_mfma_f32_32x32x16_bf16 v[64:79], v[112:115], a[128:131], 4.0
    v_sub_f32 v48, v48, v36
    v_exp_f32 v48, v48
    v_sub_f32 v49, v49, v36
    v_exp_f32 v49, v49
    v_sub_f32 v50, v50, v36
    v_exp_f32 v50, v50
    v_mfma_f32_32x32x16_bf16 v[64:79], v[116:119], a[132:135], v[64:79]
    ds_write_b128 v14, a[64:67] offset:20480
    v_sub_f32 v51, v51, v36
    v_exp_f32 v51, v51
    v_sub_f32 v52, v52, v36
    v_exp_f32 v52, v52
    v_sub_f32 v53, v53, v36
    v_exp_f32 v53, v53
    v_smfmac_f32_32x32x32_bf16 v[208:223], a[172:175], v[88:95], v12
    ds_write_b128 v14, a[68:71] offset:21504
    v_sub_f32 v54, v54, v36
    v_exp_f32 v54, v54
    v_sub_f32 v55, v55, v36
    v_exp_f32 v55, v55
    v_sub_f32 v56, v56, v36
    v_exp_f32 v56, v56
    v_smfmac_f32_16x16x64_bf16 v[240:243], v[20:23], v[88:95], v12
    ds_write_b128 v14, a[72:75] offset:22528
    v_sub_f32 v57, v57, v36
    v_exp_f32 v57, v57
    v_sub_f32 v58, v58, v36
    v_exp_f32 v58, v58
    v_smfmac_f32_32x32x32_bf16 v[208:223], a[176:179], v[48:55], v12
    ds_write_b128 v14, a[76:79] offset:23552
    v_sub_f32 v59, v59, v36
    v_exp_f32 v59, v59
    v_sub_f32 v60, v60, v36
    v_exp_f32 v60, v60
    v_sub_f32 v61, v61, v36
    v_exp_f32 v61, v61
    v_smfmac_f32_16x16x64_bf16 v[240:243], v[20:23], v[48:55], v12
    ds_write_b32 v14, a112 offset:24576
    v_sub_f32 v62, v62, v36
    v_exp_f32 v62, v62
    v_sub_f32 v63, v63, v36
    v_exp_f32 v63, v63
    v_mfma_f32_32x32x16_bf16 v[80:95], v[120:123], a[128:131], 4.0
    v_sub_f32 v64, v64, v39
    v_exp_f32 v64, v64
    v_sub_f32 v65, v65, v39
    v_exp_f32 v65, v65
    v_sub_f32 v66, v66, v39
    v_exp_f32 v66, v66
    v_mfma_f32_32x32x16_bf16 v[80:95], v[124:127], a[132:135], v[80:95]
    s_waitcnt lgkmcnt(0)
    v_sub_f32 v67, v67, v39
    v_exp_f32 v67, v67
    v_sub_f32 v68, v68, v39
    v_exp_f32 v68, v68
    v_sub_f32 v69, v69, v39
    v_exp_f32 v69, v69
    v_smfmac_f32_32x32x32_bf16 v[208:223], a[180:183], v[56:63], v12
    s_barrier
    ds_read_b128 v[144:147], v248
    v_sub_f32 v70, v70, v39
    v_exp_f32 v70, v70
    v_sub_f32 v71, v71, v39
    v_exp_f32 v71, v71
    v_sub_f32 v72, v72, v39
    v_exp_f32 v72, v72
    v_smfmac_f32_16x16x64_bf16 v[240:243], v[20:23], v[56:63], v12
    ds_read_b128 v[148:151], v248 offset:1024
    ds_read_b128 v[152:155], v248 offset:2048
    v_sub_f32 v73, v73, v39
    v_exp_f32 v73, v73
    v_sub_f32 v74, v74, v39
    v_exp_f32 v74, v74
    v_smfmac_f32_32x32x32_bf16 a[16:31], a[168:171], v[64:71], v12
    ds_read_b128 v[156:159], v248 offset:3072
    ds_read_b32 v8, v248 offset:4096
    v_sub_f32 v75, v75, v39
    v_exp_f32 v75, v75
    v_sub_f32 v76, v76, v39
    v_exp_f32 v76, v76
    v_sub_f32 v77, v77, v39
    v_exp_f32 v77, v77
    v_smfmac_f32_16x16x64_bf16 a[100:103], v[20:23], v[64:71], v12
    ds_read_b128 v[160:163], v249 offset:10240
    ds_read_b128 v[164:167], v249 offset:11264
    v_sub_f32 v78, v78, v39
    v_exp_f32 v78, v78
    v_sub_f32 v79, v79, v39
    v_exp_f32 v79, v79
    v_mfma_f32_32x32x16_bf16 v[48:63], v[112:115], a[144:147], 4.0
    ds_read_b128 v[168:171], v249 offset:12288
    v_sub_f32 v80, v80, v39
    v_exp_f32 v80, v80
    v_sub_f32 v81, v81, v39
    v_exp_f32 v81, v81
    v_sub_f32 v82, v82, v39
    v_exp_f32 v82, v82
    v_mfma_f32_32x32x16_bf16 v[48:63], v[116:119], a[148:151], v[48:63]
    ds_read_b128 v[172:175], v249 offset:13312
    v_sub_f32 v83, v83, v39
    v_exp_f32 v83, v83
    v_sub_f32 v84, v84, v39
    v_exp_f32 v84, v84
    v_sub_f32 v85, v85, v39
    v_exp_f32 v85, v85
    v_smfmac_f32_32x32x32_bf16 a[16:31], a[172:175], v[72:79], v12
    ds_read_b32 v9, v249 offset:14336
    ds_read_b128 v[176:179], v250 offset:20480
    v_sub_f32 v86, v86, v39
    v_exp_f32 v86, v86
    v_sub_f32 v87, v87, v39
    v_exp_f32 v87, v87
    v_sub_f32 v88, v88, v39
    v_exp_f32 v88, v88
    v_smfmac_f32_16x16x64_bf16 a[100:103], v[20:23], v[72:79], v12
    s_waitcnt lgkmcnt(6)
    ds_read_b128 v[180:183], v250 offset:21504
    v_sub_f32 v89, v89, v39
    v_exp_f32 v89, v89
    v_sub_f32 v90, v90, v39
    v_exp_f32 v90, v90
    v_pk_add_f32 v[208:209], v[208:209], v[144:145]
    v_pk_add_f32 v[210:211], v[210:211], v[146:147]
    v_pk_add_f32 v[212:213], v[212:213], v[148:149]
    v_pk_add_f32 v[214:215], v[214:215], v[150:151]
    v_pk_add_f32 v[216:217], v[216:217], v[152:153]
    v_pk_add_f32 v[218:219], v[218:219], v[154:155]
    v_smfmac_f32_32x32x32_bf16 a[16:31], a[176:179], v[80:87], v12
    ds_read_b128 v[184:187], v250 offset:22528
    v_sub_f32 v91, v91, v39
    v_exp_f32 v91, v91
    v_sub_f32 v92, v92, v39
    v_exp_f32 v92, v92
    v_sub_f32 v93, v93, v39
    v_exp_f32 v93, v93
    v_smfmac_f32_16x16x64_bf16 a[100:103], v[20:23], v[80:87], v12
    s_waitcnt lgkmcnt(3)
    ds_read_b128 v[188:191], v250 offset:23552
    v_sub_f32 v94, v94, v39
    v_exp_f32 v94, v94
    v_sub_f32 v95, v95, v39
    v_exp_f32 v95, v95
    v_pk_add_f32 v[220:221], v[220:221], v[156:157]
    v_pk_add_f32 v[222:223], v[222:223], v[158:159]
    v_pk_add_f32 v[208:209], v[208:209], v[160:161]
    v_pk_add_f32 v[210:211], v[210:211], v[162:163]
    v_pk_add_f32 v[212:213], v[212:213], v[164:165]
    v_pk_add_f32 v[214:215], v[214:215], v[166:167]
    v_mfma_f32_32x32x16_bf16 v[64:79], v[120:123], a[144:147], 4.0
    ds_read_b32 v10, v250 offset:24576
    v_sub_f32 v48, v48, v41
    v_exp_f32 v48, v48
    v_sub_f32 v49, v49, v41
    v_exp_f32 v49, v49
    v_sub_f32 v50, v50, v41
    v_exp_f32 v50, v50
    v_mfma_f32_32x32x16_bf16 v[64:79], v[124:127], a[148:151], v[64:79]
    v_sub_f32 v51, v51, v41
    v_exp_f32 v51, v51
    v_sub_f32 v52, v52, v41
    v_exp_f32 v52, v52
    v_sub_f32 v53, v53, v41
    v_exp_f32 v53, v53
    v_smfmac_f32_32x32x32_bf16 a[16:31], a[180:183], v[88:95], v12
    v_sub_f32 v54, v54, v41
    v_exp_f32 v54, v54
    v_sub_f32 v55, v55, v41
    v_exp_f32 v55, v55
    v_sub_f32 v56, v56, v41
    v_exp_f32 v56, v56
    v_smfmac_f32_16x16x64_bf16 a[100:103], v[20:23], v[88:95], v12
    s_waitcnt lgkmcnt(0)
    v_sub_f32 v57, v57, v41
    v_exp_f32 v57, v57
    v_sub_f32 v58, v58, v41
    v_exp_f32 v58, v58
    v_pk_add_f32 v[216:217], v[216:217], v[168:169]
    v_pk_add_f32 v[218:219], v[218:219], v[170:171]
    v_pk_add_f32 v[220:221], v[220:221], v[172:173]
    v_pk_add_f32 v[222:223], v[222:223], v[174:175]
    v_pk_add_f32 v[208:209], v[208:209], v[176:177]
    v_pk_add_f32 v[210:211], v[210:211], v[178:179]
    v_smfmac_f32_32x32x32_bf16 a[48:63], a[168:171], v[48:55], v12
    v_sub_f32 v59, v59, v41
    v_exp_f32 v59, v59
    v_sub_f32 v60, v60, v41
    v_exp_f32 v60, v60
    v_sub_f32 v61, v61, v41
    v_exp_f32 v61, v61
    v_add_f32 v240, v240, v8
    v_add_f32 v240, v240, v9
    v_add_f32 v240, v240, v10
    v_rcp_f32 v240, v240
    v_smfmac_f32_16x16x64_bf16 a[108:111], v[20:23], v[48:55], v12
    v_sub_f32 v62, v62, v41
    v_exp_f32 v62, v62
    v_sub_f32 v63, v63, v41
    v_exp_f32 v63, v63
    v_pk_add_f32 v[212:213], v[212:213], v[180:181]
    v_pk_add_f32 v[214:215], v[214:215], v[182:183]
    v_pk_add_f32 v[216:217], v[216:217], v[184:185]
    v_pk_add_f32 v[218:219], v[218:219], v[186:187]
    v_pk_add_f32 v[220:221], v[220:221], v[188:189]
    v_pk_add_f32 v[222:223], v[222:223], v[190:191]
    v_mfma_f32_32x32x16_bf16 v[80:95], v[112:115], a[160:163], 4.0
    v_sub_f32 v64, v64, v41
    v_exp_f32 v64, v64
    v_sub_f32 v65, v65, v41
    v_exp_f32 v65, v65
    v_sub_f32 v66, v66, v41
    v_exp_f32 v66, v66
    v_mfma_f32_32x32x16_bf16 v[80:95], v[116:119], a[164:167], v[80:95]
    ds_write_b128 v14, a[16:19] offset:5120
    v_sub_f32 v67, v67, v41
    v_exp_f32 v67, v67
    v_sub_f32 v68, v68, v41
    v_exp_f32 v68, v68
    v_sub_f32 v69, v69, v41
    v_exp_f32 v69, v69
    v_smfmac_f32_32x32x32_bf16 a[48:63], a[172:175], v[56:63], v12
    ds_write_b128 v14, a[20:23] offset:6144
    v_sub_f32 v70, v70, v41
    v_exp_f32 v70, v70
    v_sub_f32 v71, v71, v41
    v_exp_f32 v71, v71
    v_sub_f32 v72, v72, v41
    v_exp_f32 v72, v72
    v_smfmac_f32_16x16x64_bf16 a[108:111], v[20:23], v[56:63], v12
    ds_write_b128 v14, a[24:27] offset:7168
    v_sub_f32 v73, v73, v41
    v_exp_f32 v73, v73
    v_sub_f32 v74, v74, v41
    v_exp_f32 v74, v74
    v_pk_mul_f32 v[208:209], v[208:209], v[240:241] op_sel_hi:[1,0]
    v_pk_mul_f32 v[210:211], v[210:211], v[240:241] op_sel_hi:[1,0]
    v_pk_mul_f32 v[212:213], v[212:213], v[240:241] op_sel_hi:[1,0]
    v_pk_mul_f32 v[214:215], v[214:215], v[240:241] op_sel_hi:[1,0]
    v_smfmac_f32_32x32x32_bf16 a[48:63], a[176:179], v[64:71], v12
    ds_write_b128 v14, a[28:31] offset:8192
    v_sub_f32 v75, v75, v41
    v_exp_f32 v75, v75
    v_sub_f32 v76, v76, v41
    v_exp_f32 v76, v76
    v_sub_f32 v77, v77, v41
    v_exp_f32 v77, v77
    v_cvt_pk_bf16_f32 v4, v208, v209
    v_cvt_pk_bf16_f32 v5, v210, v211
    v_cvt_pk_bf16_f32 v6, v212, v213
    v_cvt_pk_bf16_f32 v7, v214, v215
    v_smfmac_f32_16x16x64_bf16 a[108:111], v[20:23], v[64:71], v12
    ds_write_b32 v14, a100 offset:9216
    v_sub_f32 v78, v78, v41
    v_exp_f32 v78, v78
    v_sub_f32 v79, v79, v41
    v_exp_f32 v79, v79
    v_pk_mul_f32 v[216:217], v[216:217], v[240:241] op_sel_hi:[1,0]
    v_pk_mul_f32 v[218:219], v[218:219], v[240:241] op_sel_hi:[1,0]
    v_pk_mul_f32 v[220:221], v[220:221], v[240:241] op_sel_hi:[1,0]
    v_pk_mul_f32 v[222:223], v[222:223], v[240:241] op_sel_hi:[1,0]
    v_mfma_f32_32x32x16_bf16 v[48:63], v[120:123], a[160:163], 4.0
    ds_write_b128 v251, v[4:7] offset:30720
    v_sub_f32 v80, v80, v43
    v_exp_f32 v80, v80
    v_sub_f32 v81, v81, v43
    v_exp_f32 v81, v81
    v_sub_f32 v82, v82, v43
    v_exp_f32 v82, v82
    v_cvt_pk_bf16_f32 v24, v216, v217
    v_cvt_pk_bf16_f32 v25, v218, v219
    v_cvt_pk_bf16_f32 v26, v220, v221
    v_cvt_pk_bf16_f32 v27, v222, v223
    v_mfma_f32_32x32x16_bf16 v[48:63], v[124:127], a[164:167], v[48:63]
    ds_write_b128 v252, v[24:27] offset:30720
    v_sub_f32 v83, v83, v43
    v_exp_f32 v83, v83
    v_sub_f32 v84, v84, v43
    v_exp_f32 v84, v84
    v_sub_f32 v85, v85, v43
    v_exp_f32 v85, v85
    v_smfmac_f32_32x32x32_bf16 a[48:63], a[180:183], v[72:79], v12
    ds_read_b128 v[28:31], v14 offset:30720
    v_sub_f32 v86, v86, v43
    v_exp_f32 v86, v86
    v_sub_f32 v87, v87, v43
    v_exp_f32 v87, v87
    v_sub_f32 v88, v88, v43
    v_exp_f32 v88, v88
    v_smfmac_f32_16x16x64_bf16 a[108:111], v[20:23], v[72:79], v12
    ds_read_b128 v[32:35], v14 offset:31744
    v_sub_f32 v89, v89, v43
    v_exp_f32 v89, v89
    v_sub_f32 v90, v90, v43
    v_exp_f32 v90, v90
    v_smfmac_f32_32x32x32_bf16 a[80:95], a[168:171], v[80:87], v12
    v_sub_f32 v91, v91, v43
    v_exp_f32 v91, v91
    v_sub_f32 v92, v92, v43
    v_exp_f32 v92, v92
    v_sub_f32 v93, v93, v43
    v_exp_f32 v93, v93
    v_smfmac_f32_16x16x64_bf16 a[116:119], v[20:23], v[80:87], v12
    s_waitcnt lgkmcnt(1)
    buffer_store_dwordx4 v[28:31], v253, s[28:31], s35 offen sc0 sc1
    v_sub_f32 v94, v94, v43
    v_exp_f32 v94, v94
    v_sub_f32 v95, v95, v43
    v_exp_f32 v95, v95
    v_mfma_f32_32x32x16_bf16 v[64:79], v[96:99], v[200:203], 4.0
    s_waitcnt lgkmcnt(0)
    buffer_store_dwordx4 v[32:35], v253, s[28:31], s35 offen offset:1024 sc0 sc1
    v_sub_f32 v48, v48, v43
    v_exp_f32 v48, v48
    v_sub_f32 v49, v49, v43
    v_exp_f32 v49, v49
    v_sub_f32 v50, v50, v43
    v_exp_f32 v50, v50
    v_mfma_f32_32x32x16_bf16 v[64:79], v[100:103], v[204:207], v[64:79]
    ds_write_b128 v14, a[48:51] offset:15360
    v_sub_f32 v51, v51, v43
    v_exp_f32 v51, v51
    v_sub_f32 v52, v52, v43
    v_exp_f32 v52, v52
    v_sub_f32 v53, v53, v43
    v_exp_f32 v53, v53
    v_smfmac_f32_32x32x32_bf16 a[80:95], a[172:175], v[88:95], v12
    ds_write_b128 v14, a[52:55] offset:16384
    v_sub_f32 v54, v54, v43
    v_exp_f32 v54, v54
    v_sub_f32 v55, v55, v43
    v_exp_f32 v55, v55
    v_sub_f32 v56, v56, v43
    v_exp_f32 v56, v56
    v_smfmac_f32_16x16x64_bf16 a[116:119], v[20:23], v[88:95], v12
    ds_write_b128 v14, a[56:59] offset:17408
    v_sub_f32 v57, v57, v43
    v_exp_f32 v57, v57
    v_sub_f32 v58, v58, v43
    v_exp_f32 v58, v58
    v_smfmac_f32_32x32x32_bf16 a[80:95], a[176:179], v[48:55], v12
    ds_write_b128 v14, a[60:63] offset:18432
    v_sub_f32 v59, v59, v43
    v_exp_f32 v59, v59
    v_sub_f32 v60, v60, v43
    v_exp_f32 v60, v60
    v_sub_f32 v61, v61, v43
    v_exp_f32 v61, v61
    v_smfmac_f32_16x16x64_bf16 a[116:119], v[20:23], v[48:55], v12
    ds_write_b32 v14, a108 offset:19456
    v_sub_f32 v62, v62, v43
    v_exp_f32 v62, v62
    v_sub_f32 v63, v63, v43
    v_exp_f32 v63, v63
    v_mfma_f32_32x32x16_bf16 v[80:95], v[104:107], v[200:203], 4.0
    v_sub_f32 v64, v64, v37
    v_exp_f32 v64, v64
    v_sub_f32 v65, v65, v37
    v_exp_f32 v65, v65
    v_sub_f32 v66, v66, v37
    v_exp_f32 v66, v66
    v_mfma_f32_32x32x16_bf16 v[80:95], v[108:111], v[204:207], v[80:95]
    s_waitcnt lgkmcnt(0)
    v_sub_f32 v67, v67, v37
    v_exp_f32 v67, v67
    v_sub_f32 v68, v68, v37
    v_exp_f32 v68, v68
    v_sub_f32 v69, v69, v37
    v_exp_f32 v69, v69
    v_smfmac_f32_32x32x32_bf16 a[80:95], a[180:183], v[56:63], v12
    s_barrier
    ds_read_b128 v[144:147], v248 offset:5120
    v_sub_f32 v70, v70, v37
    v_exp_f32 v70, v70
    v_sub_f32 v71, v71, v37
    v_exp_f32 v71, v71
    v_sub_f32 v72, v72, v37
    v_exp_f32 v72, v72
    v_smfmac_f32_16x16x64_bf16 a[116:119], v[20:23], v[56:63], v12
    ds_read_b128 v[148:151], v248 offset:6144
    ds_read_b128 v[152:155], v248 offset:7168
    v_sub_f32 v73, v73, v37
    v_exp_f32 v73, v73
    v_sub_f32 v74, v74, v37
    v_exp_f32 v74, v74
    v_smfmac_f32_32x32x32_bf16 v[224:239], v[128:131], v[64:71], v12
    ds_read_b128 v[156:159], v248 offset:8192
    ds_read_b32 v11, v248 offset:9216
    v_sub_f32 v75, v75, v37
    v_exp_f32 v75, v75
    v_sub_f32 v76, v76, v37
    v_exp_f32 v76, v76
    v_sub_f32 v77, v77, v37
    v_exp_f32 v77, v77
    v_smfmac_f32_16x16x64_bf16 v[244:247], v[20:23], v[64:71], v12
    ds_read_b128 v[160:163], v249 offset:15360
    ds_read_b128 v[164:167], v249 offset:16384
    v_sub_f32 v78, v78, v37
    v_exp_f32 v78, v78
    v_sub_f32 v79, v79, v37
    v_exp_f32 v79, v79
    v_mfma_f32_32x32x16_bf16 v[48:63], v[112:115], v[200:203], 4.0
    ds_read_b128 v[168:171], v249 offset:17408
    v_sub_f32 v80, v80, v37
    v_exp_f32 v80, v80
    v_sub_f32 v81, v81, v37
    v_exp_f32 v81, v81
    v_sub_f32 v82, v82, v37
    v_exp_f32 v82, v82
    v_mfma_f32_32x32x16_bf16 v[48:63], v[116:119], v[204:207], v[48:63]
    ds_write_b128 v14, a[80:83] offset:25600
    v_sub_f32 v83, v83, v37
    v_exp_f32 v83, v83
    v_sub_f32 v84, v84, v37
    v_exp_f32 v84, v84
    v_sub_f32 v85, v85, v37
    v_exp_f32 v85, v85
    v_smfmac_f32_32x32x32_bf16 v[224:239], v[132:135], v[72:79], v12
    ds_write_b128 v14, a[84:87] offset:26624
    v_sub_f32 v86, v86, v37
    v_exp_f32 v86, v86
    v_sub_f32 v87, v87, v37
    v_exp_f32 v87, v87
    v_sub_f32 v88, v88, v37
    v_exp_f32 v88, v88
    v_smfmac_f32_16x16x64_bf16 v[244:247], v[20:23], v[72:79], v12
    ds_write_b128 v14, a[88:91] offset:27648
    v_sub_f32 v89, v89, v37
    v_exp_f32 v89, v89
    v_sub_f32 v90, v90, v37
    v_exp_f32 v90, v90
    v_smfmac_f32_32x32x32_bf16 v[224:239], v[136:139], v[80:87], v12
    ds_write_b128 v14, a[92:95] offset:28672
    v_sub_f32 v91, v91, v37
    v_exp_f32 v91, v91
    v_sub_f32 v92, v92, v37
    v_exp_f32 v92, v92
    v_sub_f32 v93, v93, v37
    v_exp_f32 v93, v93
    v_smfmac_f32_16x16x64_bf16 v[244:247], v[20:23], v[80:87], v12
    ds_write_b32 v14, a116 offset:29696
    v_sub_f32 v94, v94, v37
    v_exp_f32 v94, v94
    v_sub_f32 v95, v95, v37
    v_exp_f32 v95, v95
    v_mfma_f32_32x32x16_bf16 v[64:79], v[120:123], v[200:203], 4.0
    ds_read_b128 v[172:175], v249 offset:18432
    ds_read_b32 v1, v249 offset:19456
    v_sub_f32 v48, v48, v37
    v_exp_f32 v48, v48
    v_sub_f32 v49, v49, v37
    v_exp_f32 v49, v49
    v_sub_f32 v50, v50, v37
    v_exp_f32 v50, v50
    v_mfma_f32_32x32x16_bf16 v[64:79], v[124:127], v[204:207], v[64:79]
    s_waitcnt lgkmcnt(2)
    v_sub_f32 v51, v51, v37
    v_exp_f32 v51, v51
    v_sub_f32 v52, v52, v37
    v_exp_f32 v52, v52
    v_sub_f32 v53, v53, v37
    v_exp_f32 v53, v53
    v_smfmac_f32_32x32x32_bf16 v[224:239], v[140:143], v[88:95], v12
    s_barrier
    ds_read_b128 v[176:179], v250 offset:25600
    v_sub_f32 v54, v54, v37
    v_exp_f32 v54, v54
    v_sub_f32 v55, v55, v37
    v_exp_f32 v55, v55
    v_sub_f32 v56, v56, v37
    v_exp_f32 v56, v56
    v_smfmac_f32_16x16x64_bf16 v[244:247], v[20:23], v[88:95], v12
    s_waitcnt lgkmcnt(1)
    ds_read_b128 v[180:183], v250 offset:26624
    v_sub_f32 v57, v57, v37
    v_exp_f32 v57, v57
    v_sub_f32 v58, v58, v37
    v_exp_f32 v58, v58
    v_pk_add_f32 v[144:145], v[144:145], v[160:161]
    v_pk_add_f32 v[146:147], v[146:147], v[162:163]
    v_pk_add_f32 v[148:149], v[148:149], v[164:165]
    v_pk_add_f32 v[150:151], v[150:151], v[166:167]
    v_smfmac_f32_32x32x32_bf16 v[224:239], a[168:171], v[48:55], v12
    ds_read_b128 v[184:187], v250 offset:27648
    v_sub_f32 v59, v59, v37
    v_exp_f32 v59, v59
    v_sub_f32 v60, v60, v37
    v_exp_f32 v60, v60
    v_sub_f32 v61, v61, v37
    v_exp_f32 v61, v61
    v_add_f32 v11, v11, v1
    v_smfmac_f32_16x16x64_bf16 v[244:247], v[20:23], v[48:55], v12
    ds_read_b128 v[188:191], v250 offset:28672
    ds_read_b32 v3, v250 offset:29696
    v_sub_f32 v62, v62, v37
    v_exp_f32 v62, v62
    v_sub_f32 v63, v63, v37
    v_exp_f32 v63, v63
    v_pk_add_f32 v[152:153], v[152:153], v[168:169]
    v_pk_add_f32 v[154:155], v[154:155], v[170:171]
    v_pk_add_f32 v[156:157], v[156:157], v[172:173]
    v_pk_add_f32 v[158:159], v[158:159], v[174:175]
    v_sub_f32 v64, v64, v37
    v_exp_f32 v64, v64
    v_sub_f32 v65, v65, v37
    v_exp_f32 v65, v65
    v_sub_f32 v66, v66, v37
    v_exp_f32 v66, v66
    v_sub_f32 v67, v67, v37
    v_exp_f32 v67, v67
    v_sub_f32 v68, v68, v37
    v_exp_f32 v68, v68
    v_sub_f32 v69, v69, v37
    v_exp_f32 v69, v69
    s_waitcnt lgkmcnt(0)
    v_pk_add_f32 v[144:145], v[144:145], v[176:177]
    v_pk_add_f32 v[146:147], v[146:147], v[178:179]
    v_pk_add_f32 v[148:149], v[148:149], v[180:181]
    v_pk_add_f32 v[150:151], v[150:151], v[182:183]
    v_pk_add_f32 v[152:153], v[152:153], v[184:185]
    v_pk_add_f32 v[154:155], v[154:155], v[186:187]
    v_pk_add_f32 v[156:157], v[156:157], v[188:189]
    v_pk_add_f32 v[158:159], v[158:159], v[190:191]
    v_add_f32 v11, v11, v3
    v_smfmac_f32_32x32x32_bf16 v[224:239], a[172:175], v[56:63], v12
    v_sub_f32 v70, v70, v37
    v_exp_f32 v70, v70
    v_sub_f32 v71, v71, v37
    v_exp_f32 v71, v71
    v_sub_f32 v72, v72, v37
    v_exp_f32 v72, v72
    v_smfmac_f32_16x16x64_bf16 v[244:247], v[20:23], v[56:63], v12
    v_sub_f32 v73, v73, v37
    v_exp_f32 v73, v73
    v_sub_f32 v74, v74, v37
    v_exp_f32 v74, v74
    v_smfmac_f32_32x32x32_bf16 v[224:239], a[176:179], v[64:71], v12
    v_sub_f32 v75, v75, v37
    v_exp_f32 v75, v75
    v_sub_f32 v76, v76, v37
    v_exp_f32 v76, v76
    v_sub_f32 v77, v77, v37
    v_exp_f32 v77, v77
    v_smfmac_f32_16x16x64_bf16 v[244:247], v[20:23], v[64:71], v12
    v_sub_f32 v78, v78, v37
    v_exp_f32 v78, v78
    v_sub_f32 v79, v79, v37
    v_exp_f32 v79, v79
    s_nop 1
    v_smfmac_f32_16x16x64_bf16 v[244:247], v[20:23], v[72:79], v12
    v_smfmac_f32_32x32x32_bf16 v[224:239], a[180:183], v[72:79], v12
    s_nop 6
    v_add_f32 v244, v244, v11
    v_rcp_f32 v244, v244
    s_nop 2
    v_pk_add_f32 v[224:225], v[224:225], v[144:145]
    v_pk_add_f32 v[226:227], v[226:227], v[146:147]
    v_pk_add_f32 v[228:229], v[228:229], v[148:149]
    v_pk_add_f32 v[230:231], v[230:231], v[150:151]
    v_pk_mul_f32 v[224:225], v[224:225], v[244:245] op_sel_hi:[1,0]
    v_pk_mul_f32 v[226:227], v[226:227], v[244:245] op_sel_hi:[1,0]
    v_pk_mul_f32 v[228:229], v[228:229], v[244:245] op_sel_hi:[1,0]
    v_pk_mul_f32 v[230:231], v[230:231], v[244:245] op_sel_hi:[1,0]
    v_cvt_pk_bf16_f32 v4, v224, v225
    v_cvt_pk_bf16_f32 v5, v226, v227
    v_cvt_pk_bf16_f32 v6, v228, v229
    v_cvt_pk_bf16_f32 v7, v230, v231
    ds_write_b128 v251, v[4:7] offset:30720
    v_pk_add_f32 v[232:233], v[232:233], v[152:153]
    v_pk_add_f32 v[234:235], v[234:235], v[154:155]
    v_pk_add_f32 v[236:237], v[236:237], v[156:157]
    v_pk_add_f32 v[238:239], v[238:239], v[158:159]
    v_pk_mul_f32 v[232:233], v[232:233], v[244:245] op_sel_hi:[1,0]
    v_pk_mul_f32 v[234:235], v[234:235], v[244:245] op_sel_hi:[1,0]
    v_pk_mul_f32 v[236:237], v[236:237], v[244:245] op_sel_hi:[1,0]
    v_pk_mul_f32 v[238:239], v[238:239], v[244:245] op_sel_hi:[1,0]
    v_cvt_pk_bf16_f32 v24, v232, v233
    v_cvt_pk_bf16_f32 v25, v234, v235
    v_cvt_pk_bf16_f32 v26, v236, v237
    v_cvt_pk_bf16_f32 v27, v238, v239
    ds_write_b128 v252, v[24:27] offset:30720
    ds_read_b128 v[160:163], v14 offset:30720
    ds_read_b128 v[164:167], v14 offset:31744
    s_waitcnt lgkmcnt(1)
    buffer_store_dwordx4 v[160:163], v253, s[28:31], s35 offen offset:2048 sc0 sc1
    s_waitcnt lgkmcnt(0)
    buffer_store_dwordx4 v[164:167], v253, s[28:31], s35 offen offset:3072 sc0 sc1
    s_endpgm
L_end:
    s_endpgm
.section .rodata,"a"
.p2align 6
.amdhsa_kernel standalone__qk_norm__prompt_kernel
  .amdhsa_next_free_vgpr 440
  .amdhsa_next_free_sgpr 96
  .amdhsa_accum_offset 256
  .amdhsa_group_segment_fixed_size 0
  .amdhsa_kernarg_size 56
  .amdhsa_user_sgpr_count 2
  .amdhsa_user_sgpr_kernarg_segment_ptr 1
  .amdhsa_system_sgpr_workgroup_id_x 1
.end_amdhsa_kernel
```
